```python
import torch

def _softmax(x, axis=-1):
    return torch.softmax(x, dim=axis)
def _gelu(x):
    return torch.nn.functional.gelu(x, approximate="tanh")
def _silu(x):
    return torch.nn.functional.silu(x)
def _sigmoid(x):
    return torch.sigmoid(x)
def _layernorm(x, axis=-1, eps=1e-5):
    m = x.mean(dim=axis, keepdim=True)
    v = x.var(dim=axis, keepdim=True, unbiased=False)
    return (x - m) / torch.sqrt(v + eps)
def _scatter_add(tgt, idx, src, axis=0):
    return tgt.clone().index_add_(axis, idx, src)
def _segment_sum(src, seg, n):
    out = torch.zeros((n,) + src.shape[1:], dtype=src.dtype)
    return out.index_add_(0, seg, src)
def _pad(x, pw):
    flat = tuple(v for pair in reversed(pw) for v in pair)
    return torch.nn.functional.pad(x, flat)

kernel_name = 'sequential_preLN__sliding_block__dense_activation_squared_relu__prompt'

def setup_inputs():

    _w = (lambda a: (lambda t: t.to(torch.bfloat16) if t.is_floating_point() else t)(torch.as_tensor(a)))
    def _A_setup():
        B, S, D = 1, 2048, 640
        return {
            "x": _w((lambda *s: torch.randn(*s, dtype=torch.bfloat16) * 0.05)(B, S, D)),
            "wqkv": _w((lambda *s: torch.randn(*s, dtype=torch.bfloat16) * 0.05)(D, 3 * D)),
            "wo": _w((lambda *s: torch.randn(*s, dtype=torch.bfloat16) * 0.05)(D, D)),
        }
    _A_in = _A_setup()

    def _B_setup():
        B, S, D, F = 1, 2048, 640, 1728
        return {
            "x": _w((lambda *s: torch.randn(*s, dtype=torch.bfloat16) * 0.05)(B, S, D)),
            "w1": _w((lambda *s: torch.randn(*s, dtype=torch.bfloat16) * 0.05)(D, F)),
            "b1": _w((lambda *s: torch.randn(*s, dtype=torch.bfloat16) * 0.4)(F)),
            "w2": _w((lambda *s: torch.randn(*s, dtype=torch.bfloat16) * 0.05)(F, D)),
            "b2": _w((lambda *s: torch.randn(*s, dtype=torch.bfloat16) * 3.2)(D)),
        }
    _B_in = _B_setup()

    return {
        "A_x": _A_in["x"],
        "A_wqkv": _A_in["wqkv"],
        "A_wo": _A_in["wo"],
        "B_x": _B_in["x"],
        "B_w1": _B_in["w1"],
        "B_b1": _B_in["b1"],
        "B_w2": _B_in["w2"],
        "B_b2": _B_in["b2"],
    }

def reference(A_x, A_wqkv, A_wo, B_x, B_w1, B_b1, B_w2, B_b2):
    def _A_ref(x, wqkv, wo):
        B, S, D = x.shape
        H = 32; Dh = D // H; W = 256
        qkv = (lambda x, *d: x.permute(*d))((x @ wqkv).reshape(B, S, 3, H, Dh), 2, 0, 3, 1, 4)
        q, k, v = qkv[0], qkv[1], qkv[2]
        scores = torch.einsum("bhqd,bhkd->bhqk", q, k) * (Dh ** -0.5)
        idx = torch.arange(S)
        mask = (idx[:, None] - idx[None, :] >= 0) & (idx[:, None] - idx[None, :] < W)
        scores = torch.where(mask[None, None], scores, -1e9)
        p = _softmax(scores, axis=-1)
        o = torch.einsum("bhqk,bhkd->bhqd", p, v)
        return (lambda x, *d: x.permute(*d))(o, 0, 2, 1, 3).reshape(B, S, D) @ wo

    def _B_ref(x, w1, b1, w2, b2):
        h = torch.einsum("bsd,df->bsf", x, w1) + b1
        zero = torch.zeros_like(h)
        r = torch.where(h > zero, h, zero)
        h = r * r
        out = torch.einsum("bsf,fd->bsd", h, w2) + b2
        return out

    x = A_x
    h = x + _A_ref(_layernorm(x, axis=-1), A_wqkv, A_wo)
    h2 = h + _B_ref(_layernorm(h, axis=-1), B_w1, B_b1, B_w2, B_b2)
    return h2
```

```asm
; @launch grid=(256,1,1) block=(512,1,1) lds=159744
.amdgcn_target "amdgcn-amd-amdhsa--gfx950"
.text
.globl sequential_preLN__sliding_block__dense_activation_squared_relu__prompt_kernel
.p2align 8
.type sequential_preLN__sliding_block__dense_activation_squared_relu__prompt_kernel,@function
sequential_preLN__sliding_block__dense_activation_squared_relu__prompt_kernel:
    s_cmp_ge_u32 s2, 256
    s_cbranch_scc1 sequential_preLN__sliding_block__dense_activation_squared_relu__prompt_kernel_done
    s_load_dwordx16 s[4:19], s[0:1], 0
    s_load_dwordx2 s[20:21], s[0:1], 64
    s_load_dwordx2 s[22:23], s[0:1], 80
    v_lshrrev_b32 v1, 6, v0
    s_and_b32 s25, s2, 7
    v_readfirstlane_b32 s24, v1
    s_lshr_b32 s26, s2, 3
    v_and_b32 v1, 63, v0
    s_lshr_b32 s52, s25, 1
    s_lshl_b32 s52, s52, 2
    s_and_b32 s57, s26, 3
    s_add_u32 s52, s52, s57
    s_and_b32 s57, s25, 1
    s_mul_i32 s57, s57, 8
    s_lshr_b32 s53, s26, 2
    s_add_u32 s53, s53, s57
    s_lshr_b32 s54, s25, 1
    s_lshl_b32 s54, s54, 2
    s_and_b32 s57, s26, 3
    s_add_u32 s54, s54, s57
    s_and_b32 s57, s25, 1
    s_mul_i32 s57, s57, 5
    s_lshr_b32 s55, s26, 2
    s_add_u32 s55, s55, s57
    s_lshr_b32 s54, s25, 1
    s_lshl_b32 s54, s54, 2
    s_and_b32 s57, s26, 3
    s_add_u32 s54, s54, s57
    s_and_b32 s57, s25, 1
    s_mul_i32 s57, s57, 7
    s_lshr_b32 s56, s26, 2
    s_add_u32 s56, s56, s57
    s_lshr_b32 s58, s26, 2
    s_cmp_lg_u32 s24, 0
    s_cbranch_scc1 nocnt_1
    v_lshlrev_b32 v4, 2, v1
    v_add_u32 v4, 3840, v4
    v_mov_b32 v5, 0
    s_mov_b64 exec, 0xff
    ds_write_b32 v4, v5
    s_mov_b64 exec, -1
nocnt_1:
    s_cmp_ge_u32 s24, 4
    s_cbranch_scc1 sequential_preLN__sliding_block__dense_activation_squared_relu__prompt_kernel_loader
    s_cmp_ge_u32 s53, 15
    s_cbranch_scc1 sequential_preLN__sliding_block__dense_activation_squared_relu__prompt_kernel_inactive
    s_lshl_b32 s59, s52, 7
    s_add_u32 s60, s52, s53
    s_mul_i32 s61, s60, 26
    s_lshr_b32 s61, s61, 8
    s_mul_i32 s61, s61, 10
    s_sub_u32 s60, s60, s61
    v_and_b32 v8, 31, v1
    v_lshrrev_b32 v9, 5, v1
    s_lshr_b32 s66, s24, 1
    s_and_b32 s67, s24, 1
    s_lshl_b32 s62, s66, 1
    s_add_u32 s62, s62, s67
    s_xor_b32 s63, s62, 1
    s_lshl_b32 s64, s67, 1
    s_add_u32 s64, s64, s66
    s_xor_b32 s65, s64, 1
    s_lshl_b32 s66, s62, 12
    s_add_u32 s66, s66, 4096
    v_bfe_u32 v4, v8, 1, 3
    v_add_u32 v5, 0, v9
    v_xor_b32 v4, v4, v5
    v_lshlrev_b32 v4, 4, v4
    v_lshl_add_u32 v4, v8, 7, v4
    v_add_u32 v10, s66, v4
    s_lshl_b32 s66, s62, 12
    s_add_u32 s66, s66, 4096
    v_bfe_u32 v4, v8, 1, 3
    v_add_u32 v5, 2, v9
    v_xor_b32 v4, v4, v5
    v_lshlrev_b32 v4, 4, v4
    v_lshl_add_u32 v4, v8, 7, v4
    v_add_u32 v11, s66, v4
    s_lshl_b32 s66, s62, 12
    s_add_u32 s66, s66, 4096
    v_bfe_u32 v4, v8, 1, 3
    v_add_u32 v5, 4, v9
    v_xor_b32 v4, v4, v5
    v_lshlrev_b32 v4, 4, v4
    v_lshl_add_u32 v4, v8, 7, v4
    v_add_u32 v12, s66, v4
    s_lshl_b32 s66, s62, 12
    s_add_u32 s66, s66, 4096
    v_bfe_u32 v4, v8, 1, 3
    v_add_u32 v5, 6, v9
    v_xor_b32 v4, v4, v5
    v_lshlrev_b32 v4, 4, v4
    v_lshl_add_u32 v4, v8, 7, v4
    v_add_u32 v13, s66, v4
    s_lshl_b32 s66, s63, 12
    s_add_u32 s66, s66, 4096
    v_bfe_u32 v4, v8, 1, 3
    v_add_u32 v5, 0, v9
    v_xor_b32 v4, v4, v5
    v_lshlrev_b32 v4, 4, v4
    v_lshl_add_u32 v4, v8, 7, v4
    v_add_u32 v14, s66, v4
    s_lshl_b32 s66, s63, 12
    s_add_u32 s66, s66, 4096
    v_bfe_u32 v4, v8, 1, 3
    v_add_u32 v5, 2, v9
    v_xor_b32 v4, v4, v5
    v_lshlrev_b32 v4, 4, v4
    v_lshl_add_u32 v4, v8, 7, v4
    v_add_u32 v15, s66, v4
    s_lshl_b32 s66, s63, 12
    s_add_u32 s66, s66, 4096
    v_bfe_u32 v4, v8, 1, 3
    v_add_u32 v5, 4, v9
    v_xor_b32 v4, v4, v5
    v_lshlrev_b32 v4, 4, v4
    v_lshl_add_u32 v4, v8, 7, v4
    v_add_u32 v16, s66, v4
    s_lshl_b32 s66, s63, 12
    s_add_u32 s66, s66, 4096
    v_bfe_u32 v4, v8, 1, 3
    v_add_u32 v5, 6, v9
    v_xor_b32 v4, v4, v5
    v_lshlrev_b32 v4, 4, v4
    v_lshl_add_u32 v4, v8, 7, v4
    v_add_u32 v17, s66, v4
    v_bfe_u32 v4, v1, 2, 2
    v_xor_b32 v5, s64, v4
    v_lshlrev_b32 v5, 2, v5
    v_bfe_u32 v6, v1, 4, 1
    v_lshl_add_u32 v5, v6, 1, v5
    v_bfe_u32 v6, v1, 1, 1
    v_add_u32 v5, v5, v6
    v_lshlrev_b32 v5, 4, v5
    v_and_b32 v6, 1, v1
    v_lshl_add_u32 v5, v6, 3, v5
    v_lshl_add_u32 v4, v9, 3, v4
    v_mul_u32_u24 v4, 256, v4
    v_add_u32 v4, v4, v5
    v_add_u32 v18, 75776, v4
    v_bfe_u32 v4, v1, 2, 2
    v_xor_b32 v5, s65, v4
    v_lshlrev_b32 v5, 2, v5
    v_bfe_u32 v6, v1, 4, 1
    v_lshl_add_u32 v5, v6, 1, v5
    v_bfe_u32 v6, v1, 1, 1
    v_add_u32 v5, v5, v6
    v_lshlrev_b32 v5, 4, v5
    v_and_b32 v6, 1, v1
    v_lshl_add_u32 v5, v6, 3, v5
    v_lshl_add_u32 v4, v9, 3, v4
    v_mul_u32_u24 v4, 256, v4
    v_add_u32 v4, v4, v5
    v_add_u32 v19, 75776, v4
    s_mov_b32 s68, 0x3f803f80
    v_mov_b32 v116, 0
    v_mov_b32 v117, 0
    v_mov_b32 v118, 0
    v_mov_b32 v119, 0
    v_mov_b32 v120, 0
    v_mov_b32 v121, 0
    s_mul_i32 s66, s52, 10
    s_add_u32 s66, s66, s60
    s_lshl_b32 s66, s66, 2
    s_add_u32 s66, s66, s62
    s_lshl_b32 s66, s66, 9
    s_add_u32 s66, s66, 0
    s_cmp_lt_u32 s53, 10
    s_cselect_b32 s67, 0, 1073741824
    s_add_u32 s66, s66, s67
    v_lshl_add_u32 v4, v8, 4, s66
    v_lshl_add_u32 v122, v9, 3, v4
    s_mul_i32 s66, s53, 10
    s_add_u32 s66, s66, s60
    s_lshl_b32 s66, s66, 2
    s_add_u32 s66, s66, s64
    s_lshl_b32 s66, s66, 8
    s_add_u32 s66, s66, 327680
    s_cmp_lt_u32 s52, 10
    s_cselect_b32 s67, 0, 1073741824
    s_add_u32 s66, s66, s67
    v_lshl_add_u32 v4, v8, 3, s66
    v_lshl_add_u32 v123, v9, 30, v4
    s_mul_i32 s66, s52, 20480
    s_add_u32 s66, s66, 0
    v_mov_b32 v4, s62
    v_xor_b32 v4, v4, v9
    v_lshl_add_u32 v4, v4, 5, v8
    v_lshl_add_u32 v124, v4, 4, s66
    s_mul_i32 s66, s53, 10240
    s_add_u32 s66, s66, 327680
    v_mov_b32 v4, s64
    v_xor_b32 v4, v4, v9
    v_lshl_add_u32 v4, v4, 5, v8
    v_lshl_add_u32 v125, v4, 3, s66
    v_mov_b32 v4, s62
    v_xor_b32 v4, v4, v9
    v_lshl_add_u32 v4, v4, 5, v8
    v_lshlrev_b32 v4, 4, v4
    v_add_u32 v126, 36864, v4
    v_add_u32 v127, 108544, v4
    v_mov_b32 v4, s64
    v_xor_b32 v4, v4, v9
    v_lshl_add_u32 v4, v4, 5, v8
    v_lshlrev_b32 v4, 3, v4
    v_add_u32 v128, 112640, v4
    s_mul_i32 s73, s24, 768
    s_waitcnt lgkmcnt(0)
    s_add_u32 s48, s22, 21168128
    s_addc_u32 s49, s23, 0
    s_and_b32 s49, s49, 0xffff
    s_mov_b32 s50, 33024
    s_mov_b32 s51, 0x20000
    v_mov_b32 v2, 32768
    buffer_load_dword v2, v2, s[48:51], 0 offen sc1
    s_mov_b32 s28, s22
    s_and_b32 s29, s23, 0xffff
    s_mov_b32 s30, 5242880
    s_mov_b32 s31, 0x20000
    s_add_u32 s32, s22, 5242880
    s_addc_u32 s33, s23, 0
    s_and_b32 s33, s33, 0xffff
    s_mov_b32 s34, 2621440
    s_mov_b32 s35, 0x20000
    s_add_u32 s36, s22, 20185088
    s_addc_u32 s37, s23, 0
    s_and_b32 s37, s37, 0xffff
    s_mov_b32 s38, 983040
    s_mov_b32 s39, 0x20000
    s_cmp_ge_u32 s53, 10
    s_cbranch_scc1 qkv_nt_2
    s_lshl_b32 s66, s62, 5
    s_add_u32 s66, s66, s59
    v_add_u32 v206, s66, v8
    v_lshlrev_b32 v206, 4, v206
    v_lshl_add_u32 v206, v9, 15, v206
    s_lshl_b32 s66, s63, 5
    s_add_u32 s66, s66, s59
    v_add_u32 v207, s66, v8
    v_lshlrev_b32 v207, 4, v207
    v_lshl_add_u32 v207, v9, 15, v207
    s_lshl_b32 s74, s53, 2
    s_add_u32 s74, s74, s64
    s_lshl_b32 s74, s74, 17
    s_add_u32 s75, s74, 65536
    s_lshl_b32 s76, s53, 2
    s_add_u32 s76, s76, s65
    s_lshl_b32 s76, s76, 17
    s_add_u32 s77, s76, 65536
    s_barrier
    ds_read_b128 v[20:23], v10 offset:0
    ds_read_b128 v[24:27], v14 offset:0
    ds_read_b64_tr_b16 v[36:37], v18 offset:0
    ds_read_b64_tr_b16 v[38:39], v18 offset:1024
    ds_read_b64_tr_b16 v[40:41], v19 offset:0
    ds_read_b64_tr_b16 v[42:43], v19 offset:1024
    s_waitcnt lgkmcnt(0)
    v_mfma_f32_32x32x16_bf16 v[52:67], v[36:39], v[20:23], 0
    ds_read_b128 v[28:31], v11 offset:0
    ds_read_b128 v[32:35], v15 offset:0
    ds_read_b64_tr_b16 v[44:45], v18 offset:4096
    v_mfma_f32_32x32x16_bf16 v[68:83], v[40:43], v[20:23], 0
    ds_read_b64_tr_b16 v[46:47], v18 offset:5120
    ds_read_b64_tr_b16 v[48:49], v19 offset:4096
    ds_read_b64_tr_b16 v[50:51], v19 offset:5120
    v_mfma_f32_32x32x16_bf16 v[84:99], v[36:39], v[24:27], 0
    v_mfma_f32_32x32x16_bf16 v[100:115], v[40:43], v[24:27], 0
    v_dot2c_f32_bf16 v116, s68, v20
    v_dot2c_f32_bf16 v118, v20, v20
    v_dot2c_f32_bf16 v120, s68, v36
    v_dot2c_f32_bf16 v117, s68, v21
    v_dot2c_f32_bf16 v119, v21, v21
    v_dot2c_f32_bf16 v121, s68, v37
    v_dot2c_f32_bf16 v116, s68, v22
    v_dot2c_f32_bf16 v118, v22, v22
    v_dot2c_f32_bf16 v120, s68, v38
    v_dot2c_f32_bf16 v117, s68, v23
    v_dot2c_f32_bf16 v119, v23, v23
    v_dot2c_f32_bf16 v121, s68, v39
    s_waitcnt lgkmcnt(0)
    v_mfma_f32_32x32x16_bf16 v[52:67], v[44:47], v[28:31], v[52:67]
    ds_read_b128 v[20:23], v12 offset:0
    ds_read_b128 v[24:27], v16 offset:0
    ds_read_b64_tr_b16 v[36:37], v18 offset:8192
    v_mfma_f32_32x32x16_bf16 v[68:83], v[48:51], v[28:31], v[68:83]
    ds_read_b64_tr_b16 v[38:39], v18 offset:9216
    ds_read_b64_tr_b16 v[40:41], v19 offset:8192
    ds_read_b64_tr_b16 v[42:43], v19 offset:9216
    v_mfma_f32_32x32x16_bf16 v[84:99], v[44:47], v[32:35], v[84:99]
    v_mfma_f32_32x32x16_bf16 v[100:115], v[48:51], v[32:35], v[100:115]
    v_dot2c_f32_bf16 v116, s68, v28
    v_dot2c_f32_bf16 v118, v28, v28
    v_dot2c_f32_bf16 v120, s68, v44
    v_dot2c_f32_bf16 v117, s68, v29
    v_dot2c_f32_bf16 v119, v29, v29
    v_dot2c_f32_bf16 v121, s68, v45
    v_dot2c_f32_bf16 v116, s68, v30
    v_dot2c_f32_bf16 v118, v30, v30
    v_dot2c_f32_bf16 v120, s68, v46
    v_dot2c_f32_bf16 v117, s68, v31
    v_dot2c_f32_bf16 v119, v31, v31
    v_dot2c_f32_bf16 v121, s68, v47
    s_waitcnt lgkmcnt(0)
    v_mfma_f32_32x32x16_bf16 v[52:67], v[36:39], v[20:23], v[52:67]
    ds_read_b128 v[28:31], v13 offset:0
    ds_read_b128 v[32:35], v17 offset:0
    ds_read_b64_tr_b16 v[44:45], v18 offset:12288
    v_mfma_f32_32x32x16_bf16 v[68:83], v[40:43], v[20:23], v[68:83]
    ds_read_b64_tr_b16 v[46:47], v18 offset:13312
    ds_read_b64_tr_b16 v[48:49], v19 offset:12288
    ds_read_b64_tr_b16 v[50:51], v19 offset:13312
    v_mfma_f32_32x32x16_bf16 v[84:99], v[36:39], v[24:27], v[84:99]
    v_mfma_f32_32x32x16_bf16 v[100:115], v[40:43], v[24:27], v[100:115]
    v_dot2c_f32_bf16 v116, s68, v20
    v_dot2c_f32_bf16 v118, v20, v20
    v_dot2c_f32_bf16 v120, s68, v36
    v_dot2c_f32_bf16 v117, s68, v21
    v_dot2c_f32_bf16 v119, v21, v21
    v_dot2c_f32_bf16 v121, s68, v37
    v_dot2c_f32_bf16 v116, s68, v22
    v_dot2c_f32_bf16 v118, v22, v22
    v_dot2c_f32_bf16 v120, s68, v38
    v_dot2c_f32_bf16 v117, s68, v23
    v_dot2c_f32_bf16 v119, v23, v23
    v_dot2c_f32_bf16 v121, s68, v39
    s_waitcnt lgkmcnt(0)
    s_barrier
    v_mfma_f32_32x32x16_bf16 v[52:67], v[44:47], v[28:31], v[52:67]
    ds_read_b128 v[20:23], v10 offset:16384
    ds_read_b128 v[24:27], v14 offset:16384
    ds_read_b64_tr_b16 v[36:37], v18 offset:16384
    v_mfma_f32_32x32x16_bf16 v[68:83], v[48:51], v[28:31], v[68:83]
    ds_read_b64_tr_b16 v[38:39], v18 offset:17408
    ds_read_b64_tr_b16 v[40:41], v19 offset:16384
    ds_read_b64_tr_b16 v[42:43], v19 offset:17408
    v_mfma_f32_32x32x16_bf16 v[84:99], v[44:47], v[32:35], v[84:99]
    v_mfma_f32_32x32x16_bf16 v[100:115], v[48:51], v[32:35], v[100:115]
    v_dot2c_f32_bf16 v116, s68, v28
    v_dot2c_f32_bf16 v118, v28, v28
    v_dot2c_f32_bf16 v120, s68, v44
    v_dot2c_f32_bf16 v117, s68, v29
    v_dot2c_f32_bf16 v119, v29, v29
    v_dot2c_f32_bf16 v121, s68, v45
    v_dot2c_f32_bf16 v116, s68, v30
    v_dot2c_f32_bf16 v118, v30, v30
    v_dot2c_f32_bf16 v120, s68, v46
    v_dot2c_f32_bf16 v117, s68, v31
    v_dot2c_f32_bf16 v119, v31, v31
    v_dot2c_f32_bf16 v121, s68, v47
    s_waitcnt lgkmcnt(0)
    v_mfma_f32_32x32x16_bf16 v[52:67], v[36:39], v[20:23], v[52:67]
    ds_read_b128 v[28:31], v11 offset:16384
    ds_read_b128 v[32:35], v15 offset:16384
    ds_read_b64_tr_b16 v[44:45], v18 offset:20480
    v_mfma_f32_32x32x16_bf16 v[68:83], v[40:43], v[20:23], v[68:83]
    ds_read_b64_tr_b16 v[46:47], v18 offset:21504
    ds_read_b64_tr_b16 v[48:49], v19 offset:20480
    ds_read_b64_tr_b16 v[50:51], v19 offset:21504
    v_mfma_f32_32x32x16_bf16 v[84:99], v[36:39], v[24:27], v[84:99]
    v_mfma_f32_32x32x16_bf16 v[100:115], v[40:43], v[24:27], v[100:115]
    s_waitcnt vmcnt(0)
    v_add_u32 v190, 1, v2
    v_add_f32 v116, v116, v117
    v_add_f32 v118, v118, v119
    v_add_f32 v120, v120, v121
    v_mov_b32 v4, v116
    v_mov_b32 v5, v118
    v_mov_b32 v6, v120
    s_nop 1
    v_permlane32_swap_b32 v4, v116
    v_permlane32_swap_b32 v5, v118
    v_permlane32_swap_b32 v6, v120
    v_cmp_eq_u32 vcc, 0, v9
    v_mov_b32 v195, v190
    v_mov_b32 v197, v190
    v_add_f32 v116, v116, v4
    v_add_f32 v118, v118, v5
    v_add_f32 v196, v120, v6
    v_cndmask_b32 v194, v118, v116, vcc
    buffer_store_dwordx2 v[196:197], v123, s[36:39], 0 offen sc1
    buffer_store_dwordx2 v[194:195], v122, s[36:39], 0 offen sc1
    s_waitcnt lgkmcnt(0)
    v_mfma_f32_32x32x16_bf16 v[52:67], v[44:47], v[28:31], v[52:67]
    ds_read_b128 v[20:23], v12 offset:16384
    ds_read_b128 v[24:27], v16 offset:16384
    ds_read_b64_tr_b16 v[36:37], v18 offset:24576
    v_mfma_f32_32x32x16_bf16 v[68:83], v[48:51], v[28:31], v[68:83]
    ds_read_b64_tr_b16 v[38:39], v18 offset:25600
    ds_read_b64_tr_b16 v[40:41], v19 offset:24576
    ds_read_b64_tr_b16 v[42:43], v19 offset:25600
    v_mfma_f32_32x32x16_bf16 v[84:99], v[44:47], v[32:35], v[84:99]
    v_mfma_f32_32x32x16_bf16 v[100:115], v[48:51], v[32:35], v[100:115]
    s_waitcnt lgkmcnt(0)
    v_mfma_f32_32x32x16_bf16 v[52:67], v[36:39], v[20:23], v[52:67]
    ds_read_b128 v[28:31], v13 offset:16384
    ds_read_b128 v[32:35], v17 offset:16384
    ds_read_b64_tr_b16 v[44:45], v18 offset:28672
    v_mfma_f32_32x32x16_bf16 v[68:83], v[40:43], v[20:23], v[68:83]
    ds_read_b64_tr_b16 v[46:47], v18 offset:29696
    ds_read_b64_tr_b16 v[48:49], v19 offset:28672
    ds_read_b64_tr_b16 v[50:51], v19 offset:29696
    v_mfma_f32_32x32x16_bf16 v[84:99], v[36:39], v[24:27], v[84:99]
    v_mfma_f32_32x32x16_bf16 v[100:115], v[40:43], v[24:27], v[100:115]
    s_waitcnt lgkmcnt(0)
    s_barrier
    v_mfma_f32_32x32x16_bf16 v[52:67], v[44:47], v[28:31], v[52:67]
    ds_read_b128 v[20:23], v10 offset:32768
    ds_read_b128 v[24:27], v14 offset:32768
    ds_read_b64_tr_b16 v[36:37], v18 offset:32768
    v_mfma_f32_32x32x16_bf16 v[68:83], v[48:51], v[28:31], v[68:83]
    ds_read_b64_tr_b16 v[38:39], v18 offset:33792
    ds_read_b64_tr_b16 v[40:41], v19 offset:32768
    ds_read_b64_tr_b16 v[42:43], v19 offset:33792
    v_mfma_f32_32x32x16_bf16 v[84:99], v[44:47], v[32:35], v[84:99]
    v_mfma_f32_32x32x16_bf16 v[100:115], v[48:51], v[32:35], v[100:115]
    s_waitcnt lgkmcnt(0)
    v_mfma_f32_32x32x16_bf16 v[52:67], v[36:39], v[20:23], v[52:67]
    ds_read_b128 v[28:31], v11 offset:32768
    ds_read_b128 v[32:35], v15 offset:32768
    ds_read_b64_tr_b16 v[44:45], v18 offset:36864
    v_mfma_f32_32x32x16_bf16 v[68:83], v[40:43], v[20:23], v[68:83]
    ds_read_b64_tr_b16 v[46:47], v18 offset:37888
    ds_read_b64_tr_b16 v[48:49], v19 offset:36864
    ds_read_b64_tr_b16 v[50:51], v19 offset:37888
    v_mfma_f32_32x32x16_bf16 v[84:99], v[36:39], v[24:27], v[84:99]
    v_mfma_f32_32x32x16_bf16 v[100:115], v[40:43], v[24:27], v[100:115]
    s_waitcnt lgkmcnt(0)
    v_mfma_f32_32x32x16_bf16 v[52:67], v[44:47], v[28:31], v[52:67]
    ds_read_b128 v[20:23], v12 offset:32768
    ds_read_b128 v[24:27], v16 offset:32768
    ds_read_b64_tr_b16 v[36:37], v18 offset:40960
    v_mfma_f32_32x32x16_bf16 v[68:83], v[48:51], v[28:31], v[68:83]
    ds_read_b64_tr_b16 v[38:39], v18 offset:41984
    ds_read_b64_tr_b16 v[40:41], v19 offset:40960
    ds_read_b64_tr_b16 v[42:43], v19 offset:41984
    v_mfma_f32_32x32x16_bf16 v[84:99], v[44:47], v[32:35], v[84:99]
    v_mfma_f32_32x32x16_bf16 v[100:115], v[48:51], v[32:35], v[100:115]
    s_waitcnt lgkmcnt(0)
    v_mfma_f32_32x32x16_bf16 v[52:67], v[36:39], v[20:23], v[52:67]
    ds_read_b128 v[28:31], v13 offset:32768
    ds_read_b128 v[32:35], v17 offset:32768
    ds_read_b64_tr_b16 v[44:45], v18 offset:45056
    v_mfma_f32_32x32x16_bf16 v[68:83], v[40:43], v[20:23], v[68:83]
    ds_read_b64_tr_b16 v[46:47], v18 offset:46080
    ds_read_b64_tr_b16 v[48:49], v19 offset:45056
    ds_read_b64_tr_b16 v[50:51], v19 offset:46080
    v_mfma_f32_32x32x16_bf16 v[84:99], v[36:39], v[24:27], v[84:99]
    v_mfma_f32_32x32x16_bf16 v[100:115], v[40:43], v[24:27], v[100:115]
    s_waitcnt lgkmcnt(0)
    s_barrier
    v_mfma_f32_32x32x16_bf16 v[52:67], v[44:47], v[28:31], v[52:67]
    ds_read_b128 v[20:23], v10 offset:49152
    ds_read_b128 v[24:27], v14 offset:49152
    ds_read_b64_tr_b16 v[36:37], v18 offset:49152
    v_mfma_f32_32x32x16_bf16 v[68:83], v[48:51], v[28:31], v[68:83]
    ds_read_b64_tr_b16 v[38:39], v18 offset:50176
    ds_read_b64_tr_b16 v[40:41], v19 offset:49152
    ds_read_b64_tr_b16 v[42:43], v19 offset:50176
    v_mfma_f32_32x32x16_bf16 v[84:99], v[44:47], v[32:35], v[84:99]
    v_mfma_f32_32x32x16_bf16 v[100:115], v[48:51], v[32:35], v[100:115]
    s_waitcnt lgkmcnt(0)
    v_mfma_f32_32x32x16_bf16 v[52:67], v[36:39], v[20:23], v[52:67]
    ds_read_b128 v[28:31], v11 offset:49152
    ds_read_b128 v[32:35], v15 offset:49152
    ds_read_b64_tr_b16 v[44:45], v18 offset:53248
    v_mfma_f32_32x32x16_bf16 v[68:83], v[40:43], v[20:23], v[68:83]
    ds_read_b64_tr_b16 v[46:47], v18 offset:54272
    ds_read_b64_tr_b16 v[48:49], v19 offset:53248
    ds_read_b64_tr_b16 v[50:51], v19 offset:54272
    v_mfma_f32_32x32x16_bf16 v[84:99], v[36:39], v[24:27], v[84:99]
    v_mfma_f32_32x32x16_bf16 v[100:115], v[40:43], v[24:27], v[100:115]
    s_waitcnt lgkmcnt(0)
    v_mfma_f32_32x32x16_bf16 v[52:67], v[44:47], v[28:31], v[52:67]
    ds_read_b128 v[20:23], v12 offset:49152
    ds_read_b128 v[24:27], v16 offset:49152
    ds_read_b64_tr_b16 v[36:37], v18 offset:57344
    v_mfma_f32_32x32x16_bf16 v[68:83], v[48:51], v[28:31], v[68:83]
    ds_read_b64_tr_b16 v[38:39], v18 offset:58368
    ds_read_b64_tr_b16 v[40:41], v19 offset:57344
    ds_read_b64_tr_b16 v[42:43], v19 offset:58368
    v_mfma_f32_32x32x16_bf16 v[84:99], v[44:47], v[32:35], v[84:99]
    v_mfma_f32_32x32x16_bf16 v[100:115], v[48:51], v[32:35], v[100:115]
    s_waitcnt lgkmcnt(0)
    v_mfma_f32_32x32x16_bf16 v[52:67], v[36:39], v[20:23], v[52:67]
    ds_read_b128 v[28:31], v13 offset:49152
    ds_read_b128 v[32:35], v17 offset:49152
    ds_read_b64_tr_b16 v[44:45], v18 offset:61440
    v_mfma_f32_32x32x16_bf16 v[68:83], v[40:43], v[20:23], v[68:83]
    ds_read_b64_tr_b16 v[46:47], v18 offset:62464
    ds_read_b64_tr_b16 v[48:49], v19 offset:61440
    ds_read_b64_tr_b16 v[50:51], v19 offset:62464
    v_mfma_f32_32x32x16_bf16 v[84:99], v[36:39], v[24:27], v[84:99]
    v_mfma_f32_32x32x16_bf16 v[100:115], v[40:43], v[24:27], v[100:115]
    s_waitcnt lgkmcnt(0)
    s_barrier
    v_mfma_f32_32x32x16_bf16 v[52:67], v[44:47], v[28:31], v[52:67]
    ds_read_b128 v[20:23], v10 offset:0
    ds_read_b128 v[24:27], v14 offset:0
    ds_read_b64_tr_b16 v[36:37], v18 offset:0
    v_mfma_f32_32x32x16_bf16 v[68:83], v[48:51], v[28:31], v[68:83]
    ds_read_b64_tr_b16 v[38:39], v18 offset:1024
    ds_read_b64_tr_b16 v[40:41], v19 offset:0
    ds_read_b64_tr_b16 v[42:43], v19 offset:1024
    v_mfma_f32_32x32x16_bf16 v[84:99], v[44:47], v[32:35], v[84:99]
    v_mfma_f32_32x32x16_bf16 v[100:115], v[48:51], v[32:35], v[100:115]
    s_waitcnt lgkmcnt(0)
    v_mfma_f32_32x32x16_bf16 v[52:67], v[36:39], v[20:23], v[52:67]
    ds_read_b128 v[28:31], v11 offset:0
    ds_read_b128 v[32:35], v15 offset:0
    ds_read_b64_tr_b16 v[44:45], v18 offset:4096
    v_mfma_f32_32x32x16_bf16 v[68:83], v[40:43], v[20:23], v[68:83]
    ds_read_b64_tr_b16 v[46:47], v18 offset:5120
    ds_read_b64_tr_b16 v[48:49], v19 offset:4096
    ds_read_b64_tr_b16 v[50:51], v19 offset:5120
    v_mfma_f32_32x32x16_bf16 v[84:99], v[36:39], v[24:27], v[84:99]
    v_mfma_f32_32x32x16_bf16 v[100:115], v[40:43], v[24:27], v[100:115]
    s_waitcnt lgkmcnt(0)
    v_mfma_f32_32x32x16_bf16 v[52:67], v[44:47], v[28:31], v[52:67]
    ds_read_b128 v[20:23], v12 offset:0
    ds_read_b128 v[24:27], v16 offset:0
    ds_read_b64_tr_b16 v[36:37], v18 offset:8192
    v_mfma_f32_32x32x16_bf16 v[68:83], v[48:51], v[28:31], v[68:83]
    ds_read_b64_tr_b16 v[38:39], v18 offset:9216
    ds_read_b64_tr_b16 v[40:41], v19 offset:8192
    ds_read_b64_tr_b16 v[42:43], v19 offset:9216
    v_mfma_f32_32x32x16_bf16 v[84:99], v[44:47], v[32:35], v[84:99]
    v_mfma_f32_32x32x16_bf16 v[100:115], v[48:51], v[32:35], v[100:115]
    s_waitcnt lgkmcnt(0)
    v_mfma_f32_32x32x16_bf16 v[52:67], v[36:39], v[20:23], v[52:67]
    ds_read_b128 v[28:31], v13 offset:0
    ds_read_b128 v[32:35], v17 offset:0
    ds_read_b64_tr_b16 v[44:45], v18 offset:12288
    v_mfma_f32_32x32x16_bf16 v[68:83], v[40:43], v[20:23], v[68:83]
    ds_read_b64_tr_b16 v[46:47], v18 offset:13312
    ds_read_b64_tr_b16 v[48:49], v19 offset:12288
    ds_read_b64_tr_b16 v[50:51], v19 offset:13312
    v_mfma_f32_32x32x16_bf16 v[84:99], v[36:39], v[24:27], v[84:99]
    v_mfma_f32_32x32x16_bf16 v[100:115], v[40:43], v[24:27], v[100:115]
    s_waitcnt lgkmcnt(0)
    s_barrier
    v_mfma_f32_32x32x16_bf16 v[52:67], v[44:47], v[28:31], v[52:67]
    ds_read_b128 v[20:23], v10 offset:16384
    ds_read_b128 v[24:27], v14 offset:16384
    ds_read_b64_tr_b16 v[36:37], v18 offset:16384
    v_mfma_f32_32x32x16_bf16 v[68:83], v[48:51], v[28:31], v[68:83]
    ds_read_b64_tr_b16 v[38:39], v18 offset:17408
    ds_read_b64_tr_b16 v[40:41], v19 offset:16384
    ds_read_b64_tr_b16 v[42:43], v19 offset:17408
    v_mfma_f32_32x32x16_bf16 v[84:99], v[44:47], v[32:35], v[84:99]
    v_mfma_f32_32x32x16_bf16 v[100:115], v[48:51], v[32:35], v[100:115]
    s_waitcnt lgkmcnt(0)
    v_mfma_f32_32x32x16_bf16 v[52:67], v[36:39], v[20:23], v[52:67]
    ds_read_b128 v[28:31], v11 offset:16384
    ds_read_b128 v[32:35], v15 offset:16384
    ds_read_b64_tr_b16 v[44:45], v18 offset:20480
    v_mfma_f32_32x32x16_bf16 v[68:83], v[40:43], v[20:23], v[68:83]
    ds_read_b64_tr_b16 v[46:47], v18 offset:21504
    ds_read_b64_tr_b16 v[48:49], v19 offset:20480
    ds_read_b64_tr_b16 v[50:51], v19 offset:21504
    v_mfma_f32_32x32x16_bf16 v[84:99], v[36:39], v[24:27], v[84:99]
    v_mfma_f32_32x32x16_bf16 v[100:115], v[40:43], v[24:27], v[100:115]
    s_waitcnt lgkmcnt(0)
    v_mfma_f32_32x32x16_bf16 v[52:67], v[44:47], v[28:31], v[52:67]
    ds_read_b128 v[20:23], v12 offset:16384
    ds_read_b128 v[24:27], v16 offset:16384
    ds_read_b64_tr_b16 v[36:37], v18 offset:24576
    v_mfma_f32_32x32x16_bf16 v[68:83], v[48:51], v[28:31], v[68:83]
    ds_read_b64_tr_b16 v[38:39], v18 offset:25600
    ds_read_b64_tr_b16 v[40:41], v19 offset:24576
    ds_read_b64_tr_b16 v[42:43], v19 offset:25600
    v_mfma_f32_32x32x16_bf16 v[84:99], v[44:47], v[32:35], v[84:99]
    v_mfma_f32_32x32x16_bf16 v[100:115], v[48:51], v[32:35], v[100:115]
    s_waitcnt lgkmcnt(0)
    v_mfma_f32_32x32x16_bf16 v[52:67], v[36:39], v[20:23], v[52:67]
    ds_read_b128 v[28:31], v13 offset:16384
    ds_read_b128 v[32:35], v17 offset:16384
    ds_read_b64_tr_b16 v[44:45], v18 offset:28672
    v_mfma_f32_32x32x16_bf16 v[68:83], v[40:43], v[20:23], v[68:83]
    ds_read_b64_tr_b16 v[46:47], v18 offset:29696
    ds_read_b64_tr_b16 v[48:49], v19 offset:28672
    ds_read_b64_tr_b16 v[50:51], v19 offset:29696
    v_mfma_f32_32x32x16_bf16 v[84:99], v[36:39], v[24:27], v[84:99]
    v_mfma_f32_32x32x16_bf16 v[100:115], v[40:43], v[24:27], v[100:115]
    s_waitcnt lgkmcnt(0)
    s_barrier
    v_mfma_f32_32x32x16_bf16 v[52:67], v[44:47], v[28:31], v[52:67]
    ds_read_b128 v[20:23], v10 offset:32768
    ds_read_b128 v[24:27], v14 offset:32768
    ds_read_b64_tr_b16 v[36:37], v18 offset:32768
    v_mfma_f32_32x32x16_bf16 v[68:83], v[48:51], v[28:31], v[68:83]
    ds_read_b64_tr_b16 v[38:39], v18 offset:33792
    ds_read_b64_tr_b16 v[40:41], v19 offset:32768
    ds_read_b64_tr_b16 v[42:43], v19 offset:33792
    v_mfma_f32_32x32x16_bf16 v[84:99], v[44:47], v[32:35], v[84:99]
    v_mfma_f32_32x32x16_bf16 v[100:115], v[48:51], v[32:35], v[100:115]
    s_waitcnt lgkmcnt(0)
    v_mfma_f32_32x32x16_bf16 v[52:67], v[36:39], v[20:23], v[52:67]
    ds_read_b128 v[28:31], v11 offset:32768
    ds_read_b128 v[32:35], v15 offset:32768
    ds_read_b64_tr_b16 v[44:45], v18 offset:36864
    v_mfma_f32_32x32x16_bf16 v[68:83], v[40:43], v[20:23], v[68:83]
    ds_read_b64_tr_b16 v[46:47], v18 offset:37888
    ds_read_b64_tr_b16 v[48:49], v19 offset:36864
    ds_read_b64_tr_b16 v[50:51], v19 offset:37888
    v_mfma_f32_32x32x16_bf16 v[84:99], v[36:39], v[24:27], v[84:99]
    v_mfma_f32_32x32x16_bf16 v[100:115], v[40:43], v[24:27], v[100:115]
    s_waitcnt lgkmcnt(0)
    v_mfma_f32_32x32x16_bf16 v[52:67], v[44:47], v[28:31], v[52:67]
    ds_read_b128 v[20:23], v12 offset:32768
    ds_read_b128 v[24:27], v16 offset:32768
    ds_read_b64_tr_b16 v[36:37], v18 offset:40960
    v_mfma_f32_32x32x16_bf16 v[68:83], v[48:51], v[28:31], v[68:83]
    ds_read_b64_tr_b16 v[38:39], v18 offset:41984
    ds_read_b64_tr_b16 v[40:41], v19 offset:40960
    ds_read_b64_tr_b16 v[42:43], v19 offset:41984
    v_mfma_f32_32x32x16_bf16 v[84:99], v[44:47], v[32:35], v[84:99]
    v_mfma_f32_32x32x16_bf16 v[100:115], v[48:51], v[32:35], v[100:115]
    s_waitcnt lgkmcnt(0)
    v_mfma_f32_32x32x16_bf16 v[52:67], v[36:39], v[20:23], v[52:67]
    ds_read_b128 v[28:31], v13 offset:32768
    ds_read_b128 v[32:35], v17 offset:32768
    ds_read_b64_tr_b16 v[44:45], v18 offset:45056
    v_mfma_f32_32x32x16_bf16 v[68:83], v[40:43], v[20:23], v[68:83]
    ds_read_b64_tr_b16 v[46:47], v18 offset:46080
    ds_read_b64_tr_b16 v[48:49], v19 offset:45056
    ds_read_b64_tr_b16 v[50:51], v19 offset:46080
    v_mfma_f32_32x32x16_bf16 v[84:99], v[36:39], v[24:27], v[84:99]
    v_mfma_f32_32x32x16_bf16 v[100:115], v[40:43], v[24:27], v[100:115]
    s_waitcnt lgkmcnt(0)
    s_barrier
    v_mfma_f32_32x32x16_bf16 v[52:67], v[44:47], v[28:31], v[52:67]
    ds_read_b128 v[20:23], v10 offset:49152
    ds_read_b128 v[24:27], v14 offset:49152
    ds_read_b64_tr_b16 v[36:37], v18 offset:49152
    v_mfma_f32_32x32x16_bf16 v[68:83], v[48:51], v[28:31], v[68:83]
    ds_read_b64_tr_b16 v[38:39], v18 offset:50176
    ds_read_b64_tr_b16 v[40:41], v19 offset:49152
    ds_read_b64_tr_b16 v[42:43], v19 offset:50176
    v_mfma_f32_32x32x16_bf16 v[84:99], v[44:47], v[32:35], v[84:99]
    v_mfma_f32_32x32x16_bf16 v[100:115], v[48:51], v[32:35], v[100:115]
    s_waitcnt lgkmcnt(0)
    v_mfma_f32_32x32x16_bf16 v[52:67], v[36:39], v[20:23], v[52:67]
    ds_read_b128 v[28:31], v11 offset:49152
    ds_read_b128 v[32:35], v15 offset:49152
    ds_read_b64_tr_b16 v[44:45], v18 offset:53248
    v_mfma_f32_32x32x16_bf16 v[68:83], v[40:43], v[20:23], v[68:83]
    ds_read_b64_tr_b16 v[46:47], v18 offset:54272
    ds_read_b64_tr_b16 v[48:49], v19 offset:53248
    ds_read_b64_tr_b16 v[50:51], v19 offset:54272
    v_mfma_f32_32x32x16_bf16 v[84:99], v[36:39], v[24:27], v[84:99]
    v_mfma_f32_32x32x16_bf16 v[100:115], v[40:43], v[24:27], v[100:115]
    s_waitcnt lgkmcnt(0)
    v_mfma_f32_32x32x16_bf16 v[52:67], v[44:47], v[28:31], v[52:67]
    ds_read_b128 v[20:23], v12 offset:49152
    ds_read_b128 v[24:27], v16 offset:49152
    ds_read_b64_tr_b16 v[36:37], v18 offset:57344
    v_mfma_f32_32x32x16_bf16 v[68:83], v[48:51], v[28:31], v[68:83]
    ds_read_b64_tr_b16 v[38:39], v18 offset:58368
    ds_read_b64_tr_b16 v[40:41], v19 offset:57344
    ds_read_b64_tr_b16 v[42:43], v19 offset:58368
    v_mfma_f32_32x32x16_bf16 v[84:99], v[44:47], v[32:35], v[84:99]
    v_mfma_f32_32x32x16_bf16 v[100:115], v[48:51], v[32:35], v[100:115]
    s_waitcnt lgkmcnt(0)
    v_mfma_f32_32x32x16_bf16 v[52:67], v[36:39], v[20:23], v[52:67]
    ds_read_b128 v[28:31], v13 offset:49152
    ds_read_b128 v[32:35], v17 offset:49152
    ds_read_b64_tr_b16 v[44:45], v18 offset:61440
    v_mfma_f32_32x32x16_bf16 v[68:83], v[40:43], v[20:23], v[68:83]
    ds_read_b64_tr_b16 v[46:47], v18 offset:62464
    ds_read_b64_tr_b16 v[48:49], v19 offset:61440
    ds_read_b64_tr_b16 v[50:51], v19 offset:62464
    v_mfma_f32_32x32x16_bf16 v[84:99], v[36:39], v[24:27], v[84:99]
    v_mfma_f32_32x32x16_bf16 v[100:115], v[40:43], v[24:27], v[100:115]
    s_waitcnt lgkmcnt(0)
    s_barrier
    v_mfma_f32_32x32x16_bf16 v[52:67], v[44:47], v[28:31], v[52:67]
    ds_read_b128 v[20:23], v10 offset:0
    ds_read_b128 v[24:27], v14 offset:0
    ds_read_b64_tr_b16 v[36:37], v18 offset:0
    v_mfma_f32_32x32x16_bf16 v[68:83], v[48:51], v[28:31], v[68:83]
    ds_read_b64_tr_b16 v[38:39], v18 offset:1024
    ds_read_b64_tr_b16 v[40:41], v19 offset:0
    ds_read_b64_tr_b16 v[42:43], v19 offset:1024
    v_mfma_f32_32x32x16_bf16 v[84:99], v[44:47], v[32:35], v[84:99]
    v_mfma_f32_32x32x16_bf16 v[100:115], v[48:51], v[32:35], v[100:115]
    s_waitcnt lgkmcnt(0)
    v_mfma_f32_32x32x16_bf16 v[52:67], v[36:39], v[20:23], v[52:67]
    ds_read_b128 v[28:31], v11 offset:0
    ds_read_b128 v[32:35], v15 offset:0
    ds_read_b64_tr_b16 v[44:45], v18 offset:4096
    v_mfma_f32_32x32x16_bf16 v[68:83], v[40:43], v[20:23], v[68:83]
    ds_read_b64_tr_b16 v[46:47], v18 offset:5120
    ds_read_b64_tr_b16 v[48:49], v19 offset:4096
    ds_read_b64_tr_b16 v[50:51], v19 offset:5120
    v_mfma_f32_32x32x16_bf16 v[84:99], v[36:39], v[24:27], v[84:99]
    v_mfma_f32_32x32x16_bf16 v[100:115], v[40:43], v[24:27], v[100:115]
    s_waitcnt lgkmcnt(0)
    v_mfma_f32_32x32x16_bf16 v[52:67], v[44:47], v[28:31], v[52:67]
    ds_read_b128 v[20:23], v12 offset:0
    ds_read_b128 v[24:27], v16 offset:0
    ds_read_b64_tr_b16 v[36:37], v18 offset:8192
    v_mfma_f32_32x32x16_bf16 v[68:83], v[48:51], v[28:31], v[68:83]
    ds_read_b64_tr_b16 v[38:39], v18 offset:9216
    ds_read_b64_tr_b16 v[40:41], v19 offset:8192
    ds_read_b64_tr_b16 v[42:43], v19 offset:9216
    v_mfma_f32_32x32x16_bf16 v[84:99], v[44:47], v[32:35], v[84:99]
    v_mfma_f32_32x32x16_bf16 v[100:115], v[48:51], v[32:35], v[100:115]
    s_waitcnt lgkmcnt(0)
    v_mfma_f32_32x32x16_bf16 v[52:67], v[36:39], v[20:23], v[52:67]
    ds_read_b128 v[28:31], v13 offset:0
    ds_read_b128 v[32:35], v17 offset:0
    ds_read_b64_tr_b16 v[44:45], v18 offset:12288
    v_mfma_f32_32x32x16_bf16 v[68:83], v[40:43], v[20:23], v[68:83]
    ds_read_b64_tr_b16 v[46:47], v18 offset:13312
    ds_read_b64_tr_b16 v[48:49], v19 offset:12288
    ds_read_b64_tr_b16 v[50:51], v19 offset:13312
    v_mfma_f32_32x32x16_bf16 v[84:99], v[36:39], v[24:27], v[84:99]
    v_mfma_f32_32x32x16_bf16 v[100:115], v[40:43], v[24:27], v[100:115]
    s_waitcnt lgkmcnt(0)
    s_barrier
    v_mfma_f32_32x32x16_bf16 v[52:67], v[44:47], v[28:31], v[52:67]
    ds_read_b128 v[20:23], v10 offset:16384
    ds_read_b128 v[24:27], v14 offset:16384
    ds_read_b64_tr_b16 v[36:37], v18 offset:16384
    ds_read_b128 v[130:133], v126 offset:0
    ds_read_b128 v[134:137], v126 offset:2048
    v_mfma_f32_32x32x16_bf16 v[68:83], v[48:51], v[28:31], v[68:83]
    ds_read_b64_tr_b16 v[38:39], v18 offset:17408
    ds_read_b64_tr_b16 v[40:41], v19 offset:16384
    ds_read_b64_tr_b16 v[42:43], v19 offset:17408
    ds_read_b128 v[138:141], v126 offset:4096
    ds_read_b128 v[142:145], v126 offset:6144
    v_mfma_f32_32x32x16_bf16 v[84:99], v[44:47], v[32:35], v[84:99]
    ds_read_b128 v[146:149], v126 offset:8192
    ds_read_b128 v[150:153], v126 offset:10240
    ds_read_b128 v[154:157], v126 offset:12288
    ds_read_b128 v[158:161], v126 offset:14336
    v_mfma_f32_32x32x16_bf16 v[100:115], v[48:51], v[32:35], v[100:115]
    ds_read_b128 v[162:165], v127 offset:0
    ds_read_b128 v[166:169], v127 offset:2048
    s_waitcnt lgkmcnt(0)
    v_mfma_f32_32x32x16_bf16 v[52:67], v[36:39], v[20:23], v[52:67]
    ds_read_b128 v[28:31], v11 offset:16384
    ds_read_b128 v[32:35], v15 offset:16384
    ds_read_b64_tr_b16 v[44:45], v18 offset:20480
    ds_read_b64 v[170:171], v128 offset:0
    ds_read_b64 v[172:173], v128 offset:1024
    v_mfma_f32_32x32x16_bf16 v[68:83], v[40:43], v[20:23], v[68:83]
    ds_read_b64_tr_b16 v[46:47], v18 offset:21504
    ds_read_b64_tr_b16 v[48:49], v19 offset:20480
    ds_read_b64_tr_b16 v[50:51], v19 offset:21504
    ds_read_b64 v[174:175], v128 offset:2048
    ds_read_b64 v[176:177], v128 offset:3072
    v_mfma_f32_32x32x16_bf16 v[84:99], v[36:39], v[24:27], v[84:99]
    ds_read_b64 v[178:179], v128 offset:4096
    ds_read_b64 v[180:181], v128 offset:5120
    ds_read_b64 v[182:183], v128 offset:6144
    ds_read_b64 v[184:185], v128 offset:7168
    v_mfma_f32_32x32x16_bf16 v[100:115], v[40:43], v[24:27], v[100:115]
    ds_read_b64 v[186:187], v128 offset:8192
    ds_read_b64 v[188:189], v128 offset:9216
    s_waitcnt lgkmcnt(0)
    v_mfma_f32_32x32x16_bf16 v[52:67], v[44:47], v[28:31], v[52:67]
    ds_read_b128 v[20:23], v12 offset:16384
    ds_read_b128 v[24:27], v16 offset:16384
    ds_read_b64_tr_b16 v[36:37], v18 offset:24576
    v_min_u32 v191, v131, v135
    v_max_u32 v192, v131, v135
    v_add_f32 v130, v130, v134
    v_mfma_f32_32x32x16_bf16 v[68:83], v[48:51], v[28:31], v[68:83]
    ds_read_b64_tr_b16 v[38:39], v18 offset:25600
    ds_read_b64_tr_b16 v[40:41], v19 offset:24576
    ds_read_b64_tr_b16 v[42:43], v19 offset:25600
    v_min3_u32 v191, v139, v143, v191
    v_add_f32 v132, v132, v136
    v_max3_u32 v192, v139, v143, v192
    v_mfma_f32_32x32x16_bf16 v[84:99], v[44:47], v[32:35], v[84:99]
    v_add_f32 v170, v170, v172
    v_min3_u32 v191, v147, v151, v191
    v_add_f32 v130, v130, v138
    v_max3_u32 v192, v147, v151, v192
    v_add_f32 v132, v132, v140
    v_min3_u32 v191, v155, v159, v191
    v_add_f32 v170, v170, v174
    v_max3_u32 v192, v155, v159, v192
    v_add_f32 v130, v130, v142
    v_mfma_f32_32x32x16_bf16 v[100:115], v[48:51], v[32:35], v[100:115]
    v_min3_u32 v191, v163, v167, v191
    v_add_f32 v132, v132, v144
    v_max3_u32 v192, v163, v167, v192
    v_add_f32 v170, v170, v176
    v_min3_u32 v191, v133, v137, v191
    v_add_f32 v130, v130, v146
    v_max3_u32 v192, v133, v137, v192
    v_add_f32 v132, v132, v148
    s_waitcnt lgkmcnt(0)
    v_mfma_f32_32x32x16_bf16 v[52:67], v[36:39], v[20:23], v[52:67]
    ds_read_b128 v[28:31], v13 offset:16384
    ds_read_b128 v[32:35], v17 offset:16384
    ds_read_b64_tr_b16 v[44:45], v18 offset:28672
    v_min3_u32 v191, v141, v145, v191
    v_add_f32 v170, v170, v178
    v_max3_u32 v192, v141, v145, v192
    v_mfma_f32_32x32x16_bf16 v[68:83], v[40:43], v[20:23], v[68:83]
    ds_read_b64_tr_b16 v[46:47], v18 offset:29696
    ds_read_b64_tr_b16 v[48:49], v19 offset:28672
    ds_read_b64_tr_b16 v[50:51], v19 offset:29696
    v_add_f32 v130, v130, v150
    v_min3_u32 v191, v149, v153, v191
    v_add_f32 v132, v132, v152
    v_mfma_f32_32x32x16_bf16 v[84:99], v[36:39], v[24:27], v[84:99]
    v_max3_u32 v192, v149, v153, v192
    v_add_f32 v170, v170, v180
    v_min3_u32 v191, v157, v161, v191
    v_add_f32 v130, v130, v154
    v_max3_u32 v192, v157, v161, v192
    v_add_f32 v132, v132, v156
    v_min3_u32 v191, v165, v169, v191
    v_add_f32 v170, v170, v182
    v_max3_u32 v192, v165, v169, v192
    v_mfma_f32_32x32x16_bf16 v[100:115], v[40:43], v[24:27], v[100:115]
    v_add_f32 v130, v130, v158
    v_min3_u32 v191, v171, v173, v191
    v_add_f32 v132, v132, v160
    v_max3_u32 v192, v171, v173, v192
    v_add_f32 v170, v170, v184
    v_min3_u32 v191, v175, v177, v191
    v_add_f32 v130, v130, v162
    v_max3_u32 v192, v175, v177, v192
    s_waitcnt lgkmcnt(0)
    s_barrier
    v_mfma_f32_32x32x16_bf16 v[52:67], v[44:47], v[28:31], v[52:67]
    v_add_f32 v132, v132, v164
    v_min3_u32 v191, v179, v181, v191
    v_add_f32 v170, v170, v186
    v_mfma_f32_32x32x16_bf16 v[68:83], v[48:51], v[28:31], v[68:83]
    v_max3_u32 v192, v179, v181, v192
    v_add_f32 v130, v130, v166
    v_min3_u32 v191, v183, v185, v191
    v_mfma_f32_32x32x16_bf16 v[84:99], v[44:47], v[32:35], v[84:99]
    v_add_f32 v132, v132, v168
    v_max3_u32 v192, v183, v185, v192
    v_add_f32 v170, v170, v188
    v_min3_u32 v191, v187, v189, v191
    v_max3_u32 v192, v187, v189, v192
    v_mul_f32 v130, 0x3acccccd, v130
    v_mul_f32 v132, 0x3acccccd, v132
    v_fma_f32 v132, -v130, v130, v132
    v_max_f32 v132, 0, v132
    v_mfma_f32_32x32x16_bf16 v[100:115], v[48:51], v[32:35], v[100:115]
    v_add_f32 v132, 0x3727c5ac, v132
    v_rsq_f32 v132, v132
    v_xor_b32 v191, v191, v190
    v_xor_b32 v192, v192, v190
    v_mul_f32 v130, v130, v132
    v_or_b32 v191, v191, v192
    v_sub_f32 v130, 0, v130
    v_cmp_ne_u32 vcc, 0, v191
    s_cmp_eq_u64 vcc, 0
    s_cbranch_scc1 st_ok_4
    s_mov_b32 s70, 50000
st_retry_5:
    s_mov_b32 s69, 0
    buffer_load_dwordx4 v[130:133], v124, s[36:39], s69 offen sc1
    s_mov_b32 s69, 0
    buffer_load_dwordx2 v[170:171], v125, s[36:39], s69 offen sc1
    s_mov_b32 s69, 2048
    buffer_load_dwordx4 v[134:137], v124, s[36:39], s69 offen sc1
    s_mov_b32 s69, 1024
    buffer_load_dwordx2 v[172:173], v125, s[36:39], s69 offen sc1
    s_mov_b32 s69, 4096
    buffer_load_dwordx4 v[138:141], v124, s[36:39], s69 offen sc1
    s_mov_b32 s69, 2048
    buffer_load_dwordx2 v[174:175], v125, s[36:39], s69 offen sc1
    s_mov_b32 s69, 6144
    buffer_load_dwordx4 v[142:145], v124, s[36:39], s69 offen sc1
    s_mov_b32 s69, 3072
    buffer_load_dwordx2 v[176:177], v125, s[36:39], s69 offen sc1
    s_mov_b32 s69, 8192
    buffer_load_dwordx4 v[146:149], v124, s[36:39], s69 offen sc1
    s_mov_b32 s69, 4096
    buffer_load_dwordx2 v[178:179], v125, s[36:39], s69 offen sc1
    s_mov_b32 s69, 10240
    buffer_load_dwordx4 v[150:153], v124, s[36:39], s69 offen sc1
    s_mov_b32 s69, 5120
    buffer_load_dwordx2 v[180:181], v125, s[36:39], s69 offen sc1
    s_mov_b32 s69, 12288
    buffer_load_dwordx4 v[154:157], v124, s[36:39], s69 offen sc1
    s_mov_b32 s69, 6144
    buffer_load_dwordx2 v[182:183], v125, s[36:39], s69 offen sc1
    s_mov_b32 s69, 14336
    buffer_load_dwordx4 v[158:161], v124, s[36:39], s69 offen sc1
    s_mov_b32 s69, 7168
    buffer_load_dwordx2 v[184:185], v125, s[36:39], s69 offen sc1
    s_mov_b32 s69, 16384
    buffer_load_dwordx4 v[162:165], v124, s[36:39], s69 offen sc1
    s_mov_b32 s69, 8192
    buffer_load_dwordx2 v[186:187], v125, s[36:39], s69 offen sc1
    s_mov_b32 s69, 18432
    buffer_load_dwordx4 v[166:169], v124, s[36:39], s69 offen sc1
    s_mov_b32 s69, 9216
    buffer_load_dwordx2 v[188:189], v125, s[36:39], s69 offen sc1
    s_waitcnt vmcnt(0)
    v_min_u32 v191, v131, v135
    v_max_u32 v192, v131, v135
    v_add_f32 v130, v130, v134
    v_min3_u32 v191, v139, v143, v191
    v_add_f32 v132, v132, v136
    v_max3_u32 v192, v139, v143, v192
    v_add_f32 v170, v170, v172
    v_min3_u32 v191, v147, v151, v191
    v_add_f32 v130, v130, v138
    v_max3_u32 v192, v147, v151, v192
    v_add_f32 v132, v132, v140
    v_min3_u32 v191, v155, v159, v191
    v_add_f32 v170, v170, v174
    v_max3_u32 v192, v155, v159, v192
    v_add_f32 v130, v130, v142
    v_min3_u32 v191, v163, v167, v191
    v_add_f32 v132, v132, v144
    v_max3_u32 v192, v163, v167, v192
    v_add_f32 v170, v170, v176
    v_min3_u32 v191, v133, v137, v191
    v_add_f32 v130, v130, v146
    v_max3_u32 v192, v133, v137, v192
    v_add_f32 v132, v132, v148
    v_min3_u32 v191, v141, v145, v191
    v_add_f32 v170, v170, v178
    v_max3_u32 v192, v141, v145, v192
    v_add_f32 v130, v130, v150
    v_min3_u32 v191, v149, v153, v191
    v_add_f32 v132, v132, v152
    v_max3_u32 v192, v149, v153, v192
    v_add_f32 v170, v170, v180
    v_min3_u32 v191, v157, v161, v191
    v_add_f32 v130, v130, v154
    v_max3_u32 v192, v157, v161, v192
    v_add_f32 v132, v132, v156
    v_min3_u32 v191, v165, v169, v191
    v_add_f32 v170, v170, v182
    v_max3_u32 v192, v165, v169, v192
    v_add_f32 v130, v130, v158
    v_min3_u32 v191, v171, v173, v191
    v_add_f32 v132, v132, v160
    v_max3_u32 v192, v171, v173, v192
    v_add_f32 v170, v170, v184
    v_min3_u32 v191, v175, v177, v191
    v_add_f32 v130, v130, v162
    v_max3_u32 v192, v175, v177, v192
    v_add_f32 v132, v132, v164
    v_min3_u32 v191, v179, v181, v191
    v_add_f32 v170, v170, v186
    v_max3_u32 v192, v179, v181, v192
    v_add_f32 v130, v130, v166
    v_min3_u32 v191, v183, v185, v191
    v_add_f32 v132, v132, v168
    v_max3_u32 v192, v183, v185, v192
    v_add_f32 v170, v170, v188
    v_min3_u32 v191, v187, v189, v191
    v_max3_u32 v192, v187, v189, v192
    v_mul_f32 v130, 0x3acccccd, v130
    v_mul_f32 v132, 0x3acccccd, v132
    v_fma_f32 v132, -v130, v130, v132
    v_max_f32 v132, 0, v132
    v_add_f32 v132, 0x3727c5ac, v132
    v_rsq_f32 v132, v132
    s_nop 0
    v_xor_b32 v191, v191, v190
    v_xor_b32 v192, v192, v190
    v_mul_f32 v130, v130, v132
    v_or_b32 v191, v191, v192
    v_sub_f32 v130, 0, v130
    v_cmp_ne_u32 vcc, 0, v191
    s_cmp_eq_u64 vcc, 0
    s_cbranch_scc1 st_ok_4
    s_sub_u32 s70, s70, 1
    s_cmp_lg_u32 s70, 0
    s_cbranch_scc1 st_retry_5
st_ok_4:
    s_cmp_lt_u32 s53, 5
    s_cselect_b32 s66, 0x3ea52b5c, 1.0
    v_mul_f32 v130, s66, v130
    v_mul_f32 v132, s66, v132
    v_mov_b32 v198, v132
    v_mov_b32 v200, v132
    s_nop 1
    v_permlane32_swap_b32 v198, v200
    v_mov_b32 v202, v130
    v_mov_b32 v204, v130
    s_nop 1
    v_permlane32_swap_b32 v202, v204
    v_lshl_add_u32 v208, v1, 2, s73
    ds_write_b32 v208, v170
    v_lshl_add_u32 v208, v9, 4, s73
    s_waitcnt lgkmcnt(0)
    ds_read_b128 v[134:137], v208 offset:0
    ds_read_b128 v[138:141], v208 offset:32
    ds_read_b128 v[142:145], v208 offset:64
    ds_read_b128 v[146:149], v208 offset:96
    ds_read_b128 v[150:153], v208 offset:128
    ds_read_b128 v[154:157], v208 offset:160
    ds_read_b128 v[158:161], v208 offset:192
    ds_read_b128 v[162:165], v208 offset:224
    s_waitcnt lgkmcnt(4)
    v_pk_mul_f32 v[172:173], v[134:135], v[202:203] op_sel_hi:[1,0]
    v_pk_mul_f32 v[174:175], v[136:137], v[202:203] op_sel_hi:[1,0]
    v_pk_mul_f32 v[176:177], v[138:139], v[202:203] op_sel_hi:[1,0]
    v_pk_fma_f32 v[52:53], v[52:53], v[198:199], v[172:173] op_sel_hi:[1,0,1]
    v_pk_mul_f32 v[178:179], v[140:141], v[202:203] op_sel_hi:[1,0]
    v_pk_fma_f32 v[54:55], v[54:55], v[198:199], v[174:175] op_sel_hi:[1,0,1]
    v_pk_mul_f32 v[172:173], v[142:143], v[202:203] op_sel_hi:[1,0]
    v_pk_fma_f32 v[56:57], v[56:57], v[198:199], v[176:177] op_sel_hi:[1,0,1]
    v_pk_mul_f32 v[174:175], v[144:145], v[202:203] op_sel_hi:[1,0]
    v_pk_fma_f32 v[58:59], v[58:59], v[198:199], v[178:179] op_sel_hi:[1,0,1]
    v_pk_mul_f32 v[176:177], v[146:147], v[202:203] op_sel_hi:[1,0]
    v_pk_fma_f32 v[60:61], v[60:61], v[198:199], v[172:173] op_sel_hi:[1,0,1]
    v_pk_mul_f32 v[178:179], v[148:149], v[202:203] op_sel_hi:[1,0]
    v_pk_fma_f32 v[62:63], v[62:63], v[198:199], v[174:175] op_sel_hi:[1,0,1]
    v_pk_fma_f32 v[64:65], v[64:65], v[198:199], v[176:177] op_sel_hi:[1,0,1]
    v_pk_fma_f32 v[66:67], v[66:67], v[198:199], v[178:179] op_sel_hi:[1,0,1]
    v_cvt_pk_bf16_f32 v180, v52, v53
    v_cvt_pk_bf16_f32 v181, v54, v55
    v_cvt_pk_bf16_f32 v182, v56, v57
    v_cvt_pk_bf16_f32 v183, v58, v59
    v_cvt_pk_bf16_f32 v184, v60, v61
    v_cvt_pk_bf16_f32 v185, v62, v63
    v_cvt_pk_bf16_f32 v186, v64, v65
    v_cvt_pk_bf16_f32 v187, v66, v67
    s_nop 1
    v_permlane32_swap_b32 v180, v182
    v_permlane32_swap_b32 v181, v183
    v_permlane32_swap_b32 v184, v186
    v_permlane32_swap_b32 v185, v187
    buffer_store_dwordx4 v[180:183], v206, s[28:31], s74 offen sc1
    buffer_store_dwordx4 v[184:187], v206, s[28:31], s75 offen sc1
    v_pk_mul_f32 v[172:173], v[134:135], v[204:205] op_sel_hi:[1,0]
    v_pk_mul_f32 v[174:175], v[136:137], v[204:205] op_sel_hi:[1,0]
    v_pk_mul_f32 v[176:177], v[138:139], v[204:205] op_sel_hi:[1,0]
    v_pk_fma_f32 v[84:85], v[84:85], v[200:201], v[172:173] op_sel_hi:[1,0,1]
    v_pk_mul_f32 v[178:179], v[140:141], v[204:205] op_sel_hi:[1,0]
    v_pk_fma_f32 v[86:87], v[86:87], v[200:201], v[174:175] op_sel_hi:[1,0,1]
    v_pk_mul_f32 v[172:173], v[142:143], v[204:205] op_sel_hi:[1,0]
    v_pk_fma_f32 v[88:89], v[88:89], v[200:201], v[176:177] op_sel_hi:[1,0,1]
    v_pk_mul_f32 v[174:175], v[144:145], v[204:205] op_sel_hi:[1,0]
    v_pk_fma_f32 v[90:91], v[90:91], v[200:201], v[178:179] op_sel_hi:[1,0,1]
    v_pk_mul_f32 v[176:177], v[146:147], v[204:205] op_sel_hi:[1,0]
    v_pk_fma_f32 v[92:93], v[92:93], v[200:201], v[172:173] op_sel_hi:[1,0,1]
    v_pk_mul_f32 v[178:179], v[148:149], v[204:205] op_sel_hi:[1,0]
    v_pk_fma_f32 v[94:95], v[94:95], v[200:201], v[174:175] op_sel_hi:[1,0,1]
    v_pk_fma_f32 v[96:97], v[96:97], v[200:201], v[176:177] op_sel_hi:[1,0,1]
    v_pk_fma_f32 v[98:99], v[98:99], v[200:201], v[178:179] op_sel_hi:[1,0,1]
    v_cvt_pk_bf16_f32 v180, v84, v85
    v_cvt_pk_bf16_f32 v181, v86, v87
    v_cvt_pk_bf16_f32 v182, v88, v89
    v_cvt_pk_bf16_f32 v183, v90, v91
    v_cvt_pk_bf16_f32 v184, v92, v93
    v_cvt_pk_bf16_f32 v185, v94, v95
    v_cvt_pk_bf16_f32 v186, v96, v97
    v_cvt_pk_bf16_f32 v187, v98, v99
    s_nop 1
    v_permlane32_swap_b32 v180, v182
    v_permlane32_swap_b32 v181, v183
    v_permlane32_swap_b32 v184, v186
    v_permlane32_swap_b32 v185, v187
    buffer_store_dwordx4 v[180:183], v207, s[28:31], s74 offen sc1
    buffer_store_dwordx4 v[184:187], v207, s[28:31], s75 offen sc1
    s_waitcnt lgkmcnt(0)
    v_pk_mul_f32 v[172:173], v[150:151], v[202:203] op_sel_hi:[1,0]
    v_pk_mul_f32 v[174:175], v[152:153], v[202:203] op_sel_hi:[1,0]
    v_pk_mul_f32 v[176:177], v[154:155], v[202:203] op_sel_hi:[1,0]
    v_pk_fma_f32 v[68:69], v[68:69], v[198:199], v[172:173] op_sel_hi:[1,0,1]
    v_pk_mul_f32 v[178:179], v[156:157], v[202:203] op_sel_hi:[1,0]
    v_pk_fma_f32 v[70:71], v[70:71], v[198:199], v[174:175] op_sel_hi:[1,0,1]
    v_pk_mul_f32 v[172:173], v[158:159], v[202:203] op_sel_hi:[1,0]
    v_pk_fma_f32 v[72:73], v[72:73], v[198:199], v[176:177] op_sel_hi:[1,0,1]
    v_pk_mul_f32 v[174:175], v[160:161], v[202:203] op_sel_hi:[1,0]
    v_pk_fma_f32 v[74:75], v[74:75], v[198:199], v[178:179] op_sel_hi:[1,0,1]
    v_pk_mul_f32 v[176:177], v[162:163], v[202:203] op_sel_hi:[1,0]
    v_pk_fma_f32 v[76:77], v[76:77], v[198:199], v[172:173] op_sel_hi:[1,0,1]
    v_pk_mul_f32 v[178:179], v[164:165], v[202:203] op_sel_hi:[1,0]
    v_pk_fma_f32 v[78:79], v[78:79], v[198:199], v[174:175] op_sel_hi:[1,0,1]
    v_pk_fma_f32 v[80:81], v[80:81], v[198:199], v[176:177] op_sel_hi:[1,0,1]
    v_pk_fma_f32 v[82:83], v[82:83], v[198:199], v[178:179] op_sel_hi:[1,0,1]
    v_cvt_pk_bf16_f32 v180, v68, v69
    v_cvt_pk_bf16_f32 v181, v70, v71
    v_cvt_pk_bf16_f32 v182, v72, v73
    v_cvt_pk_bf16_f32 v183, v74, v75
    v_cvt_pk_bf16_f32 v184, v76, v77
    v_cvt_pk_bf16_f32 v185, v78, v79
    v_cvt_pk_bf16_f32 v186, v80, v81
    v_cvt_pk_bf16_f32 v187, v82, v83
    s_nop 1
    v_permlane32_swap_b32 v180, v182
    v_permlane32_swap_b32 v181, v183
    v_permlane32_swap_b32 v184, v186
    v_permlane32_swap_b32 v185, v187
    buffer_store_dwordx4 v[180:183], v206, s[28:31], s76 offen sc1
    buffer_store_dwordx4 v[184:187], v206, s[28:31], s77 offen sc1
    v_pk_mul_f32 v[172:173], v[150:151], v[204:205] op_sel_hi:[1,0]
    v_pk_mul_f32 v[174:175], v[152:153], v[204:205] op_sel_hi:[1,0]
    v_pk_mul_f32 v[176:177], v[154:155], v[204:205] op_sel_hi:[1,0]
    v_pk_fma_f32 v[100:101], v[100:101], v[200:201], v[172:173] op_sel_hi:[1,0,1]
    v_pk_mul_f32 v[178:179], v[156:157], v[204:205] op_sel_hi:[1,0]
    v_pk_fma_f32 v[102:103], v[102:103], v[200:201], v[174:175] op_sel_hi:[1,0,1]
    v_pk_mul_f32 v[172:173], v[158:159], v[204:205] op_sel_hi:[1,0]
    v_pk_fma_f32 v[104:105], v[104:105], v[200:201], v[176:177] op_sel_hi:[1,0,1]
    v_pk_mul_f32 v[174:175], v[160:161], v[204:205] op_sel_hi:[1,0]
    v_pk_fma_f32 v[106:107], v[106:107], v[200:201], v[178:179] op_sel_hi:[1,0,1]
    v_pk_mul_f32 v[176:177], v[162:163], v[204:205] op_sel_hi:[1,0]
    v_pk_fma_f32 v[108:109], v[108:109], v[200:201], v[172:173] op_sel_hi:[1,0,1]
    v_pk_mul_f32 v[178:179], v[164:165], v[204:205] op_sel_hi:[1,0]
    v_pk_fma_f32 v[110:111], v[110:111], v[200:201], v[174:175] op_sel_hi:[1,0,1]
    v_pk_fma_f32 v[112:113], v[112:113], v[200:201], v[176:177] op_sel_hi:[1,0,1]
    v_pk_fma_f32 v[114:115], v[114:115], v[200:201], v[178:179] op_sel_hi:[1,0,1]
    v_cvt_pk_bf16_f32 v180, v100, v101
    v_cvt_pk_bf16_f32 v181, v102, v103
    v_cvt_pk_bf16_f32 v182, v104, v105
    v_cvt_pk_bf16_f32 v183, v106, v107
    v_cvt_pk_bf16_f32 v184, v108, v109
    v_cvt_pk_bf16_f32 v185, v110, v111
    v_cvt_pk_bf16_f32 v186, v112, v113
    v_cvt_pk_bf16_f32 v187, v114, v115
    s_nop 1
    v_permlane32_swap_b32 v180, v182
    v_permlane32_swap_b32 v181, v183
    v_permlane32_swap_b32 v184, v186
    v_permlane32_swap_b32 v185, v187
    buffer_store_dwordx4 v[180:183], v207, s[28:31], s76 offen sc1
    buffer_store_dwordx4 v[184:187], v207, s[28:31], s77 offen sc1
    s_branch qkv_end_3
qkv_nt_2:
    s_sub_u32 s66, s53, 10
    s_lshl_b32 s66, s66, 2
    s_add_u32 s66, s66, s64
    s_lshl_b32 s66, s66, 5
    v_add_u32 v206, s66, v8
    v_lshlrev_b32 v206, 4, v206
    v_mul_u32_u24 v4, 10240, v9
    v_add_u32 v206, v206, v4
    s_sub_u32 s66, s53, 10
    s_lshl_b32 s66, s66, 2
    s_add_u32 s66, s66, s65
    s_lshl_b32 s66, s66, 5
    v_add_u32 v207, s66, v8
    v_lshlrev_b32 v207, 4, v207
    v_mul_u32_u24 v4, 10240, v9
    v_add_u32 v207, v207, v4
    s_lshl_b32 s66, s62, 2
    s_lshr_b32 s74, s59, 3
    s_add_u32 s74, s74, s66
    s_mul_i32 s74, s74, 10240
    s_add_u32 s75, s74, 20480
    s_lshl_b32 s66, s63, 2
    s_lshr_b32 s76, s59, 3
    s_add_u32 s76, s76, s66
    s_mul_i32 s76, s76, 10240
    s_add_u32 s77, s76, 20480
    s_barrier
    ds_read_b128 v[20:23], v10 offset:0
    ds_read_b128 v[24:27], v14 offset:0
    ds_read_b64_tr_b16 v[36:37], v18 offset:0
    ds_read_b64_tr_b16 v[38:39], v18 offset:1024
    ds_read_b64_tr_b16 v[40:41], v19 offset:0
    ds_read_b64_tr_b16 v[42:43], v19 offset:1024
    s_waitcnt lgkmcnt(0)
    v_mfma_f32_32x32x16_bf16 v[52:67], v[20:23], v[36:39], 0
    ds_read_b128 v[28:31], v11 offset:0
    ds_read_b128 v[32:35], v15 offset:0
    ds_read_b64_tr_b16 v[44:45], v18 offset:4096
    v_mfma_f32_32x32x16_bf16 v[68:83], v[20:23], v[40:43], 0
    ds_read_b64_tr_b16 v[46:47], v18 offset:5120
    ds_read_b64_tr_b16 v[48:49], v19 offset:4096
    ds_read_b64_tr_b16 v[50:51], v19 offset:5120
    v_mfma_f32_32x32x16_bf16 v[84:99], v[24:27], v[36:39], 0
    v_mfma_f32_32x32x16_bf16 v[100:115], v[24:27], v[40:43], 0
    v_dot2c_f32_bf16 v116, s68, v20
    v_dot2c_f32_bf16 v118, v20, v20
    v_dot2c_f32_bf16 v120, s68, v36
    v_dot2c_f32_bf16 v117, s68, v21
    v_dot2c_f32_bf16 v119, v21, v21
    v_dot2c_f32_bf16 v121, s68, v37
    v_dot2c_f32_bf16 v116, s68, v22
    v_dot2c_f32_bf16 v118, v22, v22
    v_dot2c_f32_bf16 v120, s68, v38
    v_dot2c_f32_bf16 v117, s68, v23
    v_dot2c_f32_bf16 v119, v23, v23
    v_dot2c_f32_bf16 v121, s68, v39
    s_waitcnt lgkmcnt(0)
    v_mfma_f32_32x32x16_bf16 v[52:67], v[28:31], v[44:47], v[52:67]
    ds_read_b128 v[20:23], v12 offset:0
    ds_read_b128 v[24:27], v16 offset:0
    ds_read_b64_tr_b16 v[36:37], v18 offset:8192
    v_mfma_f32_32x32x16_bf16 v[68:83], v[28:31], v[48:51], v[68:83]
    ds_read_b64_tr_b16 v[38:39], v18 offset:9216
    ds_read_b64_tr_b16 v[40:41], v19 offset:8192
    ds_read_b64_tr_b16 v[42:43], v19 offset:9216
    v_mfma_f32_32x32x16_bf16 v[84:99], v[32:35], v[44:47], v[84:99]
    v_mfma_f32_32x32x16_bf16 v[100:115], v[32:35], v[48:51], v[100:115]
    v_dot2c_f32_bf16 v116, s68, v28
    v_dot2c_f32_bf16 v118, v28, v28
    v_dot2c_f32_bf16 v120, s68, v44
    v_dot2c_f32_bf16 v117, s68, v29
    v_dot2c_f32_bf16 v119, v29, v29
    v_dot2c_f32_bf16 v121, s68, v45
    v_dot2c_f32_bf16 v116, s68, v30
    v_dot2c_f32_bf16 v118, v30, v30
    v_dot2c_f32_bf16 v120, s68, v46
    v_dot2c_f32_bf16 v117, s68, v31
    v_dot2c_f32_bf16 v119, v31, v31
    v_dot2c_f32_bf16 v121, s68, v47
    s_waitcnt lgkmcnt(0)
    v_mfma_f32_32x32x16_bf16 v[52:67], v[20:23], v[36:39], v[52:67]
    ds_read_b128 v[28:31], v13 offset:0
    ds_read_b128 v[32:35], v17 offset:0
    ds_read_b64_tr_b16 v[44:45], v18 offset:12288
    v_mfma_f32_32x32x16_bf16 v[68:83], v[20:23], v[40:43], v[68:83]
    ds_read_b64_tr_b16 v[46:47], v18 offset:13312
    ds_read_b64_tr_b16 v[48:49], v19 offset:12288
    ds_read_b64_tr_b16 v[50:51], v19 offset:13312
    v_mfma_f32_32x32x16_bf16 v[84:99], v[24:27], v[36:39], v[84:99]
    v_mfma_f32_32x32x16_bf16 v[100:115], v[24:27], v[40:43], v[100:115]
    v_dot2c_f32_bf16 v116, s68, v20
    v_dot2c_f32_bf16 v118, v20, v20
    v_dot2c_f32_bf16 v120, s68, v36
    v_dot2c_f32_bf16 v117, s68, v21
    v_dot2c_f32_bf16 v119, v21, v21
    v_dot2c_f32_bf16 v121, s68, v37
    v_dot2c_f32_bf16 v116, s68, v22
    v_dot2c_f32_bf16 v118, v22, v22
    v_dot2c_f32_bf16 v120, s68, v38
    v_dot2c_f32_bf16 v117, s68, v23
    v_dot2c_f32_bf16 v119, v23, v23
    v_dot2c_f32_bf16 v121, s68, v39
    s_waitcnt lgkmcnt(0)
    s_barrier
    v_mfma_f32_32x32x16_bf16 v[52:67], v[28:31], v[44:47], v[52:67]
    ds_read_b128 v[20:23], v10 offset:16384
    ds_read_b128 v[24:27], v14 offset:16384
    ds_read_b64_tr_b16 v[36:37], v18 offset:16384
    v_mfma_f32_32x32x16_bf16 v[68:83], v[28:31], v[48:51], v[68:83]
    ds_read_b64_tr_b16 v[38:39], v18 offset:17408
    ds_read_b64_tr_b16 v[40:41], v19 offset:16384
    ds_read_b64_tr_b16 v[42:43], v19 offset:17408
    v_mfma_f32_32x32x16_bf16 v[84:99], v[32:35], v[44:47], v[84:99]
    v_mfma_f32_32x32x16_bf16 v[100:115], v[32:35], v[48:51], v[100:115]
    v_dot2c_f32_bf16 v116, s68, v28
    v_dot2c_f32_bf16 v118, v28, v28
    v_dot2c_f32_bf16 v120, s68, v44
    v_dot2c_f32_bf16 v117, s68, v29
    v_dot2c_f32_bf16 v119, v29, v29
    v_dot2c_f32_bf16 v121, s68, v45
    v_dot2c_f32_bf16 v116, s68, v30
    v_dot2c_f32_bf16 v118, v30, v30
    v_dot2c_f32_bf16 v120, s68, v46
    v_dot2c_f32_bf16 v117, s68, v31
    v_dot2c_f32_bf16 v119, v31, v31
    v_dot2c_f32_bf16 v121, s68, v47
    s_waitcnt lgkmcnt(0)
    v_mfma_f32_32x32x16_bf16 v[52:67], v[20:23], v[36:39], v[52:67]
    ds_read_b128 v[28:31], v11 offset:16384
    ds_read_b128 v[32:35], v15 offset:16384
    ds_read_b64_tr_b16 v[44:45], v18 offset:20480
    v_mfma_f32_32x32x16_bf16 v[68:83], v[20:23], v[40:43], v[68:83]
    ds_read_b64_tr_b16 v[46:47], v18 offset:21504
    ds_read_b64_tr_b16 v[48:49], v19 offset:20480
    ds_read_b64_tr_b16 v[50:51], v19 offset:21504
    v_mfma_f32_32x32x16_bf16 v[84:99], v[24:27], v[36:39], v[84:99]
    v_mfma_f32_32x32x16_bf16 v[100:115], v[24:27], v[40:43], v[100:115]
    s_waitcnt vmcnt(0)
    v_add_u32 v190, 1, v2
    v_add_f32 v116, v116, v117
    v_add_f32 v118, v118, v119
    v_add_f32 v120, v120, v121
    v_mov_b32 v4, v116
    v_mov_b32 v5, v118
    v_mov_b32 v6, v120
    s_nop 1
    v_permlane32_swap_b32 v4, v116
    v_permlane32_swap_b32 v5, v118
    v_permlane32_swap_b32 v6, v120
    v_cmp_eq_u32 vcc, 0, v9
    v_mov_b32 v195, v190
    v_mov_b32 v197, v190
    v_add_f32 v116, v116, v4
    v_add_f32 v118, v118, v5
    v_add_f32 v196, v120, v6
    v_cndmask_b32 v194, v118, v116, vcc
    buffer_store_dwordx2 v[196:197], v123, s[36:39], 0 offen sc1
    buffer_store_dwordx2 v[194:195], v122, s[36:39], 0 offen sc1
    s_waitcnt lgkmcnt(0)
    v_mfma_f32_32x32x16_bf16 v[52:67], v[28:31], v[44:47], v[52:67]
    ds_read_b128 v[20:23], v12 offset:16384
    ds_read_b128 v[24:27], v16 offset:16384
    ds_read_b64_tr_b16 v[36:37], v18 offset:24576
    v_mfma_f32_32x32x16_bf16 v[68:83], v[28:31], v[48:51], v[68:83]
    ds_read_b64_tr_b16 v[38:39], v18 offset:25600
    ds_read_b64_tr_b16 v[40:41], v19 offset:24576
    ds_read_b64_tr_b16 v[42:43], v19 offset:25600
    v_mfma_f32_32x32x16_bf16 v[84:99], v[32:35], v[44:47], v[84:99]
    v_mfma_f32_32x32x16_bf16 v[100:115], v[32:35], v[48:51], v[100:115]
    s_waitcnt lgkmcnt(0)
    v_mfma_f32_32x32x16_bf16 v[52:67], v[20:23], v[36:39], v[52:67]
    ds_read_b128 v[28:31], v13 offset:16384
    ds_read_b128 v[32:35], v17 offset:16384
    ds_read_b64_tr_b16 v[44:45], v18 offset:28672
    v_mfma_f32_32x32x16_bf16 v[68:83], v[20:23], v[40:43], v[68:83]
    ds_read_b64_tr_b16 v[46:47], v18 offset:29696
    ds_read_b64_tr_b16 v[48:49], v19 offset:28672
    ds_read_b64_tr_b16 v[50:51], v19 offset:29696
    v_mfma_f32_32x32x16_bf16 v[84:99], v[24:27], v[36:39], v[84:99]
    v_mfma_f32_32x32x16_bf16 v[100:115], v[24:27], v[40:43], v[100:115]
    s_waitcnt lgkmcnt(0)
    s_barrier
    v_mfma_f32_32x32x16_bf16 v[52:67], v[28:31], v[44:47], v[52:67]
    ds_read_b128 v[20:23], v10 offset:32768
    ds_read_b128 v[24:27], v14 offset:32768
    ds_read_b64_tr_b16 v[36:37], v18 offset:32768
    v_mfma_f32_32x32x16_bf16 v[68:83], v[28:31], v[48:51], v[68:83]
    ds_read_b64_tr_b16 v[38:39], v18 offset:33792
    ds_read_b64_tr_b16 v[40:41], v19 offset:32768
    ds_read_b64_tr_b16 v[42:43], v19 offset:33792
    v_mfma_f32_32x32x16_bf16 v[84:99], v[32:35], v[44:47], v[84:99]
    v_mfma_f32_32x32x16_bf16 v[100:115], v[32:35], v[48:51], v[100:115]
    s_waitcnt lgkmcnt(0)
    v_mfma_f32_32x32x16_bf16 v[52:67], v[20:23], v[36:39], v[52:67]
    ds_read_b128 v[28:31], v11 offset:32768
    ds_read_b128 v[32:35], v15 offset:32768
    ds_read_b64_tr_b16 v[44:45], v18 offset:36864
    v_mfma_f32_32x32x16_bf16 v[68:83], v[20:23], v[40:43], v[68:83]
    ds_read_b64_tr_b16 v[46:47], v18 offset:37888
    ds_read_b64_tr_b16 v[48:49], v19 offset:36864
    ds_read_b64_tr_b16 v[50:51], v19 offset:37888
    v_mfma_f32_32x32x16_bf16 v[84:99], v[24:27], v[36:39], v[84:99]
    v_mfma_f32_32x32x16_bf16 v[100:115], v[24:27], v[40:43], v[100:115]
    s_waitcnt lgkmcnt(0)
    v_mfma_f32_32x32x16_bf16 v[52:67], v[28:31], v[44:47], v[52:67]
    ds_read_b128 v[20:23], v12 offset:32768
    ds_read_b128 v[24:27], v16 offset:32768
    ds_read_b64_tr_b16 v[36:37], v18 offset:40960
    v_mfma_f32_32x32x16_bf16 v[68:83], v[28:31], v[48:51], v[68:83]
    ds_read_b64_tr_b16 v[38:39], v18 offset:41984
    ds_read_b64_tr_b16 v[40:41], v19 offset:40960
    ds_read_b64_tr_b16 v[42:43], v19 offset:41984
    v_mfma_f32_32x32x16_bf16 v[84:99], v[32:35], v[44:47], v[84:99]
    v_mfma_f32_32x32x16_bf16 v[100:115], v[32:35], v[48:51], v[100:115]
    s_waitcnt lgkmcnt(0)
    v_mfma_f32_32x32x16_bf16 v[52:67], v[20:23], v[36:39], v[52:67]
    ds_read_b128 v[28:31], v13 offset:32768
    ds_read_b128 v[32:35], v17 offset:32768
    ds_read_b64_tr_b16 v[44:45], v18 offset:45056
    v_mfma_f32_32x32x16_bf16 v[68:83], v[20:23], v[40:43], v[68:83]
    ds_read_b64_tr_b16 v[46:47], v18 offset:46080
    ds_read_b64_tr_b16 v[48:49], v19 offset:45056
    ds_read_b64_tr_b16 v[50:51], v19 offset:46080
    v_mfma_f32_32x32x16_bf16 v[84:99], v[24:27], v[36:39], v[84:99]
    v_mfma_f32_32x32x16_bf16 v[100:115], v[24:27], v[40:43], v[100:115]
    s_waitcnt lgkmcnt(0)
    s_barrier
    v_mfma_f32_32x32x16_bf16 v[52:67], v[28:31], v[44:47], v[52:67]
    ds_read_b128 v[20:23], v10 offset:49152
    ds_read_b128 v[24:27], v14 offset:49152
    ds_read_b64_tr_b16 v[36:37], v18 offset:49152
    v_mfma_f32_32x32x16_bf16 v[68:83], v[28:31], v[48:51], v[68:83]
    ds_read_b64_tr_b16 v[38:39], v18 offset:50176
    ds_read_b64_tr_b16 v[40:41], v19 offset:49152
    ds_read_b64_tr_b16 v[42:43], v19 offset:50176
    v_mfma_f32_32x32x16_bf16 v[84:99], v[32:35], v[44:47], v[84:99]
    v_mfma_f32_32x32x16_bf16 v[100:115], v[32:35], v[48:51], v[100:115]
    s_waitcnt lgkmcnt(0)
    v_mfma_f32_32x32x16_bf16 v[52:67], v[20:23], v[36:39], v[52:67]
    ds_read_b128 v[28:31], v11 offset:49152
    ds_read_b128 v[32:35], v15 offset:49152
    ds_read_b64_tr_b16 v[44:45], v18 offset:53248
    v_mfma_f32_32x32x16_bf16 v[68:83], v[20:23], v[40:43], v[68:83]
    ds_read_b64_tr_b16 v[46:47], v18 offset:54272
    ds_read_b64_tr_b16 v[48:49], v19 offset:53248
    ds_read_b64_tr_b16 v[50:51], v19 offset:54272
    v_mfma_f32_32x32x16_bf16 v[84:99], v[24:27], v[36:39], v[84:99]
    v_mfma_f32_32x32x16_bf16 v[100:115], v[24:27], v[40:43], v[100:115]
    s_waitcnt lgkmcnt(0)
    v_mfma_f32_32x32x16_bf16 v[52:67], v[28:31], v[44:47], v[52:67]
    ds_read_b128 v[20:23], v12 offset:49152
    ds_read_b128 v[24:27], v16 offset:49152
    ds_read_b64_tr_b16 v[36:37], v18 offset:57344
    v_mfma_f32_32x32x16_bf16 v[68:83], v[28:31], v[48:51], v[68:83]
    ds_read_b64_tr_b16 v[38:39], v18 offset:58368
    ds_read_b64_tr_b16 v[40:41], v19 offset:57344
    ds_read_b64_tr_b16 v[42:43], v19 offset:58368
    v_mfma_f32_32x32x16_bf16 v[84:99], v[32:35], v[44:47], v[84:99]
    v_mfma_f32_32x32x16_bf16 v[100:115], v[32:35], v[48:51], v[100:115]
    s_waitcnt lgkmcnt(0)
    v_mfma_f32_32x32x16_bf16 v[52:67], v[20:23], v[36:39], v[52:67]
    ds_read_b128 v[28:31], v13 offset:49152
    ds_read_b128 v[32:35], v17 offset:49152
    ds_read_b64_tr_b16 v[44:45], v18 offset:61440
    v_mfma_f32_32x32x16_bf16 v[68:83], v[20:23], v[40:43], v[68:83]
    ds_read_b64_tr_b16 v[46:47], v18 offset:62464
    ds_read_b64_tr_b16 v[48:49], v19 offset:61440
    ds_read_b64_tr_b16 v[50:51], v19 offset:62464
    v_mfma_f32_32x32x16_bf16 v[84:99], v[24:27], v[36:39], v[84:99]
    v_mfma_f32_32x32x16_bf16 v[100:115], v[24:27], v[40:43], v[100:115]
    s_waitcnt lgkmcnt(0)
    s_barrier
    v_mfma_f32_32x32x16_bf16 v[52:67], v[28:31], v[44:47], v[52:67]
    ds_read_b128 v[20:23], v10 offset:0
    ds_read_b128 v[24:27], v14 offset:0
    ds_read_b64_tr_b16 v[36:37], v18 offset:0
    v_mfma_f32_32x32x16_bf16 v[68:83], v[28:31], v[48:51], v[68:83]
    ds_read_b64_tr_b16 v[38:39], v18 offset:1024
    ds_read_b64_tr_b16 v[40:41], v19 offset:0
    ds_read_b64_tr_b16 v[42:43], v19 offset:1024
    v_mfma_f32_32x32x16_bf16 v[84:99], v[32:35], v[44:47], v[84:99]
    v_mfma_f32_32x32x16_bf16 v[100:115], v[32:35], v[48:51], v[100:115]
    s_waitcnt lgkmcnt(0)
    v_mfma_f32_32x32x16_bf16 v[52:67], v[20:23], v[36:39], v[52:67]
    ds_read_b128 v[28:31], v11 offset:0
    ds_read_b128 v[32:35], v15 offset:0
    ds_read_b64_tr_b16 v[44:45], v18 offset:4096
    v_mfma_f32_32x32x16_bf16 v[68:83], v[20:23], v[40:43], v[68:83]
    ds_read_b64_tr_b16 v[46:47], v18 offset:5120
    ds_read_b64_tr_b16 v[48:49], v19 offset:4096
    ds_read_b64_tr_b16 v[50:51], v19 offset:5120
    v_mfma_f32_32x32x16_bf16 v[84:99], v[24:27], v[36:39], v[84:99]
    v_mfma_f32_32x32x16_bf16 v[100:115], v[24:27], v[40:43], v[100:115]
    s_waitcnt lgkmcnt(0)
    v_mfma_f32_32x32x16_bf16 v[52:67], v[28:31], v[44:47], v[52:67]
    ds_read_b128 v[20:23], v12 offset:0
    ds_read_b128 v[24:27], v16 offset:0
    ds_read_b64_tr_b16 v[36:37], v18 offset:8192
    v_mfma_f32_32x32x16_bf16 v[68:83], v[28:31], v[48:51], v[68:83]
    ds_read_b64_tr_b16 v[38:39], v18 offset:9216
    ds_read_b64_tr_b16 v[40:41], v19 offset:8192
    ds_read_b64_tr_b16 v[42:43], v19 offset:9216
    v_mfma_f32_32x32x16_bf16 v[84:99], v[32:35], v[44:47], v[84:99]
    v_mfma_f32_32x32x16_bf16 v[100:115], v[32:35], v[48:51], v[100:115]
    s_waitcnt lgkmcnt(0)
    v_mfma_f32_32x32x16_bf16 v[52:67], v[20:23], v[36:39], v[52:67]
    ds_read_b128 v[28:31], v13 offset:0
    ds_read_b128 v[32:35], v17 offset:0
    ds_read_b64_tr_b16 v[44:45], v18 offset:12288
    v_mfma_f32_32x32x16_bf16 v[68:83], v[20:23], v[40:43], v[68:83]
    ds_read_b64_tr_b16 v[46:47], v18 offset:13312
    ds_read_b64_tr_b16 v[48:49], v19 offset:12288
    ds_read_b64_tr_b16 v[50:51], v19 offset:13312
    v_mfma_f32_32x32x16_bf16 v[84:99], v[24:27], v[36:39], v[84:99]
    v_mfma_f32_32x32x16_bf16 v[100:115], v[24:27], v[40:43], v[100:115]
    s_waitcnt lgkmcnt(0)
    s_barrier
    v_mfma_f32_32x32x16_bf16 v[52:67], v[28:31], v[44:47], v[52:67]
    ds_read_b128 v[20:23], v10 offset:16384
    ds_read_b128 v[24:27], v14 offset:16384
    ds_read_b64_tr_b16 v[36:37], v18 offset:16384
    v_mfma_f32_32x32x16_bf16 v[68:83], v[28:31], v[48:51], v[68:83]
    ds_read_b64_tr_b16 v[38:39], v18 offset:17408
    ds_read_b64_tr_b16 v[40:41], v19 offset:16384
    ds_read_b64_tr_b16 v[42:43], v19 offset:17408
    v_mfma_f32_32x32x16_bf16 v[84:99], v[32:35], v[44:47], v[84:99]
    v_mfma_f32_32x32x16_bf16 v[100:115], v[32:35], v[48:51], v[100:115]
    s_waitcnt lgkmcnt(0)
    v_mfma_f32_32x32x16_bf16 v[52:67], v[20:23], v[36:39], v[52:67]
    ds_read_b128 v[28:31], v11 offset:16384
    ds_read_b128 v[32:35], v15 offset:16384
    ds_read_b64_tr_b16 v[44:45], v18 offset:20480
    v_mfma_f32_32x32x16_bf16 v[68:83], v[20:23], v[40:43], v[68:83]
    ds_read_b64_tr_b16 v[46:47], v18 offset:21504
    ds_read_b64_tr_b16 v[48:49], v19 offset:20480
    ds_read_b64_tr_b16 v[50:51], v19 offset:21504
    v_mfma_f32_32x32x16_bf16 v[84:99], v[24:27], v[36:39], v[84:99]
    v_mfma_f32_32x32x16_bf16 v[100:115], v[24:27], v[40:43], v[100:115]
    s_waitcnt lgkmcnt(0)
    v_mfma_f32_32x32x16_bf16 v[52:67], v[28:31], v[44:47], v[52:67]
    ds_read_b128 v[20:23], v12 offset:16384
    ds_read_b128 v[24:27], v16 offset:16384
    ds_read_b64_tr_b16 v[36:37], v18 offset:24576
    v_mfma_f32_32x32x16_bf16 v[68:83], v[28:31], v[48:51], v[68:83]
    ds_read_b64_tr_b16 v[38:39], v18 offset:25600
    ds_read_b64_tr_b16 v[40:41], v19 offset:24576
    ds_read_b64_tr_b16 v[42:43], v19 offset:25600
    v_mfma_f32_32x32x16_bf16 v[84:99], v[32:35], v[44:47], v[84:99]
    v_mfma_f32_32x32x16_bf16 v[100:115], v[32:35], v[48:51], v[100:115]
    s_waitcnt lgkmcnt(0)
    v_mfma_f32_32x32x16_bf16 v[52:67], v[20:23], v[36:39], v[52:67]
    ds_read_b128 v[28:31], v13 offset:16384
    ds_read_b128 v[32:35], v17 offset:16384
    ds_read_b64_tr_b16 v[44:45], v18 offset:28672
    v_mfma_f32_32x32x16_bf16 v[68:83], v[20:23], v[40:43], v[68:83]
    ds_read_b64_tr_b16 v[46:47], v18 offset:29696
    ds_read_b64_tr_b16 v[48:49], v19 offset:28672
    ds_read_b64_tr_b16 v[50:51], v19 offset:29696
    v_mfma_f32_32x32x16_bf16 v[84:99], v[24:27], v[36:39], v[84:99]
    v_mfma_f32_32x32x16_bf16 v[100:115], v[24:27], v[40:43], v[100:115]
    s_waitcnt lgkmcnt(0)
    s_barrier
    v_mfma_f32_32x32x16_bf16 v[52:67], v[28:31], v[44:47], v[52:67]
    ds_read_b128 v[20:23], v10 offset:32768
    ds_read_b128 v[24:27], v14 offset:32768
    ds_read_b64_tr_b16 v[36:37], v18 offset:32768
    v_mfma_f32_32x32x16_bf16 v[68:83], v[28:31], v[48:51], v[68:83]
    ds_read_b64_tr_b16 v[38:39], v18 offset:33792
    ds_read_b64_tr_b16 v[40:41], v19 offset:32768
    ds_read_b64_tr_b16 v[42:43], v19 offset:33792
    v_mfma_f32_32x32x16_bf16 v[84:99], v[32:35], v[44:47], v[84:99]
    v_mfma_f32_32x32x16_bf16 v[100:115], v[32:35], v[48:51], v[100:115]
    s_waitcnt lgkmcnt(0)
    v_mfma_f32_32x32x16_bf16 v[52:67], v[20:23], v[36:39], v[52:67]
    ds_read_b128 v[28:31], v11 offset:32768
    ds_read_b128 v[32:35], v15 offset:32768
    ds_read_b64_tr_b16 v[44:45], v18 offset:36864
    v_mfma_f32_32x32x16_bf16 v[68:83], v[20:23], v[40:43], v[68:83]
    ds_read_b64_tr_b16 v[46:47], v18 offset:37888
    ds_read_b64_tr_b16 v[48:49], v19 offset:36864
    ds_read_b64_tr_b16 v[50:51], v19 offset:37888
    v_mfma_f32_32x32x16_bf16 v[84:99], v[24:27], v[36:39], v[84:99]
    v_mfma_f32_32x32x16_bf16 v[100:115], v[24:27], v[40:43], v[100:115]
    s_waitcnt lgkmcnt(0)
    v_mfma_f32_32x32x16_bf16 v[52:67], v[28:31], v[44:47], v[52:67]
    ds_read_b128 v[20:23], v12 offset:32768
    ds_read_b128 v[24:27], v16 offset:32768
    ds_read_b64_tr_b16 v[36:37], v18 offset:40960
    v_mfma_f32_32x32x16_bf16 v[68:83], v[28:31], v[48:51], v[68:83]
    ds_read_b64_tr_b16 v[38:39], v18 offset:41984
    ds_read_b64_tr_b16 v[40:41], v19 offset:40960
    ds_read_b64_tr_b16 v[42:43], v19 offset:41984
    v_mfma_f32_32x32x16_bf16 v[84:99], v[32:35], v[44:47], v[84:99]
    v_mfma_f32_32x32x16_bf16 v[100:115], v[32:35], v[48:51], v[100:115]
    s_waitcnt lgkmcnt(0)
    v_mfma_f32_32x32x16_bf16 v[52:67], v[20:23], v[36:39], v[52:67]
    ds_read_b128 v[28:31], v13 offset:32768
    ds_read_b128 v[32:35], v17 offset:32768
    ds_read_b64_tr_b16 v[44:45], v18 offset:45056
    v_mfma_f32_32x32x16_bf16 v[68:83], v[20:23], v[40:43], v[68:83]
    ds_read_b64_tr_b16 v[46:47], v18 offset:46080
    ds_read_b64_tr_b16 v[48:49], v19 offset:45056
    ds_read_b64_tr_b16 v[50:51], v19 offset:46080
    v_mfma_f32_32x32x16_bf16 v[84:99], v[24:27], v[36:39], v[84:99]
    v_mfma_f32_32x32x16_bf16 v[100:115], v[24:27], v[40:43], v[100:115]
    s_waitcnt lgkmcnt(0)
    s_barrier
    v_mfma_f32_32x32x16_bf16 v[52:67], v[28:31], v[44:47], v[52:67]
    ds_read_b128 v[20:23], v10 offset:49152
    ds_read_b128 v[24:27], v14 offset:49152
    ds_read_b64_tr_b16 v[36:37], v18 offset:49152
    v_mfma_f32_32x32x16_bf16 v[68:83], v[28:31], v[48:51], v[68:83]
    ds_read_b64_tr_b16 v[38:39], v18 offset:50176
    ds_read_b64_tr_b16 v[40:41], v19 offset:49152
    ds_read_b64_tr_b16 v[42:43], v19 offset:50176
    v_mfma_f32_32x32x16_bf16 v[84:99], v[32:35], v[44:47], v[84:99]
    v_mfma_f32_32x32x16_bf16 v[100:115], v[32:35], v[48:51], v[100:115]
    s_waitcnt lgkmcnt(0)
    v_mfma_f32_32x32x16_bf16 v[52:67], v[20:23], v[36:39], v[52:67]
    ds_read_b128 v[28:31], v11 offset:49152
    ds_read_b128 v[32:35], v15 offset:49152
    ds_read_b64_tr_b16 v[44:45], v18 offset:53248
    v_mfma_f32_32x32x16_bf16 v[68:83], v[20:23], v[40:43], v[68:83]
    ds_read_b64_tr_b16 v[46:47], v18 offset:54272
    ds_read_b64_tr_b16 v[48:49], v19 offset:53248
    ds_read_b64_tr_b16 v[50:51], v19 offset:54272
    v_mfma_f32_32x32x16_bf16 v[84:99], v[24:27], v[36:39], v[84:99]
    v_mfma_f32_32x32x16_bf16 v[100:115], v[24:27], v[40:43], v[100:115]
    s_waitcnt lgkmcnt(0)
    v_mfma_f32_32x32x16_bf16 v[52:67], v[28:31], v[44:47], v[52:67]
    ds_read_b128 v[20:23], v12 offset:49152
    ds_read_b128 v[24:27], v16 offset:49152
    ds_read_b64_tr_b16 v[36:37], v18 offset:57344
    v_mfma_f32_32x32x16_bf16 v[68:83], v[28:31], v[48:51], v[68:83]
    ds_read_b64_tr_b16 v[38:39], v18 offset:58368
    ds_read_b64_tr_b16 v[40:41], v19 offset:57344
    ds_read_b64_tr_b16 v[42:43], v19 offset:58368
    v_mfma_f32_32x32x16_bf16 v[84:99], v[32:35], v[44:47], v[84:99]
    v_mfma_f32_32x32x16_bf16 v[100:115], v[32:35], v[48:51], v[100:115]
    s_waitcnt lgkmcnt(0)
    v_mfma_f32_32x32x16_bf16 v[52:67], v[20:23], v[36:39], v[52:67]
    ds_read_b128 v[28:31], v13 offset:49152
    ds_read_b128 v[32:35], v17 offset:49152
    ds_read_b64_tr_b16 v[44:45], v18 offset:61440
    v_mfma_f32_32x32x16_bf16 v[68:83], v[20:23], v[40:43], v[68:83]
    ds_read_b64_tr_b16 v[46:47], v18 offset:62464
    ds_read_b64_tr_b16 v[48:49], v19 offset:61440
    ds_read_b64_tr_b16 v[50:51], v19 offset:62464
    v_mfma_f32_32x32x16_bf16 v[84:99], v[24:27], v[36:39], v[84:99]
    v_mfma_f32_32x32x16_bf16 v[100:115], v[24:27], v[40:43], v[100:115]
    s_waitcnt lgkmcnt(0)
    s_barrier
    v_mfma_f32_32x32x16_bf16 v[52:67], v[28:31], v[44:47], v[52:67]
    ds_read_b128 v[20:23], v10 offset:0
    ds_read_b128 v[24:27], v14 offset:0
    ds_read_b64_tr_b16 v[36:37], v18 offset:0
    v_mfma_f32_32x32x16_bf16 v[68:83], v[28:31], v[48:51], v[68:83]
    ds_read_b64_tr_b16 v[38:39], v18 offset:1024
    ds_read_b64_tr_b16 v[40:41], v19 offset:0
    ds_read_b64_tr_b16 v[42:43], v19 offset:1024
    v_mfma_f32_32x32x16_bf16 v[84:99], v[32:35], v[44:47], v[84:99]
    v_mfma_f32_32x32x16_bf16 v[100:115], v[32:35], v[48:51], v[100:115]
    s_waitcnt lgkmcnt(0)
    v_mfma_f32_32x32x16_bf16 v[52:67], v[20:23], v[36:39], v[52:67]
    ds_read_b128 v[28:31], v11 offset:0
    ds_read_b128 v[32:35], v15 offset:0
    ds_read_b64_tr_b16 v[44:45], v18 offset:4096
    v_mfma_f32_32x32x16_bf16 v[68:83], v[20:23], v[40:43], v[68:83]
    ds_read_b64_tr_b16 v[46:47], v18 offset:5120
    ds_read_b64_tr_b16 v[48:49], v19 offset:4096
    ds_read_b64_tr_b16 v[50:51], v19 offset:5120
    v_mfma_f32_32x32x16_bf16 v[84:99], v[24:27], v[36:39], v[84:99]
    v_mfma_f32_32x32x16_bf16 v[100:115], v[24:27], v[40:43], v[100:115]
    s_waitcnt lgkmcnt(0)
    v_mfma_f32_32x32x16_bf16 v[52:67], v[28:31], v[44:47], v[52:67]
    ds_read_b128 v[20:23], v12 offset:0
    ds_read_b128 v[24:27], v16 offset:0
    ds_read_b64_tr_b16 v[36:37], v18 offset:8192
    v_mfma_f32_32x32x16_bf16 v[68:83], v[28:31], v[48:51], v[68:83]
    ds_read_b64_tr_b16 v[38:39], v18 offset:9216
    ds_read_b64_tr_b16 v[40:41], v19 offset:8192
    ds_read_b64_tr_b16 v[42:43], v19 offset:9216
    v_mfma_f32_32x32x16_bf16 v[84:99], v[32:35], v[44:47], v[84:99]
    v_mfma_f32_32x32x16_bf16 v[100:115], v[32:35], v[48:51], v[100:115]
    s_waitcnt lgkmcnt(0)
    v_mfma_f32_32x32x16_bf16 v[52:67], v[20:23], v[36:39], v[52:67]
    ds_read_b128 v[28:31], v13 offset:0
    ds_read_b128 v[32:35], v17 offset:0
    ds_read_b64_tr_b16 v[44:45], v18 offset:12288
    v_mfma_f32_32x32x16_bf16 v[68:83], v[20:23], v[40:43], v[68:83]
    ds_read_b64_tr_b16 v[46:47], v18 offset:13312
    ds_read_b64_tr_b16 v[48:49], v19 offset:12288
    ds_read_b64_tr_b16 v[50:51], v19 offset:13312
    v_mfma_f32_32x32x16_bf16 v[84:99], v[24:27], v[36:39], v[84:99]
    v_mfma_f32_32x32x16_bf16 v[100:115], v[24:27], v[40:43], v[100:115]
    s_waitcnt lgkmcnt(0)
    s_barrier
    v_mfma_f32_32x32x16_bf16 v[52:67], v[28:31], v[44:47], v[52:67]
    ds_read_b128 v[20:23], v10 offset:16384
    ds_read_b128 v[24:27], v14 offset:16384
    ds_read_b64_tr_b16 v[36:37], v18 offset:16384
    ds_read_b128 v[130:133], v126 offset:0
    ds_read_b128 v[134:137], v126 offset:2048
    v_mfma_f32_32x32x16_bf16 v[68:83], v[28:31], v[48:51], v[68:83]
    ds_read_b64_tr_b16 v[38:39], v18 offset:17408
    ds_read_b64_tr_b16 v[40:41], v19 offset:16384
    ds_read_b64_tr_b16 v[42:43], v19 offset:17408
    ds_read_b128 v[138:141], v126 offset:4096
    ds_read_b128 v[142:145], v126 offset:6144
    v_mfma_f32_32x32x16_bf16 v[84:99], v[32:35], v[44:47], v[84:99]
    ds_read_b128 v[146:149], v126 offset:8192
    ds_read_b128 v[150:153], v126 offset:10240
    ds_read_b128 v[154:157], v126 offset:12288
    ds_read_b128 v[158:161], v126 offset:14336
    v_mfma_f32_32x32x16_bf16 v[100:115], v[32:35], v[48:51], v[100:115]
    ds_read_b128 v[162:165], v127 offset:0
    ds_read_b128 v[166:169], v127 offset:2048
    s_waitcnt lgkmcnt(0)
    v_mfma_f32_32x32x16_bf16 v[52:67], v[20:23], v[36:39], v[52:67]
    ds_read_b128 v[28:31], v11 offset:16384
    ds_read_b128 v[32:35], v15 offset:16384
    ds_read_b64_tr_b16 v[44:45], v18 offset:20480
    ds_read_b64 v[170:171], v128 offset:0
    ds_read_b64 v[172:173], v128 offset:1024
    v_mfma_f32_32x32x16_bf16 v[68:83], v[20:23], v[40:43], v[68:83]
    ds_read_b64_tr_b16 v[46:47], v18 offset:21504
    ds_read_b64_tr_b16 v[48:49], v19 offset:20480
    ds_read_b64_tr_b16 v[50:51], v19 offset:21504
    ds_read_b64 v[174:175], v128 offset:2048
    ds_read_b64 v[176:177], v128 offset:3072
    v_mfma_f32_32x32x16_bf16 v[84:99], v[24:27], v[36:39], v[84:99]
    ds_read_b64 v[178:179], v128 offset:4096
    ds_read_b64 v[180:181], v128 offset:5120
    ds_read_b64 v[182:183], v128 offset:6144
    ds_read_b64 v[184:185], v128 offset:7168
    v_mfma_f32_32x32x16_bf16 v[100:115], v[24:27], v[40:43], v[100:115]
    ds_read_b64 v[186:187], v128 offset:8192
    ds_read_b64 v[188:189], v128 offset:9216
    s_waitcnt lgkmcnt(0)
    v_mfma_f32_32x32x16_bf16 v[52:67], v[28:31], v[44:47], v[52:67]
    ds_read_b128 v[20:23], v12 offset:16384
    ds_read_b128 v[24:27], v16 offset:16384
    ds_read_b64_tr_b16 v[36:37], v18 offset:24576
    v_min_u32 v191, v131, v135
    v_max_u32 v192, v131, v135
    v_add_f32 v130, v130, v134
    v_mfma_f32_32x32x16_bf16 v[68:83], v[28:31], v[48:51], v[68:83]
    ds_read_b64_tr_b16 v[38:39], v18 offset:25600
    ds_read_b64_tr_b16 v[40:41], v19 offset:24576
    ds_read_b64_tr_b16 v[42:43], v19 offset:25600
    v_min3_u32 v191, v139, v143, v191
    v_add_f32 v132, v132, v136
    v_max3_u32 v192, v139, v143, v192
    v_mfma_f32_32x32x16_bf16 v[84:99], v[32:35], v[44:47], v[84:99]
    v_add_f32 v170, v170, v172
    v_min3_u32 v191, v147, v151, v191
    v_add_f32 v130, v130, v138
    v_max3_u32 v192, v147, v151, v192
    v_add_f32 v132, v132, v140
    v_min3_u32 v191, v155, v159, v191
    v_add_f32 v170, v170, v174
    v_max3_u32 v192, v155, v159, v192
    v_add_f32 v130, v130, v142
    v_mfma_f32_32x32x16_bf16 v[100:115], v[32:35], v[48:51], v[100:115]
    v_min3_u32 v191, v163, v167, v191
    v_add_f32 v132, v132, v144
    v_max3_u32 v192, v163, v167, v192
    v_add_f32 v170, v170, v176
    v_min3_u32 v191, v133, v137, v191
    v_add_f32 v130, v130, v146
    v_max3_u32 v192, v133, v137, v192
    v_add_f32 v132, v132, v148
    s_waitcnt lgkmcnt(0)
    v_mfma_f32_32x32x16_bf16 v[52:67], v[20:23], v[36:39], v[52:67]
    ds_read_b128 v[28:31], v13 offset:16384
    ds_read_b128 v[32:35], v17 offset:16384
    ds_read_b64_tr_b16 v[44:45], v18 offset:28672
    v_min3_u32 v191, v141, v145, v191
    v_add_f32 v170, v170, v178
    v_max3_u32 v192, v141, v145, v192
    v_mfma_f32_32x32x16_bf16 v[68:83], v[20:23], v[40:43], v[68:83]
    ds_read_b64_tr_b16 v[46:47], v18 offset:29696
    ds_read_b64_tr_b16 v[48:49], v19 offset:28672
    ds_read_b64_tr_b16 v[50:51], v19 offset:29696
    v_add_f32 v130, v130, v150
    v_min3_u32 v191, v149, v153, v191
    v_add_f32 v132, v132, v152
    v_mfma_f32_32x32x16_bf16 v[84:99], v[24:27], v[36:39], v[84:99]
    v_max3_u32 v192, v149, v153, v192
    v_add_f32 v170, v170, v180
    v_min3_u32 v191, v157, v161, v191
    v_add_f32 v130, v130, v154
    v_max3_u32 v192, v157, v161, v192
    v_add_f32 v132, v132, v156
    v_min3_u32 v191, v165, v169, v191
    v_add_f32 v170, v170, v182
    v_max3_u32 v192, v165, v169, v192
    v_mfma_f32_32x32x16_bf16 v[100:115], v[24:27], v[40:43], v[100:115]
    v_add_f32 v130, v130, v158
    v_min3_u32 v191, v171, v173, v191
    v_add_f32 v132, v132, v160
    v_max3_u32 v192, v171, v173, v192
    v_add_f32 v170, v170, v184
    v_min3_u32 v191, v175, v177, v191
    v_add_f32 v130, v130, v162
    v_max3_u32 v192, v175, v177, v192
    s_waitcnt lgkmcnt(0)
    s_barrier
    v_mfma_f32_32x32x16_bf16 v[52:67], v[28:31], v[44:47], v[52:67]
    v_add_f32 v132, v132, v164
    v_min3_u32 v191, v179, v181, v191
    v_add_f32 v170, v170, v186
    v_mfma_f32_32x32x16_bf16 v[68:83], v[28:31], v[48:51], v[68:83]
    v_max3_u32 v192, v179, v181, v192
    v_add_f32 v130, v130, v166
    v_min3_u32 v191, v183, v185, v191
    v_mfma_f32_32x32x16_bf16 v[84:99], v[32:35], v[44:47], v[84:99]
    v_add_f32 v132, v132, v168
    v_max3_u32 v192, v183, v185, v192
    v_add_f32 v170, v170, v188
    v_min3_u32 v191, v187, v189, v191
    v_max3_u32 v192, v187, v189, v192
    v_mul_f32 v130, 0x3acccccd, v130
    v_mul_f32 v132, 0x3acccccd, v132
    v_fma_f32 v132, -v130, v130, v132
    v_max_f32 v132, 0, v132
    v_mfma_f32_32x32x16_bf16 v[100:115], v[32:35], v[48:51], v[100:115]
    v_add_f32 v132, 0x3727c5ac, v132
    v_rsq_f32 v132, v132
    v_xor_b32 v191, v191, v190
    v_xor_b32 v192, v192, v190
    v_mul_f32 v130, v130, v132
    v_or_b32 v191, v191, v192
    v_sub_f32 v130, 0, v130
    v_cmp_ne_u32 vcc, 0, v191
    s_cmp_eq_u64 vcc, 0
    s_cbranch_scc1 st_ok_6
    s_mov_b32 s70, 50000
st_retry_7:
    s_mov_b32 s69, 0
    buffer_load_dwordx4 v[130:133], v124, s[36:39], s69 offen sc1
    s_mov_b32 s69, 0
    buffer_load_dwordx2 v[170:171], v125, s[36:39], s69 offen sc1
    s_mov_b32 s69, 2048
    buffer_load_dwordx4 v[134:137], v124, s[36:39], s69 offen sc1
    s_mov_b32 s69, 1024
    buffer_load_dwordx2 v[172:173], v125, s[36:39], s69 offen sc1
    s_mov_b32 s69, 4096
    buffer_load_dwordx4 v[138:141], v124, s[36:39], s69 offen sc1
    s_mov_b32 s69, 2048
    buffer_load_dwordx2 v[174:175], v125, s[36:39], s69 offen sc1
    s_mov_b32 s69, 6144
    buffer_load_dwordx4 v[142:145], v124, s[36:39], s69 offen sc1
    s_mov_b32 s69, 3072
    buffer_load_dwordx2 v[176:177], v125, s[36:39], s69 offen sc1
    s_mov_b32 s69, 8192
    buffer_load_dwordx4 v[146:149], v124, s[36:39], s69 offen sc1
    s_mov_b32 s69, 4096
    buffer_load_dwordx2 v[178:179], v125, s[36:39], s69 offen sc1
    s_mov_b32 s69, 10240
    buffer_load_dwordx4 v[150:153], v124, s[36:39], s69 offen sc1
    s_mov_b32 s69, 5120
    buffer_load_dwordx2 v[180:181], v125, s[36:39], s69 offen sc1
    s_mov_b32 s69, 12288
    buffer_load_dwordx4 v[154:157], v124, s[36:39], s69 offen sc1
    s_mov_b32 s69, 6144
    buffer_load_dwordx2 v[182:183], v125, s[36:39], s69 offen sc1
    s_mov_b32 s69, 14336
    buffer_load_dwordx4 v[158:161], v124, s[36:39], s69 offen sc1
    s_mov_b32 s69, 7168
    buffer_load_dwordx2 v[184:185], v125, s[36:39], s69 offen sc1
    s_mov_b32 s69, 16384
    buffer_load_dwordx4 v[162:165], v124, s[36:39], s69 offen sc1
    s_mov_b32 s69, 8192
    buffer_load_dwordx2 v[186:187], v125, s[36:39], s69 offen sc1
    s_mov_b32 s69, 18432
    buffer_load_dwordx4 v[166:169], v124, s[36:39], s69 offen sc1
    s_mov_b32 s69, 9216
    buffer_load_dwordx2 v[188:189], v125, s[36:39], s69 offen sc1
    s_waitcnt vmcnt(0)
    v_min_u32 v191, v131, v135
    v_max_u32 v192, v131, v135
    v_add_f32 v130, v130, v134
    v_min3_u32 v191, v139, v143, v191
    v_add_f32 v132, v132, v136
    v_max3_u32 v192, v139, v143, v192
    v_add_f32 v170, v170, v172
    v_min3_u32 v191, v147, v151, v191
    v_add_f32 v130, v130, v138
    v_max3_u32 v192, v147, v151, v192
    v_add_f32 v132, v132, v140
    v_min3_u32 v191, v155, v159, v191
    v_add_f32 v170, v170, v174
    v_max3_u32 v192, v155, v159, v192
    v_add_f32 v130, v130, v142
    v_min3_u32 v191, v163, v167, v191
    v_add_f32 v132, v132, v144
    v_max3_u32 v192, v163, v167, v192
    v_add_f32 v170, v170, v176
    v_min3_u32 v191, v133, v137, v191
    v_add_f32 v130, v130, v146
    v_max3_u32 v192, v133, v137, v192
    v_add_f32 v132, v132, v148
    v_min3_u32 v191, v141, v145, v191
    v_add_f32 v170, v170, v178
    v_max3_u32 v192, v141, v145, v192
    v_add_f32 v130, v130, v150
    v_min3_u32 v191, v149, v153, v191
    v_add_f32 v132, v132, v152
    v_max3_u32 v192, v149, v153, v192
    v_add_f32 v170, v170, v180
    v_min3_u32 v191, v157, v161, v191
    v_add_f32 v130, v130, v154
    v_max3_u32 v192, v157, v161, v192
    v_add_f32 v132, v132, v156
    v_min3_u32 v191, v165, v169, v191
    v_add_f32 v170, v170, v182
    v_max3_u32 v192, v165, v169, v192
    v_add_f32 v130, v130, v158
    v_min3_u32 v191, v171, v173, v191
    v_add_f32 v132, v132, v160
    v_max3_u32 v192, v171, v173, v192
    v_add_f32 v170, v170, v184
    v_min3_u32 v191, v175, v177, v191
    v_add_f32 v130, v130, v162
    v_max3_u32 v192, v175, v177, v192
    v_add_f32 v132, v132, v164
    v_min3_u32 v191, v179, v181, v191
    v_add_f32 v170, v170, v186
    v_max3_u32 v192, v179, v181, v192
    v_add_f32 v130, v130, v166
    v_min3_u32 v191, v183, v185, v191
    v_add_f32 v132, v132, v168
    v_max3_u32 v192, v183, v185, v192
    v_add_f32 v170, v170, v188
    v_min3_u32 v191, v187, v189, v191
    v_max3_u32 v192, v187, v189, v192
    v_mul_f32 v130, 0x3acccccd, v130
    v_mul_f32 v132, 0x3acccccd, v132
    v_fma_f32 v132, -v130, v130, v132
    v_max_f32 v132, 0, v132
    v_add_f32 v132, 0x3727c5ac, v132
    v_rsq_f32 v132, v132
    s_nop 0
    v_xor_b32 v191, v191, v190
    v_xor_b32 v192, v192, v190
    v_mul_f32 v130, v130, v132
    v_or_b32 v191, v191, v192
    v_sub_f32 v130, 0, v130
    v_cmp_ne_u32 vcc, 0, v191
    s_cmp_eq_u64 vcc, 0
    s_cbranch_scc1 st_ok_6
    s_sub_u32 s70, s70, 1
    s_cmp_lg_u32 s70, 0
    s_cbranch_scc1 st_retry_7
st_ok_6:
    v_mov_b32 v198, v170
    v_mov_b32 v200, v170
    s_nop 1
    v_permlane32_swap_b32 v198, v200
    v_lshl_add_u32 v208, v1, 2, s73
    ds_write_b32 v208, v132
    ds_write_b32 v208, v130 offset:256
    v_lshl_add_u32 v208, v9, 4, s73
    s_waitcnt lgkmcnt(0)
    ds_read_b128 v[134:137], v208 offset:0
    ds_read_b128 v[150:153], v208 offset:256
    ds_read_b128 v[138:141], v208 offset:32
    ds_read_b128 v[154:157], v208 offset:288
    ds_read_b128 v[142:145], v208 offset:64
    ds_read_b128 v[158:161], v208 offset:320
    ds_read_b128 v[146:149], v208 offset:96
    ds_read_b128 v[162:165], v208 offset:352
    s_waitcnt lgkmcnt(0)
    v_pk_mul_f32 v[172:173], v[150:151], v[198:199] op_sel_hi:[1,0]
    v_pk_mul_f32 v[174:175], v[152:153], v[198:199] op_sel_hi:[1,0]
    v_pk_mul_f32 v[176:177], v[154:155], v[198:199] op_sel_hi:[1,0]
    v_pk_fma_f32 v[52:53], v[52:53], v[134:135], v[172:173]
    v_pk_mul_f32 v[178:179], v[156:157], v[198:199] op_sel_hi:[1,0]
    v_pk_fma_f32 v[54:55], v[54:55], v[136:137], v[174:175]
    v_pk_mul_f32 v[172:173], v[158:159], v[198:199] op_sel_hi:[1,0]
    v_pk_fma_f32 v[56:57], v[56:57], v[138:139], v[176:177]
    v_pk_mul_f32 v[174:175], v[160:161], v[198:199] op_sel_hi:[1,0]
    v_pk_fma_f32 v[58:59], v[58:59], v[140:141], v[178:179]
    v_pk_mul_f32 v[176:177], v[162:163], v[198:199] op_sel_hi:[1,0]
    v_pk_fma_f32 v[60:61], v[60:61], v[142:143], v[172:173]
    v_pk_mul_f32 v[178:179], v[164:165], v[198:199] op_sel_hi:[1,0]
    v_pk_fma_f32 v[62:63], v[62:63], v[144:145], v[174:175]
    v_pk_fma_f32 v[64:65], v[64:65], v[146:147], v[176:177]
    v_pk_fma_f32 v[66:67], v[66:67], v[148:149], v[178:179]
    v_cvt_pk_bf16_f32 v180, v52, v53
    v_cvt_pk_bf16_f32 v181, v54, v55
    v_cvt_pk_bf16_f32 v182, v56, v57
    v_cvt_pk_bf16_f32 v183, v58, v59
    v_cvt_pk_bf16_f32 v184, v60, v61
    v_cvt_pk_bf16_f32 v185, v62, v63
    v_cvt_pk_bf16_f32 v186, v64, v65
    v_cvt_pk_bf16_f32 v187, v66, v67
    s_nop 1
    v_permlane32_swap_b32 v180, v182
    v_permlane32_swap_b32 v181, v183
    v_permlane32_swap_b32 v184, v186
    v_permlane32_swap_b32 v185, v187
    buffer_store_dwordx4 v[180:183], v206, s[32:35], s74 offen sc1
    buffer_store_dwordx4 v[184:187], v206, s[32:35], s75 offen sc1
    v_pk_mul_f32 v[172:173], v[150:151], v[200:201] op_sel_hi:[1,0]
    v_pk_mul_f32 v[174:175], v[152:153], v[200:201] op_sel_hi:[1,0]
    v_pk_mul_f32 v[176:177], v[154:155], v[200:201] op_sel_hi:[1,0]
    v_pk_fma_f32 v[68:69], v[68:69], v[134:135], v[172:173]
    v_pk_mul_f32 v[178:179], v[156:157], v[200:201] op_sel_hi:[1,0]
    v_pk_fma_f32 v[70:71], v[70:71], v[136:137], v[174:175]
    v_pk_mul_f32 v[172:173], v[158:159], v[200:201] op_sel_hi:[1,0]
    v_pk_fma_f32 v[72:73], v[72:73], v[138:139], v[176:177]
    v_pk_mul_f32 v[174:175], v[160:161], v[200:201] op_sel_hi:[1,0]
    v_pk_fma_f32 v[74:75], v[74:75], v[140:141], v[178:179]
    v_pk_mul_f32 v[176:177], v[162:163], v[200:201] op_sel_hi:[1,0]
    v_pk_fma_f32 v[76:77], v[76:77], v[142:143], v[172:173]
    v_pk_mul_f32 v[178:179], v[164:165], v[200:201] op_sel_hi:[1,0]
    v_pk_fma_f32 v[78:79], v[78:79], v[144:145], v[174:175]
    v_pk_fma_f32 v[80:81], v[80:81], v[146:147], v[176:177]
    v_pk_fma_f32 v[82:83], v[82:83], v[148:149], v[178:179]
    v_cvt_pk_bf16_f32 v180, v68, v69
    v_cvt_pk_bf16_f32 v181, v70, v71
    v_cvt_pk_bf16_f32 v182, v72, v73
    v_cvt_pk_bf16_f32 v183, v74, v75
    v_cvt_pk_bf16_f32 v184, v76, v77
    v_cvt_pk_bf16_f32 v185, v78, v79
    v_cvt_pk_bf16_f32 v186, v80, v81
    v_cvt_pk_bf16_f32 v187, v82, v83
    s_nop 1
    v_permlane32_swap_b32 v180, v182
    v_permlane32_swap_b32 v181, v183
    v_permlane32_swap_b32 v184, v186
    v_permlane32_swap_b32 v185, v187
    buffer_store_dwordx4 v[180:183], v207, s[32:35], s74 offen sc1
    buffer_store_dwordx4 v[184:187], v207, s[32:35], s75 offen sc1
    ds_read_b128 v[134:137], v208 offset:128
    ds_read_b128 v[150:153], v208 offset:384
    ds_read_b128 v[138:141], v208 offset:160
    ds_read_b128 v[154:157], v208 offset:416
    ds_read_b128 v[142:145], v208 offset:192
    ds_read_b128 v[158:161], v208 offset:448
    ds_read_b128 v[146:149], v208 offset:224
    ds_read_b128 v[162:165], v208 offset:480
    s_waitcnt lgkmcnt(0)
    v_pk_mul_f32 v[172:173], v[150:151], v[198:199] op_sel_hi:[1,0]
    v_pk_mul_f32 v[174:175], v[152:153], v[198:199] op_sel_hi:[1,0]
    v_pk_mul_f32 v[176:177], v[154:155], v[198:199] op_sel_hi:[1,0]
    v_pk_fma_f32 v[84:85], v[84:85], v[134:135], v[172:173]
    v_pk_mul_f32 v[178:179], v[156:157], v[198:199] op_sel_hi:[1,0]
    v_pk_fma_f32 v[86:87], v[86:87], v[136:137], v[174:175]
    v_pk_mul_f32 v[172:173], v[158:159], v[198:199] op_sel_hi:[1,0]
    v_pk_fma_f32 v[88:89], v[88:89], v[138:139], v[176:177]
    v_pk_mul_f32 v[174:175], v[160:161], v[198:199] op_sel_hi:[1,0]
    v_pk_fma_f32 v[90:91], v[90:91], v[140:141], v[178:179]
    v_pk_mul_f32 v[176:177], v[162:163], v[198:199] op_sel_hi:[1,0]
    v_pk_fma_f32 v[92:93], v[92:93], v[142:143], v[172:173]
    v_pk_mul_f32 v[178:179], v[164:165], v[198:199] op_sel_hi:[1,0]
    v_pk_fma_f32 v[94:95], v[94:95], v[144:145], v[174:175]
    v_pk_fma_f32 v[96:97], v[96:97], v[146:147], v[176:177]
    v_pk_fma_f32 v[98:99], v[98:99], v[148:149], v[178:179]
    v_cvt_pk_bf16_f32 v180, v84, v85
    v_cvt_pk_bf16_f32 v181, v86, v87
    v_cvt_pk_bf16_f32 v182, v88, v89
    v_cvt_pk_bf16_f32 v183, v90, v91
    v_cvt_pk_bf16_f32 v184, v92, v93
    v_cvt_pk_bf16_f32 v185, v94, v95
    v_cvt_pk_bf16_f32 v186, v96, v97
    v_cvt_pk_bf16_f32 v187, v98, v99
    s_nop 1
    v_permlane32_swap_b32 v180, v182
    v_permlane32_swap_b32 v181, v183
    v_permlane32_swap_b32 v184, v186
    v_permlane32_swap_b32 v185, v187
    buffer_store_dwordx4 v[180:183], v206, s[32:35], s76 offen sc1
    buffer_store_dwordx4 v[184:187], v206, s[32:35], s77 offen sc1
    v_pk_mul_f32 v[172:173], v[150:151], v[200:201] op_sel_hi:[1,0]
    v_pk_mul_f32 v[174:175], v[152:153], v[200:201] op_sel_hi:[1,0]
    v_pk_mul_f32 v[176:177], v[154:155], v[200:201] op_sel_hi:[1,0]
    v_pk_fma_f32 v[100:101], v[100:101], v[134:135], v[172:173]
    v_pk_mul_f32 v[178:179], v[156:157], v[200:201] op_sel_hi:[1,0]
    v_pk_fma_f32 v[102:103], v[102:103], v[136:137], v[174:175]
    v_pk_mul_f32 v[172:173], v[158:159], v[200:201] op_sel_hi:[1,0]
    v_pk_fma_f32 v[104:105], v[104:105], v[138:139], v[176:177]
    v_pk_mul_f32 v[174:175], v[160:161], v[200:201] op_sel_hi:[1,0]
    v_pk_fma_f32 v[106:107], v[106:107], v[140:141], v[178:179]
    v_pk_mul_f32 v[176:177], v[162:163], v[200:201] op_sel_hi:[1,0]
    v_pk_fma_f32 v[108:109], v[108:109], v[142:143], v[172:173]
    v_pk_mul_f32 v[178:179], v[164:165], v[200:201] op_sel_hi:[1,0]
    v_pk_fma_f32 v[110:111], v[110:111], v[144:145], v[174:175]
    v_pk_fma_f32 v[112:113], v[112:113], v[146:147], v[176:177]
    v_pk_fma_f32 v[114:115], v[114:115], v[148:149], v[178:179]
    v_cvt_pk_bf16_f32 v180, v100, v101
    v_cvt_pk_bf16_f32 v181, v102, v103
    v_cvt_pk_bf16_f32 v182, v104, v105
    v_cvt_pk_bf16_f32 v183, v106, v107
    v_cvt_pk_bf16_f32 v184, v108, v109
    v_cvt_pk_bf16_f32 v185, v110, v111
    v_cvt_pk_bf16_f32 v186, v112, v113
    v_cvt_pk_bf16_f32 v187, v114, v115
    s_nop 1
    v_permlane32_swap_b32 v180, v182
    v_permlane32_swap_b32 v181, v183
    v_permlane32_swap_b32 v184, v186
    v_permlane32_swap_b32 v185, v187
    buffer_store_dwordx4 v[180:183], v207, s[32:35], s76 offen sc1
    buffer_store_dwordx4 v[184:187], v207, s[32:35], s77 offen sc1
qkv_end_3:
    s_add_u32 s78, s52, 0
    s_lshl_b32 s78, s78, 8
    s_lshl_b32 s79, s53, 2
    s_add_u32 s78, s78, s79
    s_waitcnt vmcnt(0)
    v_mov_b32 v209, 3840
    v_mov_b32 v210, 1
    s_mov_b64 exec, 1
    ds_add_rtn_u32 v210, v209, v210
    s_waitcnt lgkmcnt(0)
    v_cmp_eq_u32 vcc, 3, v210
    s_cmp_eq_u64 vcc, 0
    s_cbranch_scc1 nopub_8
    v_add_u32 v210, 1, v2
    v_mov_b32 v209, s78
    buffer_store_dword v210, v209, s[48:51], 0 offen sc1
nopub_8:
    s_mov_b64 exec, -1
    s_branch sequential_preLN__sliding_block__dense_activation_squared_relu__prompt_kernel_att
sequential_preLN__sliding_block__dense_activation_squared_relu__prompt_kernel_inactive:
    s_waitcnt lgkmcnt(0)
    s_add_u32 s48, s22, 21168128
    s_addc_u32 s49, s23, 0
    s_and_b32 s49, s49, 0xffff
    s_mov_b32 s50, 33024
    s_mov_b32 s51, 0x20000
    v_mov_b32 v2, 32768
    buffer_load_dword v2, v2, s[48:51], 0 offen sc1
    s_branch sequential_preLN__sliding_block__dense_activation_squared_relu__prompt_kernel_att
sequential_preLN__sliding_block__dense_activation_squared_relu__prompt_kernel_loader:
    s_cmp_ge_u32 s53, 15
    s_cbranch_scc1 sequential_preLN__sliding_block__dense_activation_squared_relu__prompt_kernel_inactive
    s_lshl_b32 s59, s52, 7
    s_lshl_b32 s60, s53, 8
    s_add_u32 s61, s52, s53
    s_mul_i32 s62, s61, 26
    s_lshr_b32 s62, s62, 8
    s_mul_i32 s62, s62, 10
    s_sub_u32 s61, s61, s62
    s_sub_u32 s63, s24, 4
    v_lshrrev_b32 v4, 4, v1
    v_and_b32 v5, 15, v1
    v_lshlrev_b32 v6, 2, v4
    v_xor_b32 v5, v5, v6
    s_lshl_b32 s64, s63, 4
    v_add_u32 v4, s64, v4
    v_mul_u32_u24 v4, 3840, v4
    v_lshl_add_u32 v4, v5, 4, v4
    v_add_u32 v7, s60, v4
    s_lshl_b32 s66, s63, 12
    s_lshl_b32 s67, s63, 12
    v_lshrrev_b32 v4, 3, v1
    s_lshl_b32 s64, s63, 5
    s_add_u32 s64, s64, s59
    v_add_u32 v4, s64, v4
    v_mul_u32_u24 v4, 1280, v4
    v_and_b32 v5, 7, v1
    v_lshrrev_b32 v6, 4, v1
    v_xor_b32 v5, v5, v6
    v_lshl_add_u32 v8, v5, 4, v4
    v_xor_b32 v5, 4, v5
    v_lshl_add_u32 v9, v5, 4, v4
    s_mul_i32 s68, s61, 128
    s_mul_i32 s69, s61, 245760
    s_sub_u32 s72, s24, 4
    s_lshl_b32 s72, s72, 10
    v_lshl_add_u32 v10, v1, 4, s72
    s_mul_i32 s70, s52, 20480
    s_add_u32 s70, s70, 0
    s_mul_i32 s71, s53, 10240
    s_add_u32 s71, s71, 327680
    s_waitcnt lgkmcnt(0)
    s_add_u32 s48, s22, 21168128
    s_addc_u32 s49, s23, 0
    s_and_b32 s49, s49, 0xffff
    s_mov_b32 s50, 33024
    s_mov_b32 s51, 0x20000
    v_mov_b32 v2, 32768
    buffer_load_dword v2, v2, s[48:51], 0 offen sc1
    s_mov_b32 s28, s4
    s_and_b32 s29, s5, 0xffff
    s_mov_b32 s30, 2621440
    s_mov_b32 s31, 0x20000
    s_mov_b32 s32, s6
    s_and_b32 s33, s7, 0xffff
    s_mov_b32 s34, 2457600
    s_mov_b32 s35, 0x20000
    s_add_u32 s36, s22, 20185088
    s_addc_u32 s37, s23, 0
    s_and_b32 s37, s37, 0xffff
    s_mov_b32 s38, 983040
    s_mov_b32 s39, 0x20000
    s_add_u32 m0, s66, 75776
    s_add_u32 s65, s69, 0
    buffer_load_dwordx4 v7, s[32:35], s65 offen lds
    s_add_u32 m0, s66, 76800
    s_add_u32 s65, s69, 15360
    buffer_load_dwordx4 v7, s[32:35], s65 offen lds
    s_add_u32 m0, s66, 77824
    s_add_u32 s65, s69, 30720
    buffer_load_dwordx4 v7, s[32:35], s65 offen lds
    s_add_u32 m0, s66, 78848
    s_add_u32 s65, s69, 46080
    buffer_load_dwordx4 v7, s[32:35], s65 offen lds
    s_add_u32 s69, s69, 245760
    s_cmp_ge_u32 s69, 2457600
    s_cselect_b32 s65, 2457600, 0
    s_sub_u32 s69, s69, s65
    s_add_u32 m0, s67, 4096
    s_add_u32 s65, s68, 0
    buffer_load_dwordx4 v8, s[28:31], s65 offen  lds
    s_add_u32 m0, s67, 5120
    s_add_u32 s65, s68, 10240
    buffer_load_dwordx4 v9, s[28:31], s65 offen  lds
    s_add_u32 m0, s67, 6144
    s_add_u32 s65, s68, 20480
    buffer_load_dwordx4 v8, s[28:31], s65 offen  lds
    s_add_u32 m0, s67, 7168
    s_add_u32 s65, s68, 30720
    buffer_load_dwordx4 v9, s[28:31], s65 offen  lds
    s_add_u32 s68, s68, 128
    s_cmp_ge_u32 s68, 1280
    s_cselect_b32 s65, 1280, 0
    s_sub_u32 s68, s68, s65
    s_add_u32 m0, s66, 92160
    s_add_u32 s65, s69, 0
    buffer_load_dwordx4 v7, s[32:35], s65 offen lds
    s_add_u32 m0, s66, 93184
    s_add_u32 s65, s69, 15360
    buffer_load_dwordx4 v7, s[32:35], s65 offen lds
    s_add_u32 m0, s66, 94208
    s_add_u32 s65, s69, 30720
    buffer_load_dwordx4 v7, s[32:35], s65 offen lds
    s_add_u32 m0, s66, 95232
    s_add_u32 s65, s69, 46080
    buffer_load_dwordx4 v7, s[32:35], s65 offen lds
    s_add_u32 s69, s69, 245760
    s_cmp_ge_u32 s69, 2457600
    s_cselect_b32 s65, 2457600, 0
    s_sub_u32 s69, s69, s65
    s_add_u32 m0, s67, 20480
    s_add_u32 s65, s68, 0
    buffer_load_dwordx4 v8, s[28:31], s65 offen  lds
    s_add_u32 m0, s67, 21504
    s_add_u32 s65, s68, 10240
    buffer_load_dwordx4 v9, s[28:31], s65 offen  lds
    s_add_u32 m0, s67, 22528
    s_add_u32 s65, s68, 20480
    buffer_load_dwordx4 v8, s[28:31], s65 offen  lds
    s_add_u32 m0, s67, 23552
    s_add_u32 s65, s68, 30720
    buffer_load_dwordx4 v9, s[28:31], s65 offen  lds
    s_add_u32 s68, s68, 128
    s_cmp_ge_u32 s68, 1280
    s_cselect_b32 s65, 1280, 0
    s_sub_u32 s68, s68, s65
    s_add_u32 m0, s66, 108544
    s_add_u32 s65, s69, 0
    buffer_load_dwordx4 v7, s[32:35], s65 offen lds
    s_add_u32 m0, s66, 109568
    s_add_u32 s65, s69, 15360
    buffer_load_dwordx4 v7, s[32:35], s65 offen lds
    s_add_u32 m0, s66, 110592
    s_add_u32 s65, s69, 30720
    buffer_load_dwordx4 v7, s[32:35], s65 offen lds
    s_add_u32 m0, s66, 111616
    s_add_u32 s65, s69, 46080
    buffer_load_dwordx4 v7, s[32:35], s65 offen lds
    s_add_u32 s69, s69, 245760
    s_cmp_ge_u32 s69, 2457600
    s_cselect_b32 s65, 2457600, 0
    s_sub_u32 s69, s69, s65
    s_add_u32 m0, s67, 36864
    s_add_u32 s65, s68, 0
    buffer_load_dwordx4 v8, s[28:31], s65 offen  lds
    s_add_u32 m0, s67, 37888
    s_add_u32 s65, s68, 10240
    buffer_load_dwordx4 v9, s[28:31], s65 offen  lds
    s_add_u32 m0, s67, 38912
    s_add_u32 s65, s68, 20480
    buffer_load_dwordx4 v8, s[28:31], s65 offen  lds
    s_add_u32 m0, s67, 39936
    s_add_u32 s65, s68, 30720
    buffer_load_dwordx4 v9, s[28:31], s65 offen  lds
    s_add_u32 s68, s68, 128
    s_cmp_ge_u32 s68, 1280
    s_cselect_b32 s65, 1280, 0
    s_sub_u32 s68, s68, s65
    s_add_u32 m0, s66, 124928
    s_add_u32 s65, s69, 0
    buffer_load_dwordx4 v7, s[32:35], s65 offen lds
    s_add_u32 m0, s66, 125952
    s_add_u32 s65, s69, 15360
    buffer_load_dwordx4 v7, s[32:35], s65 offen lds
    s_add_u32 m0, s66, 126976
    s_add_u32 s65, s69, 30720
    buffer_load_dwordx4 v7, s[32:35], s65 offen lds
    s_add_u32 m0, s66, 128000
    s_add_u32 s65, s69, 46080
    buffer_load_dwordx4 v7, s[32:35], s65 offen lds
    s_add_u32 s69, s69, 245760
    s_cmp_ge_u32 s69, 2457600
    s_cselect_b32 s65, 2457600, 0
    s_sub_u32 s69, s69, s65
    s_add_u32 m0, s67, 53248
    s_add_u32 s65, s68, 0
    buffer_load_dwordx4 v8, s[28:31], s65 offen  lds
    s_add_u32 m0, s67, 54272
    s_add_u32 s65, s68, 10240
    buffer_load_dwordx4 v9, s[28:31], s65 offen  lds
    s_add_u32 m0, s67, 55296
    s_add_u32 s65, s68, 20480
    buffer_load_dwordx4 v8, s[28:31], s65 offen  lds
    s_add_u32 m0, s67, 56320
    s_add_u32 s65, s68, 30720
    buffer_load_dwordx4 v9, s[28:31], s65 offen  lds
    s_add_u32 s68, s68, 128
    s_cmp_ge_u32 s68, 1280
    s_cselect_b32 s65, 1280, 0
    s_sub_u32 s68, s68, s65
    s_waitcnt vmcnt(24)
    s_barrier
    s_waitcnt vmcnt(16)
    s_barrier
    s_add_u32 m0, s66, 75776
    s_add_u32 s65, s69, 0
    buffer_load_dwordx4 v7, s[32:35], s65 offen lds
    s_add_u32 m0, s66, 76800
    s_add_u32 s65, s69, 15360
    buffer_load_dwordx4 v7, s[32:35], s65 offen lds
    s_add_u32 m0, s66, 77824
    s_add_u32 s65, s69, 30720
    buffer_load_dwordx4 v7, s[32:35], s65 offen lds
    s_add_u32 m0, s66, 78848
    s_add_u32 s65, s69, 46080
    buffer_load_dwordx4 v7, s[32:35], s65 offen lds
    s_add_u32 s69, s69, 245760
    s_cmp_ge_u32 s69, 2457600
    s_cselect_b32 s65, 2457600, 0
    s_sub_u32 s69, s69, s65
    s_add_u32 m0, s67, 4096
    s_add_u32 s65, s68, 0
    buffer_load_dwordx4 v8, s[28:31], s65 offen  lds
    s_add_u32 m0, s67, 5120
    s_add_u32 s65, s68, 10240
    buffer_load_dwordx4 v9, s[28:31], s65 offen  lds
    s_add_u32 m0, s67, 6144
    s_add_u32 s65, s68, 20480
    buffer_load_dwordx4 v8, s[28:31], s65 offen  lds
    s_add_u32 m0, s67, 7168
    s_add_u32 s65, s68, 30720
    buffer_load_dwordx4 v9, s[28:31], s65 offen  lds
    s_add_u32 s68, s68, 128
    s_cmp_ge_u32 s68, 1280
    s_cselect_b32 s65, 1280, 0
    s_sub_u32 s68, s68, s65
    s_waitcnt vmcnt(16)
    s_barrier
    s_add_u32 m0, s66, 92160
    s_add_u32 s65, s69, 0
    buffer_load_dwordx4 v7, s[32:35], s65 offen lds
    s_add_u32 m0, s66, 93184
    s_add_u32 s65, s69, 15360
    buffer_load_dwordx4 v7, s[32:35], s65 offen lds
    s_add_u32 m0, s66, 94208
    s_add_u32 s65, s69, 30720
    buffer_load_dwordx4 v7, s[32:35], s65 offen lds
    s_add_u32 m0, s66, 95232
    s_add_u32 s65, s69, 46080
    buffer_load_dwordx4 v7, s[32:35], s65 offen lds
    s_add_u32 s69, s69, 245760
    s_cmp_ge_u32 s69, 2457600
    s_cselect_b32 s65, 2457600, 0
    s_sub_u32 s69, s69, s65
    s_add_u32 m0, s67, 20480
    s_add_u32 s65, s68, 0
    buffer_load_dwordx4 v8, s[28:31], s65 offen  lds
    s_add_u32 m0, s67, 21504
    s_add_u32 s65, s68, 10240
    buffer_load_dwordx4 v9, s[28:31], s65 offen  lds
    s_add_u32 m0, s67, 22528
    s_add_u32 s65, s68, 20480
    buffer_load_dwordx4 v8, s[28:31], s65 offen  lds
    s_add_u32 m0, s67, 23552
    s_add_u32 s65, s68, 30720
    buffer_load_dwordx4 v9, s[28:31], s65 offen  lds
    s_add_u32 s68, s68, 128
    s_cmp_ge_u32 s68, 1280
    s_cselect_b32 s65, 1280, 0
    s_sub_u32 s68, s68, s65
    s_waitcnt vmcnt(16)
    s_barrier
    s_add_u32 m0, s66, 108544
    s_add_u32 s65, s69, 0
    buffer_load_dwordx4 v7, s[32:35], s65 offen lds
    s_add_u32 m0, s66, 109568
    s_add_u32 s65, s69, 15360
    buffer_load_dwordx4 v7, s[32:35], s65 offen lds
    s_add_u32 m0, s66, 110592
    s_add_u32 s65, s69, 30720
    buffer_load_dwordx4 v7, s[32:35], s65 offen lds
    s_add_u32 m0, s66, 111616
    s_add_u32 s65, s69, 46080
    buffer_load_dwordx4 v7, s[32:35], s65 offen lds
    s_add_u32 s69, s69, 245760
    s_cmp_ge_u32 s69, 2457600
    s_cselect_b32 s65, 2457600, 0
    s_sub_u32 s69, s69, s65
    s_add_u32 m0, s67, 36864
    s_add_u32 s65, s68, 0
    buffer_load_dwordx4 v8, s[28:31], s65 offen  lds
    s_add_u32 m0, s67, 37888
    s_add_u32 s65, s68, 10240
    buffer_load_dwordx4 v9, s[28:31], s65 offen  lds
    s_add_u32 m0, s67, 38912
    s_add_u32 s65, s68, 20480
    buffer_load_dwordx4 v8, s[28:31], s65 offen  lds
    s_add_u32 m0, s67, 39936
    s_add_u32 s65, s68, 30720
    buffer_load_dwordx4 v9, s[28:31], s65 offen  lds
    s_add_u32 s68, s68, 128
    s_cmp_ge_u32 s68, 1280
    s_cselect_b32 s65, 1280, 0
    s_sub_u32 s68, s68, s65
    s_waitcnt vmcnt(16)
    s_barrier
    s_add_u32 m0, s66, 124928
    s_add_u32 s65, s69, 0
    buffer_load_dwordx4 v7, s[32:35], s65 offen lds
    s_add_u32 m0, s66, 125952
    s_add_u32 s65, s69, 15360
    buffer_load_dwordx4 v7, s[32:35], s65 offen lds
    s_add_u32 m0, s66, 126976
    s_add_u32 s65, s69, 30720
    buffer_load_dwordx4 v7, s[32:35], s65 offen lds
    s_add_u32 m0, s66, 128000
    s_add_u32 s65, s69, 46080
    buffer_load_dwordx4 v7, s[32:35], s65 offen lds
    s_add_u32 s69, s69, 245760
    s_cmp_ge_u32 s69, 2457600
    s_cselect_b32 s65, 2457600, 0
    s_sub_u32 s69, s69, s65
    s_add_u32 m0, s67, 53248
    s_add_u32 s65, s68, 0
    buffer_load_dwordx4 v8, s[28:31], s65 offen  lds
    s_add_u32 m0, s67, 54272
    s_add_u32 s65, s68, 10240
    buffer_load_dwordx4 v9, s[28:31], s65 offen  lds
    s_add_u32 m0, s67, 55296
    s_add_u32 s65, s68, 20480
    buffer_load_dwordx4 v8, s[28:31], s65 offen  lds
    s_add_u32 m0, s67, 56320
    s_add_u32 s65, s68, 30720
    buffer_load_dwordx4 v9, s[28:31], s65 offen  lds
    s_add_u32 s68, s68, 128
    s_cmp_ge_u32 s68, 1280
    s_cselect_b32 s65, 1280, 0
    s_sub_u32 s68, s68, s65
    s_waitcnt vmcnt(16)
    s_barrier
    s_add_u32 m0, s66, 75776
    s_add_u32 s65, s69, 0
    buffer_load_dwordx4 v7, s[32:35], s65 offen lds
    s_add_u32 m0, s66, 76800
    s_add_u32 s65, s69, 15360
    buffer_load_dwordx4 v7, s[32:35], s65 offen lds
    s_add_u32 m0, s66, 77824
    s_add_u32 s65, s69, 30720
    buffer_load_dwordx4 v7, s[32:35], s65 offen lds
    s_add_u32 m0, s66, 78848
    s_add_u32 s65, s69, 46080
    buffer_load_dwordx4 v7, s[32:35], s65 offen lds
    s_add_u32 s69, s69, 245760
    s_cmp_ge_u32 s69, 2457600
    s_cselect_b32 s65, 2457600, 0
    s_sub_u32 s69, s69, s65
    s_add_u32 m0, s67, 4096
    s_add_u32 s65, s68, 0
    buffer_load_dwordx4 v8, s[28:31], s65 offen  lds
    s_add_u32 m0, s67, 5120
    s_add_u32 s65, s68, 10240
    buffer_load_dwordx4 v9, s[28:31], s65 offen  lds
    s_add_u32 m0, s67, 6144
    s_add_u32 s65, s68, 20480
    buffer_load_dwordx4 v8, s[28:31], s65 offen  lds
    s_add_u32 m0, s67, 7168
    s_add_u32 s65, s68, 30720
    buffer_load_dwordx4 v9, s[28:31], s65 offen  lds
    s_add_u32 s68, s68, 128
    s_cmp_ge_u32 s68, 1280
    s_cselect_b32 s65, 1280, 0
    s_sub_u32 s68, s68, s65
    s_waitcnt vmcnt(16)
    s_barrier
    s_add_u32 m0, s66, 92160
    s_add_u32 s65, s69, 0
    buffer_load_dwordx4 v7, s[32:35], s65 offen lds
    s_add_u32 m0, s66, 93184
    s_add_u32 s65, s69, 15360
    buffer_load_dwordx4 v7, s[32:35], s65 offen lds
    s_add_u32 m0, s66, 94208
    s_add_u32 s65, s69, 30720
    buffer_load_dwordx4 v7, s[32:35], s65 offen lds
    s_add_u32 m0, s66, 95232
    s_add_u32 s65, s69, 46080
    buffer_load_dwordx4 v7, s[32:35], s65 offen lds
    s_add_u32 s69, s69, 245760
    s_cmp_ge_u32 s69, 2457600
    s_cselect_b32 s65, 2457600, 0
    s_sub_u32 s69, s69, s65
    s_add_u32 m0, s67, 20480
    s_add_u32 s65, s68, 0
    buffer_load_dwordx4 v8, s[28:31], s65 offen  lds
    s_add_u32 m0, s67, 21504
    s_add_u32 s65, s68, 10240
    buffer_load_dwordx4 v9, s[28:31], s65 offen  lds
    s_add_u32 m0, s67, 22528
    s_add_u32 s65, s68, 20480
    buffer_load_dwordx4 v8, s[28:31], s65 offen  lds
    s_add_u32 m0, s67, 23552
    s_add_u32 s65, s68, 30720
    buffer_load_dwordx4 v9, s[28:31], s65 offen  lds
    s_add_u32 s68, s68, 128
    s_cmp_ge_u32 s68, 1280
    s_cselect_b32 s65, 1280, 0
    s_sub_u32 s68, s68, s65
    s_waitcnt vmcnt(16)
    s_barrier
    s_add_u32 m0, s72, 36864
    s_add_u32 s65, s70, 0
    buffer_load_dwordx4 v10, s[36:39], s65 offen sc1 lds
    s_add_u32 m0, s72, 40960
    s_add_u32 s65, s70, 4096
    buffer_load_dwordx4 v10, s[36:39], s65 offen sc1 lds
    s_add_u32 m0, s72, 45056
    s_add_u32 s65, s70, 8192
    buffer_load_dwordx4 v10, s[36:39], s65 offen sc1 lds
    s_add_u32 m0, s72, 49152
    s_add_u32 s65, s70, 12288
    buffer_load_dwordx4 v10, s[36:39], s65 offen sc1 lds
    s_add_u32 m0, s72, 108544
    s_add_u32 s65, s70, 16384
    buffer_load_dwordx4 v10, s[36:39], s65 offen sc1 lds
    s_add_u32 m0, s72, 112640
    s_add_u32 s65, s71, 0
    buffer_load_dwordx4 v10, s[36:39], s65 offen sc1 lds
    s_add_u32 m0, s72, 116736
    s_add_u32 s65, s71, 4096
    buffer_load_dwordx4 v10, s[36:39], s65 offen sc1 lds
    s_cmp_ge_u32 s72, 2048
    s_cbranch_scc1 sd_skip_9
    s_add_u32 m0, s72, 120832
    s_add_u32 s65, s71, 8192
    buffer_load_dwordx4 v10, s[36:39], s65 offen sc1 lds
sd_skip_9:
    s_waitcnt vmcnt(8)
    s_barrier
    s_waitcnt vmcnt(0)
    s_barrier
    s_barrier
sequential_preLN__sliding_block__dense_activation_squared_relu__prompt_kernel_att:
    s_cmp_lt_u32 s53, 15
    s_cbranch_scc1 wpf_skip_10
    s_cmp_lg_u32 s24, 0
    s_cbranch_scc1 wpf_go_11
    s_add_u32 s28, s22, 20185088
    s_addc_u32 s29, s23, 0
    s_and_b32 s29, s29, 0xffff
    s_mov_b32 s30, 983040
    s_mov_b32 s31, 0x20000
    s_add_u32 s59, s52, s53
    s_mul_i32 s60, s59, 26
    s_lshr_b32 s60, s60, 8
    s_mul_i32 s60, s60, 10
    s_sub_u32 s59, s59, s60
    s_mul_i32 s60, s52, 10
    s_add_u32 s59, s59, s60
    s_lshl_b32 s59, s59, 11
    s_add_u32 s59, s59, 4
    v_mov_b32 v4, s59
    s_waitcnt vmcnt(0)
    s_mov_b32 s60, 400000
wpf_poll_12:
    buffer_load_dword v5, v4, s[28:31], 0 offen sc1
    s_waitcnt vmcnt(0)
    v_subrev_u32 v5, v2, v5
    v_cmp_ne_u32 vcc, 1, v5
    s_cmp_eq_u64 vcc, 0
    s_cbranch_scc1 wpf_go_11
    s_sub_u32 s60, s60, 1
    s_cmp_lg_u32 s60, 0
    s_cbranch_scc1 wpf_poll_12
wpf_go_11:
    s_barrier
    s_lshl_b32 s61, s52, 3
    s_add_u32 s61, s61, s24
wpf_m_14:
    s_mov_b32 s28, s12
    s_and_b32 s29, s13, 0xffff
    s_mov_b32 s30, 2211840
    s_mov_b32 s31, 0x20000
wpf_go2_13:
    s_mul_i32 s61, s61, 24576
    v_lshlrev_b32 v6, 7, v1
    v_add_u32 v6, s61, v6
    s_mov_b32 s61, 0
    buffer_load_dword v255, v6, s[28:31], s61 offen
    s_mov_b32 s61, 8192
    buffer_load_dword v255, v6, s[28:31], s61 offen
    s_mov_b32 s61, 16384
    buffer_load_dword v255, v6, s[28:31], s61 offen
wpf_skip_10:
    s_and_b32 s59, s26, 15
    s_lshr_b32 s62, s26, 4
    s_lshl_b32 s60, s25, 1
    s_add_u32 s60, s60, s62
    s_mov_b32 s36, s22
    s_and_b32 s37, s23, 0xffff
    s_mov_b32 s38, 5242880
    s_mov_b32 s39, 0x20000
    s_add_u32 s40, s22, 5242880
    s_addc_u32 s41, s23, 0
    s_and_b32 s41, s41, 0xffff
    s_mov_b32 s42, 2621440
    s_mov_b32 s43, 0x20000
    s_add_u32 s44, s22, 7864320
    s_addc_u32 s45, s23, 0
    s_and_b32 s45, s45, 0xffff
    s_mov_b32 s46, 2621440
    s_mov_b32 s47, 0x20000
    s_lshl_b32 s76, s59, 7
    s_lshl_b32 s61, s24, 6
    s_add_u32 s76, s76, s61
    s_cmp_lt_u32 s24, 6
    s_cselect_b32 s61, 0, 128
    s_add_u32 s61, s61, 256
    s_sub_u32 s76, s76, s61
    s_mul_i32 s63, s60, 5
    s_cmp_lt_u32 s24, 6
    s_cselect_b32 s61, 80, 0
    s_add_u32 s63, s63, s61
    s_lshl_b32 s64, s24, 10
    s_cmp_lt_u32 s24, 6
    s_cselect_b32 s61, 0, 24576
    s_add_u32 s64, s64, s61
    s_add_u32 s64, s64, 4096
    s_cmp_lt_u32 s24, 6
    s_cselect_b32 s65, 4096, 0
    s_add_u32 s65, s65, 2048
    v_add_u32 v8, s76, v1
    v_max_i32 v8, 0, v8
    v_lshlrev_b32 v8, 4, v8
    s_lshl_b32 s63, s63, 15
    s_lshl_b32 s77, s59, 4
    s_sub_u32 s77, s77, 32
    s_mul_i32 s67, s60, 640
    s_lshl_b32 s61, s24, 6
    s_add_u32 s61, s61, 0
    v_add_u32 v4, s61, v1
    v_mul_u32_u24 v5, 52429, v4
    v_lshrrev_b32 v5, 21, v5
    v_mul_u32_u24 v6, 40, v5
    v_sub_u32 v6, v4, v6
    v_add_u32 v5, s77, v5
    v_max_i32 v5, 0, v5
    v_mul_u32_u24 v5, 10240, v5
    v_lshl_add_u32 v9, v6, 4, v5
    s_lshl_b32 s61, s24, 6
    s_add_u32 s61, s61, 512
    v_add_u32 v4, s61, v1
    v_mul_u32_u24 v5, 52429, v4
    v_lshrrev_b32 v5, 21, v5
    v_mul_u32_u24 v6, 40, v5
    v_sub_u32 v6, v4, v6
    v_add_u32 v5, s77, v5
    v_max_i32 v5, 0, v5
    v_mul_u32_u24 v5, 10240, v5
    v_lshl_add_u32 v10, v6, 4, v5
    s_lshl_b32 s61, s24, 6
    s_add_u32 s61, s61, 1024
    v_add_u32 v4, s61, v1
    v_mul_u32_u24 v5, 52429, v4
    v_lshrrev_b32 v5, 21, v5
    v_mul_u32_u24 v6, 40, v5
    v_sub_u32 v6, v4, v6
    v_add_u32 v5, s77, v5
    v_max_i32 v5, 0, v5
    v_mul_u32_u24 v5, 10240, v5
    v_lshl_add_u32 v11, v6, 4, v5
    s_lshl_b32 s61, s24, 6
    s_add_u32 s61, s61, 1536
    v_add_u32 v4, s61, v1
    v_mul_u32_u24 v5, 52429, v4
    v_lshrrev_b32 v5, 21, v5
    v_mul_u32_u24 v6, 40, v5
    v_sub_u32 v6, v4, v6
    v_add_u32 v5, s77, v5
    v_max_i32 v5, 0, v5
    v_mul_u32_u24 v5, 10240, v5
    v_lshl_add_u32 v12, v6, 4, v5
    s_and_b32 s68, s24, 3
    s_lshr_b32 s69, s24, 2
    v_and_b32 v13, 31, v1
    v_lshrrev_b32 v14, 5, v1
    s_mul_i32 s70, s69, 3
    s_lshl_b32 s61, s68, 9
    v_lshl_add_u32 v4, v13, 4, s61
    v_add_u32 v5, s70, v14
    v_lshl_add_u32 v15, v5, 11, v4
    v_add_u32 v15, 34816, v15
    v_add_u32 v16, 38912, v4
    v_and_b32 v4, 0x13, v13
    v_bfe_u32 v6, v13, 2, 1
    v_lshl_or_b32 v4, v6, 3, v4
    v_bfe_u32 v6, v13, 3, 1
    v_lshl_or_b32 v4, v6, 2, v4
    v_lshl_add_u32 v4, v4, 4, s61
    v_mul_u32_u24 v5, 6144, v5
    v_add_u32 v17, v5, v4
    v_add_u32 v17, 4096, v17
    v_add_u32 v18, 16384, v4
    s_lshl_b32 s61, s69, 4
    v_add_u32 v4, s61, v13
    v_lshlrev_b32 v4, 4, v4
    s_lshl_b32 s61, s68, 2
    v_add_u32 v5, s61, v14
    v_mul_u32_u24 v5, 640, v5
    v_add3_u32 v19, v4, v5, 0
    v_add_u32 v19, 45056, v19
    s_lshl_b32 s61, s69, 2
    v_subrev_u32 v4, s61, v13
    v_cmp_gt_u32 s[72:73], 20, v4
    v_cmp_eq_u32 s[74:75], s69, v14
    v_lshlrev_b32 v4, 3, v14
    v_sub_u32 v20, v13, v4
    v_mov_b32 v190, 0xf149f2ca
    v_mov_b32 v62, 0x3f803f80
    v_mov_b32 v63, 0x3f803f80
    v_mov_b32 v64, 0x3f803f80
    v_mov_b32 v65, 0x3f803f80
    v_mov_b32 v66, 0x3f803f80
    v_mov_b32 v67, 0x3f803f80
    v_mov_b32 v68, 0x3f803f80
    v_mov_b32 v69, 0x3f803f80
    v_mov_b32 v70, 0x3f803f80
    v_mov_b32 v71, 0x3f803f80
    v_mov_b32 v72, 0x3f803f80
    v_mov_b32 v73, 0x3f803f80
    v_mov_b32 v74, 0x3f803f80
    v_mov_b32 v75, 0x3f803f80
    v_mov_b32 v76, 0x3f803f80
    v_mov_b32 v77, 0x3f803f80
    s_cmp_ge_u32 s58, 5
    s_cbranch_scc1 pfB_15
    s_mov_b32 s32, s8
    s_and_b32 s33, s9, 0xffff
    s_mov_b32 s34, 819200
    s_mov_b32 s35, 0x20000
    v_lshrrev_b32 v4, 3, v1
    v_and_b32 v5, 7, v1
    v_bfe_u32 v6, v1, 4, 1
    v_lshlrev_b32 v6, 2, v6
    v_xor_b32 v5, v5, v6
    s_lshl_b32 s61, s24, 3
    v_add_u32 v4, s61, v4
    v_mul_u32_u24 v4, 1280, v4
    v_lshl_add_u32 v4, v5, 4, v4
    s_lshl_b32 s61, s55, 7
    v_add_u32 v196, s61, v4
    s_mov_b32 s78, 0
    s_mov_b32 s79, 81920
    s_mov_b32 s80, 163840
    s_mov_b32 s81, 245760
    s_mov_b32 s82, 327680
    s_mov_b32 s83, 409600
    s_mov_b32 s84, 491520
    s_mov_b32 s85, 573440
    s_mov_b32 s86, 655360
    s_mov_b32 s87, 737280
    s_lshl_b32 s88, s24, 10
    s_add_u32 s88, s88, 75776
    s_mov_b32 s89, 8192
    s_mov_b32 s90, 8192
    s_branch pfE_16
pfB_15:
    s_mov_b32 s32, s12
    s_and_b32 s33, s13, 0xffff
    s_mov_b32 s34, 2211840
    s_mov_b32 s35, 0x20000
    s_cmp_ge_u32 s58, 7
    s_cselect_b32 s34, 0, s34
    v_lshrrev_b32 v4, 4, v1
    v_and_b32 v5, 15, v1
    v_lshlrev_b32 v6, 2, v4
    v_xor_b32 v5, v5, v6
    s_lshl_b32 s61, s24, 3
    v_add_u32 v4, s61, v4
    v_mul_u32_u24 v4, 3456, v4
    v_lshl_add_u32 v4, v5, 4, v4
    s_lshl_b32 s61, s56, 8
    v_add_u32 v196, s61, v4
    s_add_u32 s88, s54, s56
    s_mul_i32 s61, s88, 26
    s_lshr_b32 s61, s61, 8
    s_mul_i32 s61, s61, 10
    s_sub_u32 s88, s88, s61
    s_add_u32 s61, s88, 0
    s_cmp_ge_u32 s61, 10
    s_cselect_b32 s62, 10, 0
    s_sub_u32 s61, s61, s62
    s_mul_i32 s78, s61, 221184
    s_add_u32 s79, s78, 13824
    s_add_u32 s61, s88, 1
    s_cmp_ge_u32 s61, 10
    s_cselect_b32 s62, 10, 0
    s_sub_u32 s61, s61, s62
    s_mul_i32 s80, s61, 221184
    s_add_u32 s81, s80, 13824
    s_add_u32 s61, s88, 2
    s_cmp_ge_u32 s61, 10
    s_cselect_b32 s62, 10, 0
    s_sub_u32 s61, s61, s62
    s_mul_i32 s82, s61, 221184
    s_add_u32 s83, s82, 13824
    s_add_u32 s61, s88, 3
    s_cmp_ge_u32 s61, 10
    s_cselect_b32 s62, 10, 0
    s_sub_u32 s61, s61, s62
    s_mul_i32 s84, s61, 221184
    s_add_u32 s85, s84, 13824
    s_add_u32 s61, s88, 4
    s_cmp_ge_u32 s61, 10
    s_cselect_b32 s62, 10, 0
    s_sub_u32 s61, s61, s62
    s_mul_i32 s86, s61, 221184
    s_add_u32 s87, s86, 13824
    s_lshl_b32 s88, s24, 11
    s_add_u32 s88, s88, 75776
    s_mov_b32 s89, 1024
    s_mov_b32 s90, 15360
pfE_16:
    s_cmp_lg_u32 s24, 0
    s_cbranch_scc1 att_nopoll_18
    s_mul_i32 s61, s60, 40
    s_mov_b32 s96, 0
    s_add_u32 s62, s61, 640
    s_lshr_b32 s62, s62, 7
    s_bitset1_b32 s96, s62
    s_add_u32 s62, s61, 679
    s_lshr_b32 s62, s62, 7
    s_bitset1_b32 s96, s62
    s_add_u32 s62, s61, 1280
    s_lshr_b32 s62, s62, 7
    s_bitset1_b32 s96, s62
    s_add_u32 s62, s61, 1319
    s_lshr_b32 s62, s62, 7
    s_bitset1_b32 s96, s62
    s_mov_b32 s97, s96
    s_add_u32 s62, s61, 0
    s_lshr_b32 s62, s62, 7
    s_bitset1_b32 s96, s62
    s_add_u32 s62, s61, 39
    s_lshr_b32 s62, s62, 7
    s_bitset1_b32 s96, s62
    s_lshl_b32 s92, s97, 16
    s_or_b32 s92, s92, s97
    s_mov_b32 s93, s96
    s_cmp_ge_u32 s59, 2
    s_cselect_b32 s62, -1, 0xffff0000
    s_and_b32 s92, s92, s62
    s_cmp_ge_u32 s59, 1
    s_cselect_b32 s62, -1, 0
    s_and_b32 s92, s92, s62
    v_lshrrev_b32 v4, 4, v1
    v_add_u32 v4, s59, v4
    v_subrev_u32 v4, 2, v4
    v_and_b32 v5, 15, v1
    v_add_u32 v4, 0, v4
    v_lshlrev_b32 v4, 8, v4
    v_lshl_add_u32 v4, v5, 2, v4
    s_waitcnt vmcnt(0)
    s_mov_b32 s94, 400000
    s_mov_b64 exec, s[92:93]
poll_19:
    buffer_load_dword v6, v4, s[48:51], 0 offen sc1
    s_waitcnt vmcnt(0)
    v_subrev_u32 v6, v2, v6
    v_cmp_ne_u32 vcc, 1, v6
    s_cmp_eq_u64 vcc, 0
    s_cbranch_scc1 polled_20
    s_sub_u32 s94, s94, 1
    s_cmp_lg_u32 s94, 0
    s_cbranch_scc1 poll_19
polled_20:
    s_mov_b64 exec, -1
att_nopoll_18:
    s_barrier
    s_mov_b32 m0, s64
    s_add_u32 s66, s63, 0
    buffer_load_dwordx4 v8, s[36:39], s66 offen sc1 lds
    s_add_u32 s64, s64, s65
    s_mov_b32 m0, s64
    s_add_u32 s66, s63, 32768
    buffer_load_dwordx4 v8, s[36:39], s66 offen sc1 lds
    s_add_u32 s64, s64, s65
    s_mov_b32 m0, s64
    s_add_u32 s66, s63, 65536
    buffer_load_dwordx4 v8, s[36:39], s66 offen sc1 lds
    s_add_u32 s64, s64, s65
    s_mov_b32 m0, s64
    s_add_u32 s66, s63, 98304
    buffer_load_dwordx4 v8, s[36:39], s66 offen sc1 lds
    s_add_u32 s64, s64, s65
    s_mov_b32 m0, s64
    s_add_u32 s66, s63, 131072
    buffer_load_dwordx4 v8, s[36:39], s66 offen sc1 lds
    s_add_u32 s64, s64, s65
    s_lshl_b32 s63, s59, 2
    s_add_u32 s63, s63, s68
    s_lshl_b32 s61, s24, 10
    s_add_u32 m0, s61, 45056
    s_nop 0
    buffer_load_dwordx4 v9, s[40:43], s67 offen sc1 lds
    s_lshl_b32 s61, s24, 10
    s_add_u32 m0, s61, 53248
    s_nop 0
    buffer_load_dwordx4 v10, s[40:43], s67 offen sc1 lds
    s_lshl_b32 s61, s24, 10
    s_add_u32 m0, s61, 61440
    s_nop 0
    buffer_load_dwordx4 v11, s[40:43], s67 offen sc1 lds
    s_cmp_ge_u32 s24, 6
    s_cbranch_scc1 vskip_21
    s_lshl_b32 s61, s24, 10
    s_add_u32 m0, s61, 69632
    s_nop 0
    buffer_load_dwordx4 v12, s[40:43], s67 offen sc1 lds
vskip_21:
    v_cmp_le_i32 s[92:93], 0, v20
    v_cmp_le_i32 s[94:95], 1, v20
    s_nop 0
    v_cndmask_b32 v158, 0, v190, s[92:93]
    v_cndmask_b32 v174, v190, 0, s[92:93]
    v_cmp_le_i32 s[92:93], 2, v20
    v_cndmask_b32 v159, 0, v190, s[94:95]
    v_cndmask_b32 v175, v190, 0, s[94:95]
    v_cmp_le_i32 s[94:95], 3, v20
    v_cndmask_b32 v160, 0, v190, s[92:93]
    v_cndmask_b32 v176, v190, 0, s[92:93]
    v_cmp_le_i32 s[92:93], 4, v20
    v_cndmask_b32 v161, 0, v190, s[94:95]
    v_cndmask_b32 v177, v190, 0, s[94:95]
    v_cmp_le_i32 s[94:95], 5, v20
    v_cndmask_b32 v162, 0, v190, s[92:93]
    v_cndmask_b32 v178, v190, 0, s[92:93]
    v_cmp_le_i32 s[92:93], 6, v20
    v_cndmask_b32 v163, 0, v190, s[94:95]
    v_cndmask_b32 v179, v190, 0, s[94:95]
    v_cmp_le_i32 s[94:95], 7, v20
    v_cndmask_b32 v164, 0, v190, s[92:93]
    v_cndmask_b32 v180, v190, 0, s[92:93]
    v_cmp_le_i32 s[92:93], 16, v20
    v_cndmask_b32 v165, 0, v190, s[94:95]
    v_cndmask_b32 v181, v190, 0, s[94:95]
    v_cmp_le_i32 s[94:95], 17, v20
    v_cndmask_b32 v166, 0, v190, s[92:93]
    v_cndmask_b32 v182, v190, 0, s[92:93]
    v_cmp_le_i32 s[92:93], 18, v20
    v_cndmask_b32 v167, 0, v190, s[94:95]
    v_cndmask_b32 v183, v190, 0, s[94:95]
    v_cmp_le_i32 s[94:95], 19, v20
    v_cndmask_b32 v168, 0, v190, s[92:93]
    v_cndmask_b32 v184, v190, 0, s[92:93]
    v_cmp_le_i32 s[92:93], 20, v20
    v_cndmask_b32 v169, 0, v190, s[94:95]
    v_cndmask_b32 v185, v190, 0, s[94:95]
    v_cmp_le_i32 s[94:95], 21, v20
    v_cndmask_b32 v170, 0, v190, s[92:93]
    v_cndmask_b32 v186, v190, 0, s[92:93]
    v_cmp_le_i32 s[92:93], 22, v20
    v_cndmask_b32 v171, 0, v190, s[94:95]
    v_cndmask_b32 v187, v190, 0, s[94:95]
    v_cmp_le_i32 s[94:95], 23, v20
    v_cndmask_b32 v172, 0, v190, s[92:93]
    v_cndmask_b32 v188, v190, 0, s[92:93]
    v_cndmask_b32 v173, 0, v190, s[94:95]
    v_cndmask_b32 v189, v190, 0, s[94:95]
    s_waitcnt vmcnt(3)
    s_barrier
    ds_read_b128 v[22:25], v15
    ds_read_b128 v[26:29], v16
    ds_read_b128 v[42:45], v17 offset:4096
    ds_read_b128 v[58:61], v18 offset:4096
    ds_read_b128 v[30:33], v17 offset:0
    ds_read_b128 v[46:49], v18 offset:0
    ds_read_b128 v[34:37], v17 offset:512
    ds_read_b128 v[50:53], v18 offset:512
    ds_read_b128 v[38:41], v17 offset:1024
    ds_read_b128 v[54:57], v18 offset:1024
    v_cmp_eq_u32 vcc, 0, v14
    s_cmp_eq_u32 s69, 0
    s_cselect_b64 s[92:93], vcc, 0
    s_cselect_b64 s[94:95], 0, vcc
    s_waitcnt lgkmcnt(8)
    v_cndmask_b32 v26, 0, v26, s[92:93]
    v_cndmask_b32 v27, 0, v27, s[92:93]
    v_cndmask_b32 v28, 0, v28, s[94:95]
    v_cndmask_b32 v29, 0, v29, s[94:95]
    s_mov_b32 s96, 0
    s_waitcnt lgkmcnt(6)
    v_mfma_f32_32x32x16_bf16 v[126:141], v[42:45], v[22:25], v[174:189]
    v_mfma_f32_32x32x16_bf16 v[126:141], v[58:61], v[26:29], v[126:141]
    s_nop 11
    v_max3_f32 v192, v126, v127, v128
    v_max3_f32 v193, v130, v131, v132
    v_max3_f32 v194, v134, v135, v136
    v_max3_f32 v195, v138, v139, v140
    v_max_f32 v192, v192, v129
    v_max_f32 v193, v193, v133
    v_max_f32 v194, v194, v137
    v_max_f32 v195, v195, v141
    ds_read_b128 v[42:45], v17 offset:1536
    ds_read_b128 v[58:61], v18 offset:1536
    v_max3_f32 v192, v192, v193, v194
    v_max_f32 v192, v192, v195
    v_mov_b32 v193, v192
    s_nop 1
    v_permlane32_swap_b32 v192, v193
    s_nop 1
    v_max_f32 v192, v192, v193
    v_pk_add_f32 v[158:159], v[158:159], v[192:193] op_sel_hi:[1,0] neg_lo:[0,1] neg_hi:[0,1]
    v_pk_add_f32 v[160:161], v[160:161], v[192:193] op_sel_hi:[1,0] neg_lo:[0,1] neg_hi:[0,1]
    v_pk_add_f32 v[162:163], v[162:163], v[192:193] op_sel_hi:[1,0] neg_lo:[0,1] neg_hi:[0,1]
    v_pk_add_f32 v[164:165], v[164:165], v[192:193] op_sel_hi:[1,0] neg_lo:[0,1] neg_hi:[0,1]
    v_pk_add_f32 v[166:167], v[166:167], v[192:193] op_sel_hi:[1,0] neg_lo:[0,1] neg_hi:[0,1]
    v_pk_add_f32 v[168:169], v[168:169], v[192:193] op_sel_hi:[1,0] neg_lo:[0,1] neg_hi:[0,1]
    v_pk_add_f32 v[170:171], v[170:171], v[192:193] op_sel_hi:[1,0] neg_lo:[0,1] neg_hi:[0,1]
    v_pk_add_f32 v[172:173], v[172:173], v[192:193] op_sel_hi:[1,0] neg_lo:[0,1] neg_hi:[0,1]
    v_pk_mul_f32 v[142:143], v[192:193], -1.0 op_sel_hi:[0,0]
    v_pk_mul_f32 v[144:145], v[192:193], -1.0 op_sel_hi:[0,0]
    v_pk_mul_f32 v[146:147], v[192:193], -1.0 op_sel_hi:[0,0]
    v_pk_mul_f32 v[148:149], v[192:193], -1.0 op_sel_hi:[0,0]
    v_pk_mul_f32 v[150:151], v[192:193], -1.0 op_sel_hi:[0,0]
    v_pk_mul_f32 v[152:153], v[192:193], -1.0 op_sel_hi:[0,0]
    v_pk_mul_f32 v[154:155], v[192:193], -1.0 op_sel_hi:[0,0]
    v_pk_mul_f32 v[156:157], v[192:193], -1.0 op_sel_hi:[0,0]
    v_pk_add_f32 v[174:175], v[174:175], v[192:193] op_sel_hi:[1,0] neg_lo:[0,1] neg_hi:[0,1]
    v_pk_add_f32 v[176:177], v[176:177], v[192:193] op_sel_hi:[1,0] neg_lo:[0,1] neg_hi:[0,1]
    v_pk_add_f32 v[178:179], v[178:179], v[192:193] op_sel_hi:[1,0] neg_lo:[0,1] neg_hi:[0,1]
    v_pk_add_f32 v[180:181], v[180:181], v[192:193] op_sel_hi:[1,0] neg_lo:[0,1] neg_hi:[0,1]
    v_pk_add_f32 v[182:183], v[182:183], v[192:193] op_sel_hi:[1,0] neg_lo:[0,1] neg_hi:[0,1]
    v_pk_add_f32 v[184:185], v[184:185], v[192:193] op_sel_hi:[1,0] neg_lo:[0,1] neg_hi:[0,1]
    v_pk_add_f32 v[186:187], v[186:187], v[192:193] op_sel_hi:[1,0] neg_lo:[0,1] neg_hi:[0,1]
    v_pk_add_f32 v[188:189], v[188:189], v[192:193] op_sel_hi:[1,0] neg_lo:[0,1] neg_hi:[0,1]
    s_waitcnt vmcnt(0)
    s_barrier
att_pass2_22:
    s_waitcnt lgkmcnt(0)
    v_mfma_f32_32x32x16_bf16 v[94:109], v[30:33], v[22:25], v[158:173]
    v_mfma_f32_32x32x16_bf16 v[110:125], v[34:37], v[22:25], v[142:157]
    v_mfma_f32_32x32x16_bf16 v[94:109], v[46:49], v[26:29], v[94:109]
    v_mfma_f32_32x32x16_bf16 v[110:125], v[50:53], v[26:29], v[110:125]
    ds_read_b128 v[30:33], v17 offset:2048
    ds_read_b128 v[46:49], v18 offset:2048
    s_mov_b64 exec, s[72:73]
    ds_read_b128 v[62:65], v19 offset:0
    ds_read_b128 v[66:69], v19 offset:1280
    s_mov_b64 exec, -1
    s_waitcnt lgkmcnt(4)
    s_nop 3
    s_cmp_lt_u32 s63, 8
    s_cbranch_scc1 fixo_23
fixb_24:
    v_exp_f32 v94, v94
    v_exp_f32 v95, v95
    v_exp_f32 v96, v96
    v_exp_f32 v97, v97
    v_mfma_f32_32x32x16_bf16 v[126:141], v[38:41], v[22:25], v[142:157]
    v_exp_f32 v98, v98
    v_exp_f32 v99, v99
    v_exp_f32 v100, v100
    v_exp_f32 v101, v101
    v_exp_f32 v102, v102
    v_exp_f32 v103, v103
    v_exp_f32 v104, v104
    v_exp_f32 v105, v105
    v_mfma_f32_32x32x16_bf16 v[126:141], v[54:57], v[26:29], v[126:141]
    v_exp_f32 v106, v106
    v_exp_f32 v107, v107
    v_exp_f32 v108, v108
    v_exp_f32 v109, v109
    s_mov_b32 m0, s88
    s_nop 0
    buffer_load_dwordx4 v196, s[32:35], s78 offen lds
    s_add_u32 m0, m0, s89
    s_nop 0
    buffer_load_dwordx4 v196, s[32:35], s79 offen lds
    s_add_u32 m0, m0, s90
    s_nop 0
    v_cvt_pk_bf16_f32 v198, v94, v95
    v_cvt_pk_bf16_f32 v199, v96, v97
    v_cvt_pk_bf16_f32 v200, v98, v99
    v_cvt_pk_bf16_f32 v201, v100, v101
    v_cvt_pk_bf16_f32 v202, v102, v103
    v_cvt_pk_bf16_f32 v203, v104, v105
    v_cvt_pk_bf16_f32 v204, v106, v107
    v_cvt_pk_bf16_f32 v205, v108, v109
    ds_read_b128 v[34:37], v17 offset:2560
    ds_read_b128 v[50:53], v18 offset:2560
    s_mov_b64 exec, s[72:73]
    ds_read_b128 v[70:73], v19 offset:2560
    ds_read_b128 v[74:77], v19 offset:3840
    s_mov_b64 exec, -1
    s_waitcnt lgkmcnt(4)
    s_cmp_lt_u32 s63, 7
    s_cbranch_scc1 fixo_25
fixb_26:
    v_exp_f32 v110, v110
    v_exp_f32 v111, v111
    v_exp_f32 v112, v112
    v_exp_f32 v113, v113
    v_mfma_f32_32x32x16_bf16 v[94:109], v[42:45], v[22:25], v[142:157]
    v_exp_f32 v114, v114
    v_exp_f32 v115, v115
    v_exp_f32 v116, v116
    v_exp_f32 v117, v117
    v_mfma_f32_32x32x16_bf16 v[78:93], v[62:65], v[198:201], 0
    v_exp_f32 v118, v118
    v_exp_f32 v119, v119
    v_exp_f32 v120, v120
    v_exp_f32 v121, v121
    v_mfma_f32_32x32x16_bf16 v[94:109], v[58:61], v[26:29], v[94:109]
    v_exp_f32 v122, v122
    v_exp_f32 v123, v123
    v_exp_f32 v124, v124
    v_exp_f32 v125, v125
    v_mfma_f32_32x32x16_bf16 v[78:93], v[66:69], v[202:205], v[78:93]
    buffer_load_dwordx4 v196, s[32:35], s80 offen lds
    s_add_u32 m0, m0, s89
    s_nop 0
    buffer_load_dwordx4 v196, s[32:35], s81 offen lds
    s_add_u32 m0, m0, s90
    v_cvt_pk_bf16_f32 v206, v110, v111
    v_cvt_pk_bf16_f32 v207, v112, v113
    v_cvt_pk_bf16_f32 v208, v114, v115
    v_cvt_pk_bf16_f32 v209, v116, v117
    v_cvt_pk_bf16_f32 v210, v118, v119
    v_cvt_pk_bf16_f32 v211, v120, v121
    v_cvt_pk_bf16_f32 v212, v122, v123
    v_cvt_pk_bf16_f32 v213, v124, v125
    ds_read_b128 v[38:41], v17 offset:3072
    ds_read_b128 v[54:57], v18 offset:3072
    s_mov_b64 exec, s[72:73]
    ds_read_b128 v[62:65], v19 offset:5120
    ds_read_b128 v[66:69], v19 offset:6400
    s_mov_b64 exec, -1
    s_waitcnt lgkmcnt(4)
    s_cmp_lt_u32 s63, 6
    s_cbranch_scc1 fixo_27
fixb_28:
    v_exp_f32 v126, v126
    v_exp_f32 v127, v127
    v_exp_f32 v128, v128
    v_exp_f32 v129, v129
    v_mfma_f32_32x32x16_bf16 v[110:125], v[30:33], v[22:25], v[142:157]
    v_exp_f32 v130, v130
    v_exp_f32 v131, v131
    v_exp_f32 v132, v132
    v_exp_f32 v133, v133
    v_mfma_f32_32x32x16_bf16 v[78:93], v[70:73], v[206:209], v[78:93]
    v_exp_f32 v134, v134
    v_exp_f32 v135, v135
    v_exp_f32 v136, v136
    v_exp_f32 v137, v137
    v_mfma_f32_32x32x16_bf16 v[110:125], v[46:49], v[26:29], v[110:125]
    v_exp_f32 v138, v138
    v_exp_f32 v139, v139
    v_exp_f32 v140, v140
    v_exp_f32 v141, v141
    v_mfma_f32_32x32x16_bf16 v[78:93], v[74:77], v[210:213], v[78:93]
    buffer_load_dwordx4 v196, s[32:35], s82 offen lds
    s_add_u32 m0, m0, s89
    s_nop 0
    buffer_load_dwordx4 v196, s[32:35], s83 offen lds
    s_add_u32 m0, m0, s90
    v_cvt_pk_bf16_f32 v198, v126, v127
    v_cvt_pk_bf16_f32 v199, v128, v129
    v_cvt_pk_bf16_f32 v200, v130, v131
    v_cvt_pk_bf16_f32 v201, v132, v133
    v_cvt_pk_bf16_f32 v202, v134, v135
    v_cvt_pk_bf16_f32 v203, v136, v137
    v_cvt_pk_bf16_f32 v204, v138, v139
    v_cvt_pk_bf16_f32 v205, v140, v141
    ds_read_b128 v[42:45], v17 offset:3584
    ds_read_b128 v[58:61], v18 offset:3584
    s_mov_b64 exec, s[72:73]
    ds_read_b128 v[70:73], v19 offset:7680
    ds_read_b128 v[74:77], v19 offset:8960
    s_mov_b64 exec, -1
    s_waitcnt lgkmcnt(4)
    s_cmp_lt_u32 s63, 5
    s_cbranch_scc1 fixo_29
fixb_30:
    v_exp_f32 v94, v94
    v_exp_f32 v95, v95
    v_exp_f32 v96, v96
    v_exp_f32 v97, v97
    v_mfma_f32_32x32x16_bf16 v[126:141], v[34:37], v[22:25], v[142:157]
    v_exp_f32 v98, v98
    v_exp_f32 v99, v99
    v_exp_f32 v100, v100
    v_exp_f32 v101, v101
    v_mfma_f32_32x32x16_bf16 v[78:93], v[62:65], v[198:201], v[78:93]
    v_exp_f32 v102, v102
    v_exp_f32 v103, v103
    v_exp_f32 v104, v104
    v_exp_f32 v105, v105
    v_mfma_f32_32x32x16_bf16 v[126:141], v[50:53], v[26:29], v[126:141]
    v_exp_f32 v106, v106
    v_exp_f32 v107, v107
    v_exp_f32 v108, v108
    v_exp_f32 v109, v109
    v_mfma_f32_32x32x16_bf16 v[78:93], v[66:69], v[202:205], v[78:93]
    buffer_load_dwordx4 v196, s[32:35], s84 offen lds
    s_add_u32 m0, m0, s89
    s_nop 0
    buffer_load_dwordx4 v196, s[32:35], s85 offen lds
    s_add_u32 m0, m0, s90
    v_cvt_pk_bf16_f32 v206, v94, v95
    v_cvt_pk_bf16_f32 v207, v96, v97
    v_cvt_pk_bf16_f32 v208, v98, v99
    v_cvt_pk_bf16_f32 v209, v100, v101
    v_cvt_pk_bf16_f32 v210, v102, v103
    v_cvt_pk_bf16_f32 v211, v104, v105
    v_cvt_pk_bf16_f32 v212, v106, v107
    v_cvt_pk_bf16_f32 v213, v108, v109
    ds_read_b128 v[30:33], v17 offset:4096
    ds_read_b128 v[46:49], v18 offset:4096
    s_mov_b64 exec, s[72:73]
    ds_read_b128 v[62:65], v19 offset:10240
    ds_read_b128 v[66:69], v19 offset:11520
    s_mov_b64 exec, -1
    s_waitcnt lgkmcnt(4)
    s_cmp_lt_u32 s63, 4
    s_cbranch_scc1 fixo_31
fixb_32:
    v_exp_f32 v110, v110
    v_exp_f32 v111, v111
    v_exp_f32 v112, v112
    v_exp_f32 v113, v113
    v_mfma_f32_32x32x16_bf16 v[94:109], v[38:41], v[22:25], v[142:157]
    v_exp_f32 v114, v114
    v_exp_f32 v115, v115
    v_exp_f32 v116, v116
    v_exp_f32 v117, v117
    v_mfma_f32_32x32x16_bf16 v[78:93], v[70:73], v[206:209], v[78:93]
    v_exp_f32 v118, v118
    v_exp_f32 v119, v119
    v_exp_f32 v120, v120
    v_exp_f32 v121, v121
    v_mfma_f32_32x32x16_bf16 v[94:109], v[54:57], v[26:29], v[94:109]
    v_exp_f32 v122, v122
    v_exp_f32 v123, v123
    v_exp_f32 v124, v124
    v_exp_f32 v125, v125
    v_mfma_f32_32x32x16_bf16 v[78:93], v[74:77], v[210:213], v[78:93]
    buffer_load_dwordx4 v196, s[32:35], s86 offen lds
    s_add_u32 m0, m0, s89
    s_nop 0
    buffer_load_dwordx4 v196, s[32:35], s87 offen lds
    v_cvt_pk_bf16_f32 v198, v110, v111
    v_cvt_pk_bf16_f32 v199, v112, v113
    v_cvt_pk_bf16_f32 v200, v114, v115
    v_cvt_pk_bf16_f32 v201, v116, v117
    v_cvt_pk_bf16_f32 v202, v118, v119
    v_cvt_pk_bf16_f32 v203, v120, v121
    v_cvt_pk_bf16_f32 v204, v122, v123
    v_cvt_pk_bf16_f32 v205, v124, v125
    s_mov_b64 exec, s[72:73]
    ds_read_b128 v[70:73], v19 offset:12800
    ds_read_b128 v[74:77], v19 offset:14080
    s_mov_b64 exec, -1
    s_waitcnt lgkmcnt(2)
    s_cmp_lt_u32 s63, 3
    s_cbranch_scc1 fixo_33
fixb_34:
    v_exp_f32 v126, v126
    v_exp_f32 v127, v127
    v_exp_f32 v128, v128
    v_exp_f32 v129, v129
    v_mfma_f32_32x32x16_bf16 v[110:125], v[42:45], v[22:25], v[142:157]
    v_exp_f32 v130, v130
    v_exp_f32 v131, v131
    v_exp_f32 v132, v132
    v_exp_f32 v133, v133
    v_mfma_f32_32x32x16_bf16 v[78:93], v[62:65], v[198:201], v[78:93]
    v_exp_f32 v134, v134
    v_exp_f32 v135, v135
    v_exp_f32 v136, v136
    v_exp_f32 v137, v137
    v_mfma_f32_32x32x16_bf16 v[110:125], v[58:61], v[26:29], v[110:125]
    v_exp_f32 v138, v138
    v_exp_f32 v139, v139
    v_exp_f32 v140, v140
    v_exp_f32 v141, v141
    v_mfma_f32_32x32x16_bf16 v[78:93], v[66:69], v[202:205], v[78:93]
    s_nop 0
    v_cvt_pk_bf16_f32 v206, v126, v127
    v_cvt_pk_bf16_f32 v207, v128, v129
    v_cvt_pk_bf16_f32 v208, v130, v131
    v_cvt_pk_bf16_f32 v209, v132, v133
    v_cvt_pk_bf16_f32 v210, v134, v135
    v_cvt_pk_bf16_f32 v211, v136, v137
    v_cvt_pk_bf16_f32 v212, v138, v139
    v_cvt_pk_bf16_f32 v213, v140, v141
    s_mov_b64 exec, s[72:73]
    ds_read_b128 v[62:65], v19 offset:15360
    ds_read_b128 v[66:69], v19 offset:16640
    s_mov_b64 exec, -1
    s_waitcnt lgkmcnt(2)
    s_cmp_lt_u32 s63, 2
    s_cbranch_scc1 fixo_35
fixb_36:
    v_exp_f32 v94, v94
    v_exp_f32 v95, v95
    v_exp_f32 v96, v96
    v_exp_f32 v97, v97
    v_mfma_f32_32x32x16_bf16 v[126:141], v[30:33], v[22:25], v[174:189]
    v_exp_f32 v98, v98
    v_exp_f32 v99, v99
    v_exp_f32 v100, v100
    v_exp_f32 v101, v101
    v_mfma_f32_32x32x16_bf16 v[78:93], v[70:73], v[206:209], v[78:93]
    v_exp_f32 v102, v102
    v_exp_f32 v103, v103
    v_exp_f32 v104, v104
    v_exp_f32 v105, v105
    v_mfma_f32_32x32x16_bf16 v[126:141], v[46:49], v[26:29], v[126:141]
    v_exp_f32 v106, v106
    v_exp_f32 v107, v107
    v_exp_f32 v108, v108
    v_exp_f32 v109, v109
    v_mfma_f32_32x32x16_bf16 v[78:93], v[74:77], v[210:213], v[78:93]
    s_nop 0
    v_cvt_pk_bf16_f32 v198, v94, v95
    v_cvt_pk_bf16_f32 v199, v96, v97
    v_cvt_pk_bf16_f32 v200, v98, v99
    v_cvt_pk_bf16_f32 v201, v100, v101
    v_cvt_pk_bf16_f32 v202, v102, v103
    v_cvt_pk_bf16_f32 v203, v104, v105
    v_cvt_pk_bf16_f32 v204, v106, v107
    v_cvt_pk_bf16_f32 v205, v108, v109
    s_mov_b64 exec, s[72:73]
    ds_read_b128 v[70:73], v19 offset:17920
    ds_read_b128 v[74:77], v19 offset:19200
    s_mov_b64 exec, -1
    s_waitcnt lgkmcnt(2)
    s_cmp_lt_u32 s63, 1
    s_cbranch_scc1 fixo_37
fixb_38:
    v_exp_f32 v110, v110
    v_exp_f32 v111, v111
    v_exp_f32 v112, v112
    v_exp_f32 v113, v113
    v_exp_f32 v114, v114
    v_exp_f32 v115, v115
    v_exp_f32 v116, v116
    v_exp_f32 v117, v117
    v_mfma_f32_32x32x16_bf16 v[78:93], v[62:65], v[198:201], v[78:93]
    v_exp_f32 v118, v118
    v_exp_f32 v119, v119
    v_exp_f32 v120, v120
    v_exp_f32 v121, v121
    v_exp_f32 v122, v122
    v_exp_f32 v123, v123
    v_exp_f32 v124, v124
    v_exp_f32 v125, v125
    v_mfma_f32_32x32x16_bf16 v[78:93], v[66:69], v[202:205], v[78:93]
    s_nop 0
    v_cvt_pk_bf16_f32 v206, v110, v111
    v_cvt_pk_bf16_f32 v207, v112, v113
    v_cvt_pk_bf16_f32 v208, v114, v115
    v_cvt_pk_bf16_f32 v209, v116, v117
    v_cvt_pk_bf16_f32 v210, v118, v119
    v_cvt_pk_bf16_f32 v211, v120, v121
    v_cvt_pk_bf16_f32 v212, v122, v123
    v_cvt_pk_bf16_f32 v213, v124, v125
    s_mov_b64 exec, s[72:73]
    ds_read_b128 v[62:65], v19 offset:20480
    ds_read_b128 v[66:69], v19 offset:21760
    s_mov_b64 exec, -1
    s_waitcnt lgkmcnt(2)
    v_exp_f32 v126, v126
    v_exp_f32 v127, v127
    v_exp_f32 v128, v128
    v_exp_f32 v129, v129
    v_exp_f32 v130, v130
    v_exp_f32 v131, v131
    v_exp_f32 v132, v132
    v_exp_f32 v133, v133
    v_mfma_f32_32x32x16_bf16 v[78:93], v[70:73], v[206:209], v[78:93]
    v_exp_f32 v134, v134
    v_exp_f32 v135, v135
    v_exp_f32 v136, v136
    v_exp_f32 v137, v137
    v_exp_f32 v138, v138
    v_exp_f32 v139, v139
    v_exp_f32 v140, v140
    v_exp_f32 v141, v141
    v_mfma_f32_32x32x16_bf16 v[78:93], v[74:77], v[210:213], v[78:93]
    s_nop 0
    v_cvt_pk_bf16_f32 v198, v126, v127
    v_cvt_pk_bf16_f32 v199, v128, v129
    v_cvt_pk_bf16_f32 v200, v130, v131
    v_cvt_pk_bf16_f32 v201, v132, v133
    v_cvt_pk_bf16_f32 v202, v134, v135
    v_cvt_pk_bf16_f32 v203, v136, v137
    v_cvt_pk_bf16_f32 v204, v138, v139
    v_cvt_pk_bf16_f32 v205, v140, v141
    s_waitcnt lgkmcnt(0)
    s_nop 1
    v_mfma_f32_32x32x16_bf16 v[78:93], v[62:65], v[198:201], v[78:93]
    v_mfma_f32_32x32x16_bf16 v[78:93], v[66:69], v[202:205], v[78:93]
    s_nop 15
    s_cmp_lg_u32 s96, 0
    s_cbranch_scc1 att_sum_ok_40
    s_mov_b32 s61, 0x53800000
    v_cmp_nlt_f32_e64 vcc, v90, s61
    s_cmp_lg_u64 vcc, 0
    s_cbranch_scc1 att_truemax_39
att_sum_ok_40:
    v_rcp_f32 v193, v90
    s_nop 0
    v_mul_f32 v78, v78, v193
    v_mul_f32 v79, v79, v193
    v_mul_f32 v80, v80, v193
    v_mul_f32 v81, v81, v193
    v_mul_f32 v82, v82, v193
    v_mul_f32 v83, v83, v193
    v_mul_f32 v84, v84, v193
    v_mul_f32 v85, v85, v193
    v_mul_f32 v86, v86, v193
    v_mul_f32 v87, v87, v193
    v_mul_f32 v88, v88, v193
    v_mul_f32 v89, v89, v193
    v_cvt_pk_bf16_f32 v214, v78, v79
    v_cvt_pk_bf16_f32 v215, v80, v81
    v_cvt_pk_bf16_f32 v216, v82, v83
    v_cvt_pk_bf16_f32 v217, v84, v85
    v_cvt_pk_bf16_f32 v218, v86, v87
    v_cvt_pk_bf16_f32 v219, v88, v89
    s_lshl_b32 s61, s59, 7
    s_lshl_b32 s62, s68, 5
    s_add_u32 s61, s61, s62
    v_add_u32 v4, s61, v13
    v_lshlrev_b32 v4, 4, v4
    v_lshl_add_u32 v5, v14, 3, v4
    v_lshl_add_u32 v4, v14, 15, v4
    s_mul_i32 s61, s60, 5
    s_add_u32 s62, s61, 2
    s_lshl_b32 s62, s62, 15
    s_add_u32 s61, s61, s70
    s_lshl_b32 s61, s61, 15
    s_cmp_eq_u32 s69, 1
    s_cbranch_scc1 headB_41
    v_permlane32_swap_b32 v214, v216
    v_permlane32_swap_b32 v215, v217
    buffer_store_dwordx4 v[214:217], v4, s[44:47], s61 offen sc1
    s_mov_b64 exec, s[74:75]
    buffer_store_dwordx2 v[218:219], v5, s[44:47], s62 offen sc1
    s_branch headE_42
headB_41:
    v_permlane32_swap_b32 v216, v218
    v_permlane32_swap_b32 v217, v219
    buffer_store_dwordx4 v[216:219], v4, s[44:47], s61 offen sc1
    s_mov_b64 exec, s[74:75]
    buffer_store_dwordx2 v[214:215], v5, s[44:47], s62 offen sc1
headE_42:
    s_mov_b64 exec, -1
    s_add_u32 s61, s59, 16
    s_lshl_b32 s61, s61, 8
    s_lshl_b32 s62, s60, 2
    s_add_u32 s61, s61, s62
    s_waitcnt vmcnt(0)
    v_mov_b32 v6, 3844
    v_mov_b32 v7, 1
    s_mov_b64 exec, 1
    ds_add_rtn_u32 v7, v6, v7
    s_waitcnt lgkmcnt(0)
    v_cmp_eq_u32 vcc, 7, v7
    s_cmp_eq_u64 vcc, 0
    s_cbranch_scc1 nopub_43
    v_add_u32 v7, 1, v2
    v_mov_b32 v6, s61
    buffer_store_dword v7, v6, s[48:51], 0 offen sc1
nopub_43:
    s_mov_b64 exec, -1
    s_branch att_done_44
att_truemax_39:
    s_mov_b32 s96, 1
    v_cmp_le_i32 s[92:93], 0, v20
    v_cmp_le_i32 s[94:95], 1, v20
    s_nop 0
    v_cndmask_b32 v158, 0, v190, s[92:93]
    v_cndmask_b32 v174, v190, 0, s[92:93]
    v_cmp_le_i32 s[92:93], 2, v20
    v_cndmask_b32 v159, 0, v190, s[94:95]
    v_cndmask_b32 v175, v190, 0, s[94:95]
    v_cmp_le_i32 s[94:95], 3, v20
    v_cndmask_b32 v160, 0, v190, s[92:93]
    v_cndmask_b32 v176, v190, 0, s[92:93]
    v_cmp_le_i32 s[92:93], 4, v20
    v_cndmask_b32 v161, 0, v190, s[94:95]
    v_cndmask_b32 v177, v190, 0, s[94:95]
    v_cmp_le_i32 s[94:95], 5, v20
    v_cndmask_b32 v162, 0, v190, s[92:93]
    v_cndmask_b32 v178, v190, 0, s[92:93]
    v_cmp_le_i32 s[92:93], 6, v20
    v_cndmask_b32 v163, 0, v190, s[94:95]
    v_cndmask_b32 v179, v190, 0, s[94:95]
    v_cmp_le_i32 s[94:95], 7, v20
    v_cndmask_b32 v164, 0, v190, s[92:93]
    v_cndmask_b32 v180, v190, 0, s[92:93]
    v_cmp_le_i32 s[92:93], 16, v20
    v_cndmask_b32 v165, 0, v190, s[94:95]
    v_cndmask_b32 v181, v190, 0, s[94:95]
    v_cmp_le_i32 s[94:95], 17, v20
    v_cndmask_b32 v166, 0, v190, s[92:93]
    v_cndmask_b32 v182, v190, 0, s[92:93]
    v_cmp_le_i32 s[92:93], 18, v20
    v_cndmask_b32 v167, 0, v190, s[94:95]
    v_cndmask_b32 v183, v190, 0, s[94:95]
    v_cmp_le_i32 s[94:95], 19, v20
    v_cndmask_b32 v168, 0, v190, s[92:93]
    v_cndmask_b32 v184, v190, 0, s[92:93]
    v_cmp_le_i32 s[92:93], 20, v20
    v_cndmask_b32 v169, 0, v190, s[94:95]
    v_cndmask_b32 v185, v190, 0, s[94:95]
    v_cmp_le_i32 s[94:95], 21, v20
    v_cndmask_b32 v170, 0, v190, s[92:93]
    v_cndmask_b32 v186, v190, 0, s[92:93]
    v_cmp_le_i32 s[92:93], 22, v20
    v_cndmask_b32 v171, 0, v190, s[94:95]
    v_cndmask_b32 v187, v190, 0, s[94:95]
    v_cmp_le_i32 s[94:95], 23, v20
    v_cndmask_b32 v172, 0, v190, s[92:93]
    v_cndmask_b32 v188, v190, 0, s[92:93]
    v_cndmask_b32 v173, 0, v190, s[94:95]
    v_cndmask_b32 v189, v190, 0, s[94:95]
    ds_read_b128 v[30:33], v17 offset:0
    ds_read_b128 v[46:49], v18 offset:0
    ds_read_b128 v[34:37], v17 offset:512
    ds_read_b128 v[50:53], v18 offset:512
    ds_read_b128 v[38:41], v17 offset:1024
    ds_read_b128 v[54:57], v18 offset:1024
    ds_read_b128 v[42:45], v17 offset:1536
    ds_read_b128 v[58:61], v18 offset:1536
    s_waitcnt lgkmcnt(6)
    v_mfma_f32_32x32x16_bf16 v[94:109], v[30:33], v[22:25], v[158:173]
    v_mfma_f32_32x32x16_bf16 v[94:109], v[46:49], v[26:29], v[94:109]
    ds_read_b128 v[30:33], v17 offset:2048
    ds_read_b128 v[46:49], v18 offset:2048
    s_waitcnt lgkmcnt(6)
    v_mfma_f32_32x32x16_bf16 v[110:125], v[34:37], v[22:25], 0
    v_mfma_f32_32x32x16_bf16 v[110:125], v[50:53], v[26:29], v[110:125]
    ds_read_b128 v[34:37], v17 offset:2560
    ds_read_b128 v[50:53], v18 offset:2560
    s_waitcnt lgkmcnt(6)
    v_mfma_f32_32x32x16_bf16 v[126:141], v[38:41], v[22:25], 0
    s_nop 2
    s_cmp_lt_u32 s63, 8
    s_cbranch_scc1 fixo_45
fixb_46:
    v_max3_f32 v192, v94, v95, v96
    v_max3_f32 v193, v98, v99, v100
    v_max3_f32 v194, v102, v103, v104
    v_max3_f32 v195, v106, v107, v108
    v_mfma_f32_32x32x16_bf16 v[126:141], v[54:57], v[26:29], v[126:141]
    v_max_f32 v192, v192, v97
    v_max_f32 v193, v193, v101
    v_max_f32 v194, v194, v105
    v_max_f32 v195, v195, v109
    ds_read_b128 v[38:41], v17 offset:3072
    ds_read_b128 v[54:57], v18 offset:3072
    s_waitcnt lgkmcnt(6)
    v_mfma_f32_32x32x16_bf16 v[94:109], v[42:45], v[22:25], 0
    s_cmp_lt_u32 s63, 7
    s_cbranch_scc1 fixo_47
fixb_48:
    v_max3_f32 v192, v110, v111, v192
    v_max3_f32 v193, v112, v113, v193
    v_max3_f32 v194, v114, v115, v194
    v_max3_f32 v195, v116, v117, v195
    v_mfma_f32_32x32x16_bf16 v[94:109], v[58:61], v[26:29], v[94:109]
    v_max3_f32 v192, v118, v119, v192
    v_max3_f32 v193, v120, v121, v193
    v_max3_f32 v194, v122, v123, v194
    v_max3_f32 v195, v124, v125, v195
    ds_read_b128 v[42:45], v17 offset:3584
    ds_read_b128 v[58:61], v18 offset:3584
    s_waitcnt lgkmcnt(6)
    v_mfma_f32_32x32x16_bf16 v[110:125], v[30:33], v[22:25], 0
    s_cmp_lt_u32 s63, 6
    s_cbranch_scc1 fixo_49
fixb_50:
    v_max3_f32 v192, v126, v127, v192
    v_max3_f32 v193, v128, v129, v193
    v_max3_f32 v194, v130, v131, v194
    v_max3_f32 v195, v132, v133, v195
    v_mfma_f32_32x32x16_bf16 v[110:125], v[46:49], v[26:29], v[110:125]
    v_max3_f32 v192, v134, v135, v192
    v_max3_f32 v193, v136, v137, v193
    v_max3_f32 v194, v138, v139, v194
    v_max3_f32 v195, v140, v141, v195
    ds_read_b128 v[30:33], v17 offset:4096
    ds_read_b128 v[46:49], v18 offset:4096
    s_waitcnt lgkmcnt(6)
    v_mfma_f32_32x32x16_bf16 v[126:141], v[34:37], v[22:25], 0
    s_cmp_lt_u32 s63, 5
    s_cbranch_scc1 fixo_51
fixb_52:
    v_max3_f32 v192, v94, v95, v192
    v_max3_f32 v193, v96, v97, v193
    v_max3_f32 v194, v98, v99, v194
    v_max3_f32 v195, v100, v101, v195
    v_mfma_f32_32x32x16_bf16 v[126:141], v[50:53], v[26:29], v[126:141]
    v_max3_f32 v192, v102, v103, v192
    v_max3_f32 v193, v104, v105, v193
    v_max3_f32 v194, v106, v107, v194
    v_max3_f32 v195, v108, v109, v195
    s_waitcnt lgkmcnt(4)
    v_mfma_f32_32x32x16_bf16 v[94:109], v[38:41], v[22:25], 0
    s_cmp_lt_u32 s63, 4
    s_cbranch_scc1 fixo_53
fixb_54:
    v_max3_f32 v192, v110, v111, v192
    v_max3_f32 v193, v112, v113, v193
    v_max3_f32 v194, v114, v115, v194
    v_max3_f32 v195, v116, v117, v195
    v_mfma_f32_32x32x16_bf16 v[94:109], v[54:57], v[26:29], v[94:109]
    v_max3_f32 v192, v118, v119, v192
    v_max3_f32 v193, v120, v121, v193
    v_max3_f32 v194, v122, v123, v194
    v_max3_f32 v195, v124, v125, v195
    s_waitcnt lgkmcnt(2)
    v_mfma_f32_32x32x16_bf16 v[110:125], v[42:45], v[22:25], 0
    s_cmp_lt_u32 s63, 3
    s_cbranch_scc1 fixo_55
fixb_56:
    v_max3_f32 v192, v126, v127, v192
    v_max3_f32 v193, v128, v129, v193
    v_max3_f32 v194, v130, v131, v194
    v_max3_f32 v195, v132, v133, v195
    v_mfma_f32_32x32x16_bf16 v[110:125], v[58:61], v[26:29], v[110:125]
    v_max3_f32 v192, v134, v135, v192
    v_max3_f32 v193, v136, v137, v193
    v_max3_f32 v194, v138, v139, v194
    v_max3_f32 v195, v140, v141, v195
    s_waitcnt lgkmcnt(0)
    v_mfma_f32_32x32x16_bf16 v[126:141], v[30:33], v[22:25], v[174:189]
    s_cmp_lt_u32 s63, 2
    s_cbranch_scc1 fixo_57
fixb_58:
    v_max3_f32 v192, v94, v95, v192
    v_max3_f32 v193, v96, v97, v193
    v_max3_f32 v194, v98, v99, v194
    v_max3_f32 v195, v100, v101, v195
    v_mfma_f32_32x32x16_bf16 v[126:141], v[46:49], v[26:29], v[126:141]
    v_max3_f32 v192, v102, v103, v192
    v_max3_f32 v193, v104, v105, v193
    v_max3_f32 v194, v106, v107, v194
    v_max3_f32 v195, v108, v109, v195
    s_cmp_lt_u32 s63, 1
    s_cbranch_scc1 fixo_59
fixb_60:
    v_max3_f32 v192, v110, v111, v192
    v_max3_f32 v193, v112, v113, v193
    v_max3_f32 v194, v114, v115, v194
    v_max3_f32 v195, v116, v117, v195
    v_max3_f32 v192, v118, v119, v192
    v_max3_f32 v193, v120, v121, v193
    v_max3_f32 v194, v122, v123, v194
    v_max3_f32 v195, v124, v125, v195
    v_max3_f32 v192, v126, v127, v192
    v_max3_f32 v193, v128, v129, v193
    v_max3_f32 v194, v130, v131, v194
    v_max3_f32 v195, v132, v133, v195
    v_max3_f32 v192, v134, v135, v192
    v_max3_f32 v193, v136, v137, v193
    v_max3_f32 v194, v138, v139, v194
    v_max3_f32 v195, v140, v141, v195
    ds_read_b128 v[30:33], v17 offset:0
    ds_read_b128 v[46:49], v18 offset:0
    ds_read_b128 v[34:37], v17 offset:512
    ds_read_b128 v[50:53], v18 offset:512
    ds_read_b128 v[38:41], v17 offset:1024
    ds_read_b128 v[54:57], v18 offset:1024
    ds_read_b128 v[42:45], v17 offset:1536
    ds_read_b128 v[58:61], v18 offset:1536
    v_max3_f32 v192, v192, v193, v194
    v_max_f32 v192, v192, v195
    v_mov_b32 v193, v192
    s_nop 1
    v_permlane32_swap_b32 v192, v193
    s_nop 1
    v_max_f32 v192, v192, v193
    v_pk_add_f32 v[158:159], v[158:159], v[192:193] op_sel_hi:[1,0] neg_lo:[0,1] neg_hi:[0,1]
    v_pk_add_f32 v[160:161], v[160:161], v[192:193] op_sel_hi:[1,0] neg_lo:[0,1] neg_hi:[0,1]
    v_pk_add_f32 v[162:163], v[162:163], v[192:193] op_sel_hi:[1,0] neg_lo:[0,1] neg_hi:[0,1]
    v_pk_add_f32 v[164:165], v[164:165], v[192:193] op_sel_hi:[1,0] neg_lo:[0,1] neg_hi:[0,1]
    v_pk_add_f32 v[166:167], v[166:167], v[192:193] op_sel_hi:[1,0] neg_lo:[0,1] neg_hi:[0,1]
    v_pk_add_f32 v[168:169], v[168:169], v[192:193] op_sel_hi:[1,0] neg_lo:[0,1] neg_hi:[0,1]
    v_pk_add_f32 v[170:171], v[170:171], v[192:193] op_sel_hi:[1,0] neg_lo:[0,1] neg_hi:[0,1]
    v_pk_add_f32 v[172:173], v[172:173], v[192:193] op_sel_hi:[1,0] neg_lo:[0,1] neg_hi:[0,1]
    v_pk_mul_f32 v[142:143], v[192:193], -1.0 op_sel_hi:[0,0]
    v_pk_mul_f32 v[144:145], v[192:193], -1.0 op_sel_hi:[0,0]
    v_pk_mul_f32 v[146:147], v[192:193], -1.0 op_sel_hi:[0,0]
    v_pk_mul_f32 v[148:149], v[192:193], -1.0 op_sel_hi:[0,0]
    v_pk_mul_f32 v[150:151], v[192:193], -1.0 op_sel_hi:[0,0]
    v_pk_mul_f32 v[152:153], v[192:193], -1.0 op_sel_hi:[0,0]
    v_pk_mul_f32 v[154:155], v[192:193], -1.0 op_sel_hi:[0,0]
    v_pk_mul_f32 v[156:157], v[192:193], -1.0 op_sel_hi:[0,0]
    v_pk_add_f32 v[174:175], v[174:175], v[192:193] op_sel_hi:[1,0] neg_lo:[0,1] neg_hi:[0,1]
    v_pk_add_f32 v[176:177], v[176:177], v[192:193] op_sel_hi:[1,0] neg_lo:[0,1] neg_hi:[0,1]
    v_pk_add_f32 v[178:179], v[178:179], v[192:193] op_sel_hi:[1,0] neg_lo:[0,1] neg_hi:[0,1]
    v_pk_add_f32 v[180:181], v[180:181], v[192:193] op_sel_hi:[1,0] neg_lo:[0,1] neg_hi:[0,1]
    v_pk_add_f32 v[182:183], v[182:183], v[192:193] op_sel_hi:[1,0] neg_lo:[0,1] neg_hi:[0,1]
    v_pk_add_f32 v[184:185], v[184:185], v[192:193] op_sel_hi:[1,0] neg_lo:[0,1] neg_hi:[0,1]
    v_pk_add_f32 v[186:187], v[186:187], v[192:193] op_sel_hi:[1,0] neg_lo:[0,1] neg_hi:[0,1]
    v_pk_add_f32 v[188:189], v[188:189], v[192:193] op_sel_hi:[1,0] neg_lo:[0,1] neg_hi:[0,1]
    s_branch att_pass2_22
fixo_23:
    v_mov_b32 v94, v190
    v_mov_b32 v95, v190
    v_mov_b32 v96, v190
    v_mov_b32 v97, v190
    v_mov_b32 v98, v190
    v_mov_b32 v99, v190
    v_mov_b32 v100, v190
    v_mov_b32 v101, v190
    v_mov_b32 v102, v190
    v_mov_b32 v103, v190
    v_mov_b32 v104, v190
    v_mov_b32 v105, v190
    v_mov_b32 v106, v190
    v_mov_b32 v107, v190
    v_mov_b32 v108, v190
    v_mov_b32 v109, v190
    s_branch fixb_24
fixo_25:
    v_mov_b32 v110, v190
    v_mov_b32 v111, v190
    v_mov_b32 v112, v190
    v_mov_b32 v113, v190
    v_mov_b32 v114, v190
    v_mov_b32 v115, v190
    v_mov_b32 v116, v190
    v_mov_b32 v117, v190
    v_mov_b32 v118, v190
    v_mov_b32 v119, v190
    v_mov_b32 v120, v190
    v_mov_b32 v121, v190
    v_mov_b32 v122, v190
    v_mov_b32 v123, v190
    v_mov_b32 v124, v190
    v_mov_b32 v125, v190
    s_branch fixb_26
fixo_27:
    v_mov_b32 v126, v190
    v_mov_b32 v127, v190
    v_mov_b32 v128, v190
    v_mov_b32 v129, v190
    v_mov_b32 v130, v190
    v_mov_b32 v131, v190
    v_mov_b32 v132, v190
    v_mov_b32 v133, v190
    v_mov_b32 v134, v190
    v_mov_b32 v135, v190
    v_mov_b32 v136, v190
    v_mov_b32 v137, v190
    v_mov_b32 v138, v190
    v_mov_b32 v139, v190
    v_mov_b32 v140, v190
    v_mov_b32 v141, v190
    s_branch fixb_28
fixo_29:
    v_mov_b32 v94, v190
    v_mov_b32 v95, v190
    v_mov_b32 v96, v190
    v_mov_b32 v97, v190
    v_mov_b32 v98, v190
    v_mov_b32 v99, v190
    v_mov_b32 v100, v190
    v_mov_b32 v101, v190
    v_mov_b32 v102, v190
    v_mov_b32 v103, v190
    v_mov_b32 v104, v190
    v_mov_b32 v105, v190
    v_mov_b32 v106, v190
    v_mov_b32 v107, v190
    v_mov_b32 v108, v190
    v_mov_b32 v109, v190
    s_branch fixb_30
fixo_31:
    v_mov_b32 v110, v190
    v_mov_b32 v111, v190
    v_mov_b32 v112, v190
    v_mov_b32 v113, v190
    v_mov_b32 v114, v190
    v_mov_b32 v115, v190
    v_mov_b32 v116, v190
    v_mov_b32 v117, v190
    v_mov_b32 v118, v190
    v_mov_b32 v119, v190
    v_mov_b32 v120, v190
    v_mov_b32 v121, v190
    v_mov_b32 v122, v190
    v_mov_b32 v123, v190
    v_mov_b32 v124, v190
    v_mov_b32 v125, v190
    s_branch fixb_32
fixo_33:
    v_mov_b32 v126, v190
    v_mov_b32 v127, v190
    v_mov_b32 v128, v190
    v_mov_b32 v129, v190
    v_mov_b32 v130, v190
    v_mov_b32 v131, v190
    v_mov_b32 v132, v190
    v_mov_b32 v133, v190
    v_mov_b32 v134, v190
    v_mov_b32 v135, v190
    v_mov_b32 v136, v190
    v_mov_b32 v137, v190
    v_mov_b32 v138, v190
    v_mov_b32 v139, v190
    v_mov_b32 v140, v190
    v_mov_b32 v141, v190
    s_branch fixb_34
fixo_35:
    v_mov_b32 v94, v190
    v_mov_b32 v95, v190
    v_mov_b32 v96, v190
    v_mov_b32 v97, v190
    v_mov_b32 v98, v190
    v_mov_b32 v99, v190
    v_mov_b32 v100, v190
    v_mov_b32 v101, v190
    v_mov_b32 v102, v190
    v_mov_b32 v103, v190
    v_mov_b32 v104, v190
    v_mov_b32 v105, v190
    v_mov_b32 v106, v190
    v_mov_b32 v107, v190
    v_mov_b32 v108, v190
    v_mov_b32 v109, v190
    s_branch fixb_36
fixo_37:
    v_mov_b32 v110, v190
    v_mov_b32 v111, v190
    v_mov_b32 v112, v190
    v_mov_b32 v113, v190
    v_mov_b32 v114, v190
    v_mov_b32 v115, v190
    v_mov_b32 v116, v190
    v_mov_b32 v117, v190
    v_mov_b32 v118, v190
    v_mov_b32 v119, v190
    v_mov_b32 v120, v190
    v_mov_b32 v121, v190
    v_mov_b32 v122, v190
    v_mov_b32 v123, v190
    v_mov_b32 v124, v190
    v_mov_b32 v125, v190
    s_branch fixb_38
fixo_45:
    v_mov_b32 v94, v190
    v_mov_b32 v95, v190
    v_mov_b32 v96, v190
    v_mov_b32 v97, v190
    v_mov_b32 v98, v190
    v_mov_b32 v99, v190
    v_mov_b32 v100, v190
    v_mov_b32 v101, v190
    v_mov_b32 v102, v190
    v_mov_b32 v103, v190
    v_mov_b32 v104, v190
    v_mov_b32 v105, v190
    v_mov_b32 v106, v190
    v_mov_b32 v107, v190
    v_mov_b32 v108, v190
    v_mov_b32 v109, v190
    s_branch fixb_46
fixo_47:
    v_mov_b32 v110, v190
    v_mov_b32 v111, v190
    v_mov_b32 v112, v190
    v_mov_b32 v113, v190
    v_mov_b32 v114, v190
    v_mov_b32 v115, v190
    v_mov_b32 v116, v190
    v_mov_b32 v117, v190
    v_mov_b32 v118, v190
    v_mov_b32 v119, v190
    v_mov_b32 v120, v190
    v_mov_b32 v121, v190
    v_mov_b32 v122, v190
    v_mov_b32 v123, v190
    v_mov_b32 v124, v190
    v_mov_b32 v125, v190
    s_branch fixb_48
fixo_49:
    v_mov_b32 v126, v190
    v_mov_b32 v127, v190
    v_mov_b32 v128, v190
    v_mov_b32 v129, v190
    v_mov_b32 v130, v190
    v_mov_b32 v131, v190
    v_mov_b32 v132, v190
    v_mov_b32 v133, v190
    v_mov_b32 v134, v190
    v_mov_b32 v135, v190
    v_mov_b32 v136, v190
    v_mov_b32 v137, v190
    v_mov_b32 v138, v190
    v_mov_b32 v139, v190
    v_mov_b32 v140, v190
    v_mov_b32 v141, v190
    s_branch fixb_50
fixo_51:
    v_mov_b32 v94, v190
    v_mov_b32 v95, v190
    v_mov_b32 v96, v190
    v_mov_b32 v97, v190
    v_mov_b32 v98, v190
    v_mov_b32 v99, v190
    v_mov_b32 v100, v190
    v_mov_b32 v101, v190
    v_mov_b32 v102, v190
    v_mov_b32 v103, v190
    v_mov_b32 v104, v190
    v_mov_b32 v105, v190
    v_mov_b32 v106, v190
    v_mov_b32 v107, v190
    v_mov_b32 v108, v190
    v_mov_b32 v109, v190
    s_branch fixb_52
fixo_53:
    v_mov_b32 v110, v190
    v_mov_b32 v111, v190
    v_mov_b32 v112, v190
    v_mov_b32 v113, v190
    v_mov_b32 v114, v190
    v_mov_b32 v115, v190
    v_mov_b32 v116, v190
    v_mov_b32 v117, v190
    v_mov_b32 v118, v190
    v_mov_b32 v119, v190
    v_mov_b32 v120, v190
    v_mov_b32 v121, v190
    v_mov_b32 v122, v190
    v_mov_b32 v123, v190
    v_mov_b32 v124, v190
    v_mov_b32 v125, v190
    s_branch fixb_54
fixo_55:
    v_mov_b32 v126, v190
    v_mov_b32 v127, v190
    v_mov_b32 v128, v190
    v_mov_b32 v129, v190
    v_mov_b32 v130, v190
    v_mov_b32 v131, v190
    v_mov_b32 v132, v190
    v_mov_b32 v133, v190
    v_mov_b32 v134, v190
    v_mov_b32 v135, v190
    v_mov_b32 v136, v190
    v_mov_b32 v137, v190
    v_mov_b32 v138, v190
    v_mov_b32 v139, v190
    v_mov_b32 v140, v190
    v_mov_b32 v141, v190
    s_branch fixb_56
fixo_57:
    v_mov_b32 v94, v190
    v_mov_b32 v95, v190
    v_mov_b32 v96, v190
    v_mov_b32 v97, v190
    v_mov_b32 v98, v190
    v_mov_b32 v99, v190
    v_mov_b32 v100, v190
    v_mov_b32 v101, v190
    v_mov_b32 v102, v190
    v_mov_b32 v103, v190
    v_mov_b32 v104, v190
    v_mov_b32 v105, v190
    v_mov_b32 v106, v190
    v_mov_b32 v107, v190
    v_mov_b32 v108, v190
    v_mov_b32 v109, v190
    s_branch fixb_58
fixo_59:
    v_mov_b32 v110, v190
    v_mov_b32 v111, v190
    v_mov_b32 v112, v190
    v_mov_b32 v113, v190
    v_mov_b32 v114, v190
    v_mov_b32 v115, v190
    v_mov_b32 v116, v190
    v_mov_b32 v117, v190
    v_mov_b32 v118, v190
    v_mov_b32 v119, v190
    v_mov_b32 v120, v190
    v_mov_b32 v121, v190
    v_mov_b32 v122, v190
    v_mov_b32 v123, v190
    v_mov_b32 v124, v190
    v_mov_b32 v125, v190
    s_branch fixb_60
att_done_44:
    s_cmp_lt_u32 s58, 7
    s_cbranch_scc1 wpf4_skip_61
    s_and_b32 s59, s26, 3
    s_lshl_b32 s59, s59, 3
    s_add_u32 s59, s59, s25
    s_lshl_b32 s59, s59, 3
    s_add_u32 s59, s59, s24
    s_lshl_b32 s59, s59, 14
    v_lshlrev_b32 v4, 7, v1
    v_add_u32 v4, s59, v4
    s_mov_b32 s28, s16
    s_and_b32 s29, s17, 0xffff
    s_mov_b32 s30, 2211840
    s_mov_b32 s31, 0x20000
    s_mov_b32 s59, 0
    buffer_load_dword v255, v4, s[28:31], s59 offen
    s_mov_b32 s59, 8192
    buffer_load_dword v255, v4, s[28:31], s59 offen
wpf4_skip_61:
    s_cmp_lg_u32 s2, 248
    s_cbranch_scc1 nogen_62
    s_cmp_lg_u32 s24, 0
    s_cbranch_scc1 nogen_62
    s_mov_b64 s[60:61], -1
    v_lshrrev_b32 v4, 4, v1
    v_add_u32 v4, 16, v4
    v_lshlrev_b32 v4, 8, v4
    v_and_b32 v5, 15, v1
    v_lshl_add_u32 v4, v5, 2, v4
    s_waitcnt vmcnt(0)
    s_mov_b32 s62, 400000
    s_mov_b64 exec, s[60:61]
poll_63:
    buffer_load_dword v5, v4, s[48:51], 0 offen sc1
    s_waitcnt vmcnt(0)
    v_subrev_u32 v5, v2, v5
    v_cmp_ne_u32 vcc, 1, v5
    s_cmp_eq_u64 vcc, 0
    s_cbranch_scc1 polled_64
    s_sub_u32 s62, s62, 1
    s_cmp_lg_u32 s62, 0
    s_cbranch_scc1 poll_63
polled_64:
    s_mov_b64 exec, -1
    v_lshrrev_b32 v4, 4, v1
    v_add_u32 v4, 20, v4
    v_lshlrev_b32 v4, 8, v4
    v_and_b32 v5, 15, v1
    v_lshl_add_u32 v4, v5, 2, v4
    s_waitcnt vmcnt(0)
    s_mov_b32 s62, 400000
    s_mov_b64 exec, s[60:61]
poll_65:
    buffer_load_dword v5, v4, s[48:51], 0 offen sc1
    s_waitcnt vmcnt(0)
    v_subrev_u32 v5, v2, v5
    v_cmp_ne_u32 vcc, 1, v5
    s_cmp_eq_u64 vcc, 0
    s_cbranch_scc1 polled_66
    s_sub_u32 s62, s62, 1
    s_cmp_lg_u32 s62, 0
    s_cbranch_scc1 poll_65
polled_66:
    s_mov_b64 exec, -1
    v_lshrrev_b32 v4, 4, v1
    v_add_u32 v4, 24, v4
    v_lshlrev_b32 v4, 8, v4
    v_and_b32 v5, 15, v1
    v_lshl_add_u32 v4, v5, 2, v4
    s_waitcnt vmcnt(0)
    s_mov_b32 s62, 400000
    s_mov_b64 exec, s[60:61]
poll_67:
    buffer_load_dword v5, v4, s[48:51], 0 offen sc1
    s_waitcnt vmcnt(0)
    v_subrev_u32 v5, v2, v5
    v_cmp_ne_u32 vcc, 1, v5
    s_cmp_eq_u64 vcc, 0
    s_cbranch_scc1 polled_68
    s_sub_u32 s62, s62, 1
    s_cmp_lg_u32 s62, 0
    s_cbranch_scc1 poll_67
polled_68:
    s_mov_b64 exec, -1
    v_lshrrev_b32 v4, 4, v1
    v_add_u32 v4, 28, v4
    v_lshlrev_b32 v4, 8, v4
    v_and_b32 v5, 15, v1
    v_lshl_add_u32 v4, v5, 2, v4
    s_waitcnt vmcnt(0)
    s_mov_b32 s62, 400000
    s_mov_b64 exec, s[60:61]
poll_69:
    buffer_load_dword v5, v4, s[48:51], 0 offen sc1
    s_waitcnt vmcnt(0)
    v_subrev_u32 v5, v2, v5
    v_cmp_ne_u32 vcc, 1, v5
    s_cmp_eq_u64 vcc, 0
    s_cbranch_scc1 polled_70
    s_sub_u32 s62, s62, 1
    s_cmp_lg_u32 s62, 0
    s_cbranch_scc1 poll_69
polled_70:
    s_mov_b64 exec, -1
    v_add_u32 v5, 1, v2
    v_mov_b32 v4, 32768
    s_mov_b64 exec, 1
    buffer_store_dword v5, v4, s[48:51], 0 offen sc1
    s_mov_b64 exec, -1
nogen_62:
    s_cmp_ge_u32 s24, 4
    s_cbranch_scc1 sequential_preLN__sliding_block__dense_activation_squared_relu__prompt_kernel_lrest
    s_cmp_ge_u32 s58, 5
    s_cbranch_scc1 c_nowo_71
    s_lshl_b32 s59, s54, 7
    s_add_u32 s28, s22, 10485760
    s_addc_u32 s29, s23, 0
    s_and_b32 s29, s29, 0xffff
    s_mov_b32 s30, 2621440
    s_mov_b32 s31, 0x20000
    v_and_b32 v8, 31, v1
    v_lshrrev_b32 v9, 5, v1
    s_mov_b32 s61, s24
    s_mov_b32 s62, 0
    s_mov_b32 s63, 1
    s_lshl_b32 s64, s61, 9
    s_add_u32 s64, s64, 4096
    v_lshlrev_b32 v4, 4, v8
    v_lshl_add_u32 v4, v9, 11, v4
    v_add_u32 v10, s64, v4
    v_bfe_u32 v4, v1, 2, 2
    v_lshrrev_b32 v5, 1, v4
    v_xor_b32 v5, s62, v5
    v_lshlrev_b32 v5, 2, v5
    v_bfe_u32 v6, v1, 4, 1
    v_lshl_add_u32 v5, v6, 1, v5
    v_bfe_u32 v6, v1, 1, 1
    v_add_u32 v5, v5, v6
    v_lshlrev_b32 v5, 4, v5
    v_and_b32 v6, 1, v1
    v_lshl_add_u32 v5, v6, 3, v5
    v_lshl_add_u32 v4, v9, 3, v4
    v_mul_u32_u24 v4, 128, v4
    v_add_u32 v4, v4, v5
    v_add_u32 v11, 75776, v4
    v_add_u32 v12, 65536, v11
    v_bfe_u32 v4, v1, 2, 2
    v_lshrrev_b32 v5, 1, v4
    v_xor_b32 v5, s63, v5
    v_lshlrev_b32 v5, 2, v5
    v_bfe_u32 v6, v1, 4, 1
    v_lshl_add_u32 v5, v6, 1, v5
    v_bfe_u32 v6, v1, 1, 1
    v_add_u32 v5, v5, v6
    v_lshlrev_b32 v5, 4, v5
    v_and_b32 v6, 1, v1
    v_lshl_add_u32 v5, v6, 3, v5
    v_lshl_add_u32 v4, v9, 3, v4
    v_mul_u32_u24 v4, 128, v4
    v_add_u32 v4, v4, v5
    v_add_u32 v13, 75776, v4
    v_add_u32 v14, 65536, v13
    s_lshl_b32 s64, s24, 5
    s_add_u32 s64, s64, s59
    v_add_u32 v100, s64, v8
    s_mov_b32 s36, s4
    s_and_b32 s37, s5, 0xffff
    s_mov_b32 s38, 2621440
    s_mov_b32 s39, 0x20000
    v_mul_u32_u24 v101, 1280, v100
    v_lshl_add_u32 v101, v9, 3, v101
    s_lshl_b32 s64, s55, 7
    buffer_load_dwordx2 v[84:85], v101, s[36:39], s64 offen offset:0
    buffer_load_dwordx2 v[86:87], v101, s[36:39], s64 offen offset:16
    buffer_load_dwordx2 v[88:89], v101, s[36:39], s64 offen offset:32
    buffer_load_dwordx2 v[90:91], v101, s[36:39], s64 offen offset:48
    buffer_load_dwordx2 v[92:93], v101, s[36:39], s64 offen offset:64
    buffer_load_dwordx2 v[94:95], v101, s[36:39], s64 offen offset:80
    buffer_load_dwordx2 v[96:97], v101, s[36:39], s64 offen offset:96
    buffer_load_dwordx2 v[98:99], v101, s[36:39], s64 offen offset:112
    v_lshlrev_b32 v100, 4, v100
    v_lshl_add_u32 v100, v9, 15, v100
    s_cmp_lg_u32 s24, 0
    s_cbranch_scc1 nob2_73
    s_mov_b32 s32, s18
    s_and_b32 s33, s19, 0xffff
    s_mov_b32 s34, 1280
    s_mov_b32 s35, 0x20000
    s_lshl_b32 s64, s55, 7
    v_lshl_add_u32 v103, v1, 2, s64
    buffer_load_dword v102, v103, s[32:35], 0 offen
nob2_73:
    s_cmp_lg_u32 s24, 0
    s_cbranch_scc1 nopoll_74
    s_add_u32 s68, s54, 16
    s_lshl_b32 s68, s68, 8
    v_lshl_add_u32 v104, v1, 2, s68
    s_mov_b32 s70, 0xffff
    s_mov_b32 s71, 0
    s_waitcnt vmcnt(0)
    s_mov_b32 s72, 400000
    s_mov_b64 exec, s[70:71]
poll_75:
    buffer_load_dword v105, v104, s[48:51], 0 offen sc1
    s_waitcnt vmcnt(0)
    v_subrev_u32 v105, v2, v105
    v_cmp_ne_u32 vcc, 1, v105
    s_cmp_eq_u64 vcc, 0
    s_cbranch_scc1 polled_76
    s_sub_u32 s72, s72, 1
    s_cmp_lg_u32 s72, 0
    s_cbranch_scc1 poll_75
polled_76:
    s_mov_b64 exec, -1
nopoll_74:
    s_cmp_lg_u32 s24, 0
    s_cbranch_scc1 nob3_77
    v_lshlrev_b32 v103, 2, v1
    ds_write_b32 v103, v102 offset:3072
    s_waitcnt lgkmcnt(0)
nob3_77:
    s_barrier
    s_waitcnt vmcnt(0)
    v_lshlrev_b32 v52, 16, v84
    v_and_b32 v53, 0xffff0000, v84
    v_lshlrev_b32 v54, 16, v85
    v_and_b32 v55, 0xffff0000, v85
    v_lshlrev_b32 v56, 16, v86
    v_and_b32 v57, 0xffff0000, v86
    v_lshlrev_b32 v58, 16, v87
    v_and_b32 v59, 0xffff0000, v87
    v_lshlrev_b32 v60, 16, v88
    v_and_b32 v61, 0xffff0000, v88
    v_lshlrev_b32 v62, 16, v89
    v_and_b32 v63, 0xffff0000, v89
    v_lshlrev_b32 v64, 16, v90
    v_and_b32 v65, 0xffff0000, v90
    v_lshlrev_b32 v66, 16, v91
    v_and_b32 v67, 0xffff0000, v91
    v_lshlrev_b32 v68, 16, v92
    v_and_b32 v69, 0xffff0000, v92
    v_lshlrev_b32 v70, 16, v93
    v_and_b32 v71, 0xffff0000, v93
    v_lshlrev_b32 v72, 16, v94
    v_and_b32 v73, 0xffff0000, v94
    v_lshlrev_b32 v74, 16, v95
    v_and_b32 v75, 0xffff0000, v95
    v_lshlrev_b32 v76, 16, v96
    v_and_b32 v77, 0xffff0000, v96
    v_lshlrev_b32 v78, 16, v97
    v_and_b32 v79, 0xffff0000, v97
    v_lshlrev_b32 v80, 16, v98
    v_and_b32 v81, 0xffff0000, v98
    v_lshlrev_b32 v82, 16, v99
    v_and_b32 v83, 0xffff0000, v99
    s_barrier
    ds_read_b128 v[16:19], v10 offset:0
    ds_read_b64_tr_b16 v[28:29], v11 offset:0
    ds_read_b64_tr_b16 v[30:31], v11 offset:512
    ds_read_b64_tr_b16 v[32:33], v13 offset:0
    ds_read_b64_tr_b16 v[34:35], v13 offset:512
    ds_read_b128 v[20:23], v10 offset:4096
    ds_read_b64_tr_b16 v[36:37], v11 offset:2048
    ds_read_b64_tr_b16 v[38:39], v11 offset:2560
    ds_read_b64_tr_b16 v[40:41], v13 offset:2048
    ds_read_b64_tr_b16 v[42:43], v13 offset:2560
    s_waitcnt lgkmcnt(5)
    v_mfma_f32_32x32x16_bf16 v[52:67], v[28:31], v[16:19], v[52:67]
    ds_read_b128 v[24:27], v10 offset:8192
    ds_read_b64_tr_b16 v[44:45], v11 offset:4096
    ds_read_b64_tr_b16 v[46:47], v11 offset:4608
    v_mfma_f32_32x32x16_bf16 v[68:83], v[32:35], v[16:19], v[68:83]
    ds_read_b64_tr_b16 v[48:49], v13 offset:4096
    ds_read_b64_tr_b16 v[50:51], v13 offset:4608
    s_waitcnt lgkmcnt(5)
    v_mfma_f32_32x32x16_bf16 v[52:67], v[36:39], v[20:23], v[52:67]
    ds_read_b128 v[16:19], v10 offset:12288
    ds_read_b64_tr_b16 v[28:29], v11 offset:6144
    ds_read_b64_tr_b16 v[30:31], v11 offset:6656
    v_mfma_f32_32x32x16_bf16 v[68:83], v[40:43], v[20:23], v[68:83]
    ds_read_b64_tr_b16 v[32:33], v13 offset:6144
    ds_read_b64_tr_b16 v[34:35], v13 offset:6656
    s_waitcnt lgkmcnt(0)
    s_barrier
    v_mfma_f32_32x32x16_bf16 v[52:67], v[44:47], v[24:27], v[52:67]
    ds_read_b128 v[20:23], v10 offset:16384
    ds_read_b64_tr_b16 v[36:37], v11 offset:8192
    ds_read_b64_tr_b16 v[38:39], v11 offset:8704
    v_mfma_f32_32x32x16_bf16 v[68:83], v[48:51], v[24:27], v[68:83]
    ds_read_b64_tr_b16 v[40:41], v13 offset:8192
    ds_read_b64_tr_b16 v[42:43], v13 offset:8704
    s_waitcnt lgkmcnt(5)
    v_mfma_f32_32x32x16_bf16 v[52:67], v[28:31], v[16:19], v[52:67]
    ds_read_b128 v[24:27], v10 offset:20480
    ds_read_b64_tr_b16 v[44:45], v11 offset:10240
    ds_read_b64_tr_b16 v[46:47], v11 offset:10752
    v_mfma_f32_32x32x16_bf16 v[68:83], v[32:35], v[16:19], v[68:83]
    ds_read_b64_tr_b16 v[48:49], v13 offset:10240
    ds_read_b64_tr_b16 v[50:51], v13 offset:10752
    s_waitcnt lgkmcnt(5)
    v_mfma_f32_32x32x16_bf16 v[52:67], v[36:39], v[20:23], v[52:67]
    ds_read_b128 v[16:19], v10 offset:24576
    ds_read_b64_tr_b16 v[28:29], v11 offset:12288
    ds_read_b64_tr_b16 v[30:31], v11 offset:12800
    v_mfma_f32_32x32x16_bf16 v[68:83], v[40:43], v[20:23], v[68:83]
    ds_read_b64_tr_b16 v[32:33], v13 offset:12288
    ds_read_b64_tr_b16 v[34:35], v13 offset:12800
    s_waitcnt lgkmcnt(5)
    v_mfma_f32_32x32x16_bf16 v[52:67], v[44:47], v[24:27], v[52:67]
    ds_read_b128 v[20:23], v10 offset:28672
    ds_read_b64_tr_b16 v[36:37], v11 offset:14336
    ds_read_b64_tr_b16 v[38:39], v11 offset:14848
    v_mfma_f32_32x32x16_bf16 v[68:83], v[48:51], v[24:27], v[68:83]
    ds_read_b64_tr_b16 v[40:41], v13 offset:14336
    ds_read_b64_tr_b16 v[42:43], v13 offset:14848
    s_waitcnt lgkmcnt(0)
    s_barrier
    v_mfma_f32_32x32x16_bf16 v[52:67], v[28:31], v[16:19], v[52:67]
    ds_read_b128 v[24:27], v10 offset:32768
    ds_read_b64_tr_b16 v[44:45], v11 offset:16384
    ds_read_b64_tr_b16 v[46:47], v11 offset:16896
    v_mfma_f32_32x32x16_bf16 v[68:83], v[32:35], v[16:19], v[68:83]
    ds_read_b64_tr_b16 v[48:49], v13 offset:16384
    ds_read_b64_tr_b16 v[50:51], v13 offset:16896
    s_waitcnt lgkmcnt(5)
    v_mfma_f32_32x32x16_bf16 v[52:67], v[36:39], v[20:23], v[52:67]
    ds_read_b128 v[16:19], v10 offset:36864
    ds_read_b64_tr_b16 v[28:29], v11 offset:18432
    ds_read_b64_tr_b16 v[30:31], v11 offset:18944
    v_mfma_f32_32x32x16_bf16 v[68:83], v[40:43], v[20:23], v[68:83]
    ds_read_b64_tr_b16 v[32:33], v13 offset:18432
    ds_read_b64_tr_b16 v[34:35], v13 offset:18944
    s_waitcnt lgkmcnt(5)
    v_mfma_f32_32x32x16_bf16 v[52:67], v[44:47], v[24:27], v[52:67]
    ds_read_b128 v[20:23], v10 offset:40960
    ds_read_b64_tr_b16 v[36:37], v11 offset:20480
    ds_read_b64_tr_b16 v[38:39], v11 offset:20992
    v_mfma_f32_32x32x16_bf16 v[68:83], v[48:51], v[24:27], v[68:83]
    ds_read_b64_tr_b16 v[40:41], v13 offset:20480
    ds_read_b64_tr_b16 v[42:43], v13 offset:20992
    s_waitcnt lgkmcnt(5)
    v_mfma_f32_32x32x16_bf16 v[52:67], v[28:31], v[16:19], v[52:67]
    ds_read_b128 v[24:27], v10 offset:45056
    ds_read_b64_tr_b16 v[44:45], v11 offset:22528
    ds_read_b64_tr_b16 v[46:47], v11 offset:23040
    v_mfma_f32_32x32x16_bf16 v[68:83], v[32:35], v[16:19], v[68:83]
    ds_read_b64_tr_b16 v[48:49], v13 offset:22528
    ds_read_b64_tr_b16 v[50:51], v13 offset:23040
    s_waitcnt lgkmcnt(0)
    s_barrier
    v_mfma_f32_32x32x16_bf16 v[52:67], v[36:39], v[20:23], v[52:67]
    ds_read_b128 v[16:19], v10 offset:49152
    ds_read_b64_tr_b16 v[28:29], v11 offset:24576
    ds_read_b64_tr_b16 v[30:31], v11 offset:25088
    v_mfma_f32_32x32x16_bf16 v[68:83], v[40:43], v[20:23], v[68:83]
    ds_read_b64_tr_b16 v[32:33], v13 offset:24576
    ds_read_b64_tr_b16 v[34:35], v13 offset:25088
    s_waitcnt lgkmcnt(5)
    v_mfma_f32_32x32x16_bf16 v[52:67], v[44:47], v[24:27], v[52:67]
    ds_read_b128 v[20:23], v10 offset:53248
    ds_read_b64_tr_b16 v[36:37], v11 offset:26624
    ds_read_b64_tr_b16 v[38:39], v11 offset:27136
    v_mfma_f32_32x32x16_bf16 v[68:83], v[48:51], v[24:27], v[68:83]
    ds_read_b64_tr_b16 v[40:41], v13 offset:26624
    ds_read_b64_tr_b16 v[42:43], v13 offset:27136
    s_waitcnt lgkmcnt(5)
    v_mfma_f32_32x32x16_bf16 v[52:67], v[28:31], v[16:19], v[52:67]
    ds_read_b128 v[24:27], v10 offset:57344
    ds_read_b64_tr_b16 v[44:45], v11 offset:28672
    ds_read_b64_tr_b16 v[46:47], v11 offset:29184
    v_mfma_f32_32x32x16_bf16 v[68:83], v[32:35], v[16:19], v[68:83]
    ds_read_b64_tr_b16 v[48:49], v13 offset:28672
    ds_read_b64_tr_b16 v[50:51], v13 offset:29184
    s_waitcnt lgkmcnt(5)
    v_mfma_f32_32x32x16_bf16 v[52:67], v[36:39], v[20:23], v[52:67]
    ds_read_b128 v[16:19], v10 offset:61440
    ds_read_b64_tr_b16 v[28:29], v11 offset:30720
    ds_read_b64_tr_b16 v[30:31], v11 offset:31232
    v_mfma_f32_32x32x16_bf16 v[68:83], v[40:43], v[20:23], v[68:83]
    ds_read_b64_tr_b16 v[32:33], v13 offset:30720
    ds_read_b64_tr_b16 v[34:35], v13 offset:31232
    s_waitcnt lgkmcnt(0)
    s_barrier
    v_mfma_f32_32x32x16_bf16 v[52:67], v[44:47], v[24:27], v[52:67]
    ds_read_b128 v[20:23], v10 offset:0
    ds_read_b64_tr_b16 v[36:37], v11 offset:32768
    ds_read_b64_tr_b16 v[38:39], v11 offset:33280
    v_mfma_f32_32x32x16_bf16 v[68:83], v[48:51], v[24:27], v[68:83]
    ds_read_b64_tr_b16 v[40:41], v13 offset:32768
    ds_read_b64_tr_b16 v[42:43], v13 offset:33280
    s_waitcnt lgkmcnt(5)
    v_mfma_f32_32x32x16_bf16 v[52:67], v[28:31], v[16:19], v[52:67]
    ds_read_b128 v[24:27], v10 offset:4096
    ds_read_b64_tr_b16 v[44:45], v11 offset:34816
    ds_read_b64_tr_b16 v[46:47], v11 offset:35328
    v_mfma_f32_32x32x16_bf16 v[68:83], v[32:35], v[16:19], v[68:83]
    ds_read_b64_tr_b16 v[48:49], v13 offset:34816
    ds_read_b64_tr_b16 v[50:51], v13 offset:35328
    s_waitcnt lgkmcnt(5)
    v_mfma_f32_32x32x16_bf16 v[52:67], v[36:39], v[20:23], v[52:67]
    ds_read_b128 v[16:19], v10 offset:8192
    ds_read_b64_tr_b16 v[28:29], v11 offset:36864
    ds_read_b64_tr_b16 v[30:31], v11 offset:37376
    v_mfma_f32_32x32x16_bf16 v[68:83], v[40:43], v[20:23], v[68:83]
    ds_read_b64_tr_b16 v[32:33], v13 offset:36864
    ds_read_b64_tr_b16 v[34:35], v13 offset:37376
    s_waitcnt lgkmcnt(5)
    v_mfma_f32_32x32x16_bf16 v[52:67], v[44:47], v[24:27], v[52:67]
    ds_read_b128 v[20:23], v10 offset:12288
    ds_read_b64_tr_b16 v[36:37], v11 offset:38912
    ds_read_b64_tr_b16 v[38:39], v11 offset:39424
    v_mfma_f32_32x32x16_bf16 v[68:83], v[48:51], v[24:27], v[68:83]
    ds_read_b64_tr_b16 v[40:41], v13 offset:38912
    ds_read_b64_tr_b16 v[42:43], v13 offset:39424
    s_waitcnt lgkmcnt(0)
    s_barrier
    v_mfma_f32_32x32x16_bf16 v[52:67], v[28:31], v[16:19], v[52:67]
    ds_read_b128 v[24:27], v10 offset:16384
    ds_read_b64_tr_b16 v[44:45], v11 offset:40960
    ds_read_b64_tr_b16 v[46:47], v11 offset:41472
    v_mfma_f32_32x32x16_bf16 v[68:83], v[32:35], v[16:19], v[68:83]
    ds_read_b64_tr_b16 v[48:49], v13 offset:40960
    ds_read_b64_tr_b16 v[50:51], v13 offset:41472
    s_waitcnt lgkmcnt(5)
    v_mfma_f32_32x32x16_bf16 v[52:67], v[36:39], v[20:23], v[52:67]
    ds_read_b128 v[16:19], v10 offset:20480
    ds_read_b64_tr_b16 v[28:29], v11 offset:43008
    ds_read_b64_tr_b16 v[30:31], v11 offset:43520
    v_mfma_f32_32x32x16_bf16 v[68:83], v[40:43], v[20:23], v[68:83]
    ds_read_b64_tr_b16 v[32:33], v13 offset:43008
    ds_read_b64_tr_b16 v[34:35], v13 offset:43520
    s_waitcnt lgkmcnt(5)
    v_mfma_f32_32x32x16_bf16 v[52:67], v[44:47], v[24:27], v[52:67]
    ds_read_b128 v[20:23], v10 offset:24576
    ds_read_b64_tr_b16 v[36:37], v11 offset:45056
    ds_read_b64_tr_b16 v[38:39], v11 offset:45568
    v_mfma_f32_32x32x16_bf16 v[68:83], v[48:51], v[24:27], v[68:83]
    ds_read_b64_tr_b16 v[40:41], v13 offset:45056
    ds_read_b64_tr_b16 v[42:43], v13 offset:45568
    s_waitcnt lgkmcnt(5)
    v_mfma_f32_32x32x16_bf16 v[52:67], v[28:31], v[16:19], v[52:67]
    ds_read_b128 v[24:27], v10 offset:28672
    ds_read_b64_tr_b16 v[44:45], v11 offset:47104
    ds_read_b64_tr_b16 v[46:47], v11 offset:47616
    v_mfma_f32_32x32x16_bf16 v[68:83], v[32:35], v[16:19], v[68:83]
    ds_read_b64_tr_b16 v[48:49], v13 offset:47104
    ds_read_b64_tr_b16 v[50:51], v13 offset:47616
    s_waitcnt lgkmcnt(0)
    s_barrier
    v_mfma_f32_32x32x16_bf16 v[52:67], v[36:39], v[20:23], v[52:67]
    ds_read_b128 v[16:19], v10 offset:32768
    ds_read_b64_tr_b16 v[28:29], v11 offset:49152
    ds_read_b64_tr_b16 v[30:31], v11 offset:49664
    v_mfma_f32_32x32x16_bf16 v[68:83], v[40:43], v[20:23], v[68:83]
    ds_read_b64_tr_b16 v[32:33], v13 offset:49152
    ds_read_b64_tr_b16 v[34:35], v13 offset:49664
    s_waitcnt lgkmcnt(5)
    v_mfma_f32_32x32x16_bf16 v[52:67], v[44:47], v[24:27], v[52:67]
    ds_read_b128 v[20:23], v10 offset:36864
    ds_read_b64_tr_b16 v[36:37], v11 offset:51200
    ds_read_b64_tr_b16 v[38:39], v11 offset:51712
    v_mfma_f32_32x32x16_bf16 v[68:83], v[48:51], v[24:27], v[68:83]
    ds_read_b64_tr_b16 v[40:41], v13 offset:51200
    ds_read_b64_tr_b16 v[42:43], v13 offset:51712
    s_waitcnt lgkmcnt(5)
    v_mfma_f32_32x32x16_bf16 v[52:67], v[28:31], v[16:19], v[52:67]
    ds_read_b128 v[24:27], v10 offset:40960
    ds_read_b64_tr_b16 v[44:45], v11 offset:53248
    ds_read_b64_tr_b16 v[46:47], v11 offset:53760
    v_mfma_f32_32x32x16_bf16 v[68:83], v[32:35], v[16:19], v[68:83]
    ds_read_b64_tr_b16 v[48:49], v13 offset:53248
    ds_read_b64_tr_b16 v[50:51], v13 offset:53760
    s_waitcnt lgkmcnt(5)
    v_mfma_f32_32x32x16_bf16 v[52:67], v[36:39], v[20:23], v[52:67]
    ds_read_b128 v[16:19], v10 offset:45056
    ds_read_b64_tr_b16 v[28:29], v11 offset:55296
    ds_read_b64_tr_b16 v[30:31], v11 offset:55808
    v_mfma_f32_32x32x16_bf16 v[68:83], v[40:43], v[20:23], v[68:83]
    ds_read_b64_tr_b16 v[32:33], v13 offset:55296
    ds_read_b64_tr_b16 v[34:35], v13 offset:55808
    s_waitcnt lgkmcnt(0)
    s_barrier
    v_mfma_f32_32x32x16_bf16 v[52:67], v[44:47], v[24:27], v[52:67]
    ds_read_b128 v[20:23], v10 offset:49152
    ds_read_b64_tr_b16 v[36:37], v11 offset:57344
    ds_read_b64_tr_b16 v[38:39], v11 offset:57856
    v_mfma_f32_32x32x16_bf16 v[68:83], v[48:51], v[24:27], v[68:83]
    ds_read_b64_tr_b16 v[40:41], v13 offset:57344
    ds_read_b64_tr_b16 v[42:43], v13 offset:57856
    s_waitcnt lgkmcnt(5)
    v_mfma_f32_32x32x16_bf16 v[52:67], v[28:31], v[16:19], v[52:67]
    ds_read_b128 v[24:27], v10 offset:53248
    ds_read_b64_tr_b16 v[44:45], v11 offset:59392
    ds_read_b64_tr_b16 v[46:47], v11 offset:59904
    v_mfma_f32_32x32x16_bf16 v[68:83], v[32:35], v[16:19], v[68:83]
    ds_read_b64_tr_b16 v[48:49], v13 offset:59392
    ds_read_b64_tr_b16 v[50:51], v13 offset:59904
    s_waitcnt lgkmcnt(5)
    v_mfma_f32_32x32x16_bf16 v[52:67], v[36:39], v[20:23], v[52:67]
    ds_read_b128 v[16:19], v10 offset:57344
    ds_read_b64_tr_b16 v[28:29], v11 offset:61440
    ds_read_b64_tr_b16 v[30:31], v11 offset:61952
    v_mfma_f32_32x32x16_bf16 v[68:83], v[40:43], v[20:23], v[68:83]
    ds_read_b64_tr_b16 v[32:33], v13 offset:61440
    ds_read_b64_tr_b16 v[34:35], v13 offset:61952
    s_waitcnt lgkmcnt(5)
    v_mfma_f32_32x32x16_bf16 v[52:67], v[44:47], v[24:27], v[52:67]
    ds_read_b128 v[20:23], v10 offset:61440
    ds_read_b64_tr_b16 v[36:37], v11 offset:63488
    ds_read_b64_tr_b16 v[38:39], v11 offset:64000
    v_mfma_f32_32x32x16_bf16 v[68:83], v[48:51], v[24:27], v[68:83]
    ds_read_b64_tr_b16 v[40:41], v13 offset:63488
    ds_read_b64_tr_b16 v[42:43], v13 offset:64000
    s_waitcnt lgkmcnt(0)
    s_barrier
    v_mfma_f32_32x32x16_bf16 v[52:67], v[28:31], v[16:19], v[52:67]
    ds_read_b128 v[24:27], v10 offset:0
    ds_read_b64_tr_b16 v[44:45], v12 offset:0
    ds_read_b64_tr_b16 v[46:47], v12 offset:512
    v_mfma_f32_32x32x16_bf16 v[68:83], v[32:35], v[16:19], v[68:83]
    ds_read_b64_tr_b16 v[48:49], v14 offset:0
    ds_read_b64_tr_b16 v[50:51], v14 offset:512
    s_waitcnt lgkmcnt(5)
    v_mfma_f32_32x32x16_bf16 v[52:67], v[36:39], v[20:23], v[52:67]
    ds_read_b128 v[16:19], v10 offset:4096
    ds_read_b64_tr_b16 v[28:29], v12 offset:2048
    ds_read_b64_tr_b16 v[30:31], v12 offset:2560
    v_mfma_f32_32x32x16_bf16 v[68:83], v[40:43], v[20:23], v[68:83]
    ds_read_b64_tr_b16 v[32:33], v14 offset:2048
    ds_read_b64_tr_b16 v[34:35], v14 offset:2560
    s_waitcnt lgkmcnt(5)
    v_mfma_f32_32x32x16_bf16 v[52:67], v[44:47], v[24:27], v[52:67]
    ds_read_b128 v[20:23], v10 offset:8192
    ds_read_b64_tr_b16 v[36:37], v12 offset:4096
    ds_read_b64_tr_b16 v[38:39], v12 offset:4608
    v_mfma_f32_32x32x16_bf16 v[68:83], v[48:51], v[24:27], v[68:83]
    ds_read_b64_tr_b16 v[40:41], v14 offset:4096
    ds_read_b64_tr_b16 v[42:43], v14 offset:4608
    s_waitcnt lgkmcnt(5)
    v_mfma_f32_32x32x16_bf16 v[52:67], v[28:31], v[16:19], v[52:67]
    ds_read_b128 v[24:27], v10 offset:12288
    ds_read_b64_tr_b16 v[44:45], v12 offset:6144
    ds_read_b64_tr_b16 v[46:47], v12 offset:6656
    v_mfma_f32_32x32x16_bf16 v[68:83], v[32:35], v[16:19], v[68:83]
    ds_read_b64_tr_b16 v[48:49], v14 offset:6144
    ds_read_b64_tr_b16 v[50:51], v14 offset:6656
    s_waitcnt lgkmcnt(0)
    s_barrier
    v_mfma_f32_32x32x16_bf16 v[52:67], v[36:39], v[20:23], v[52:67]
    ds_read_b128 v[16:19], v10 offset:16384
    ds_read_b64_tr_b16 v[28:29], v12 offset:8192
    ds_read_b64_tr_b16 v[30:31], v12 offset:8704
    v_mfma_f32_32x32x16_bf16 v[68:83], v[40:43], v[20:23], v[68:83]
    ds_read_b64_tr_b16 v[32:33], v14 offset:8192
    ds_read_b64_tr_b16 v[34:35], v14 offset:8704
    s_waitcnt lgkmcnt(5)
    v_mfma_f32_32x32x16_bf16 v[52:67], v[44:47], v[24:27], v[52:67]
    ds_read_b128 v[20:23], v10 offset:20480
    ds_read_b64_tr_b16 v[36:37], v12 offset:10240
    ds_read_b64_tr_b16 v[38:39], v12 offset:10752
    v_mfma_f32_32x32x16_bf16 v[68:83], v[48:51], v[24:27], v[68:83]
    ds_read_b64_tr_b16 v[40:41], v14 offset:10240
    ds_read_b64_tr_b16 v[42:43], v14 offset:10752
    s_waitcnt lgkmcnt(5)
    v_mfma_f32_32x32x16_bf16 v[52:67], v[28:31], v[16:19], v[52:67]
    ds_read_b128 v[24:27], v10 offset:24576
    ds_read_b64_tr_b16 v[44:45], v12 offset:12288
    ds_read_b64_tr_b16 v[46:47], v12 offset:12800
    v_mfma_f32_32x32x16_bf16 v[68:83], v[32:35], v[16:19], v[68:83]
    ds_read_b64_tr_b16 v[48:49], v14 offset:12288
    ds_read_b64_tr_b16 v[50:51], v14 offset:12800
    s_waitcnt lgkmcnt(5)
    v_mfma_f32_32x32x16_bf16 v[52:67], v[36:39], v[20:23], v[52:67]
    ds_read_b128 v[16:19], v10 offset:28672
    ds_read_b64_tr_b16 v[28:29], v12 offset:14336
    ds_read_b64_tr_b16 v[30:31], v12 offset:14848
    v_mfma_f32_32x32x16_bf16 v[68:83], v[40:43], v[20:23], v[68:83]
    ds_read_b64_tr_b16 v[32:33], v14 offset:14336
    ds_read_b64_tr_b16 v[34:35], v14 offset:14848
    s_waitcnt lgkmcnt(0)
    s_barrier
    v_mfma_f32_32x32x16_bf16 v[52:67], v[44:47], v[24:27], v[52:67]
    v_mfma_f32_32x32x16_bf16 v[68:83], v[48:51], v[24:27], v[68:83]
    s_waitcnt lgkmcnt(0)
    v_mfma_f32_32x32x16_bf16 v[52:67], v[28:31], v[16:19], v[52:67]
    v_mfma_f32_32x32x16_bf16 v[68:83], v[32:35], v[16:19], v[68:83]
    s_nop 11
    s_lshl_b32 s66, s55, 3
    s_add_u32 s66, s66, 0
    s_lshl_b32 s66, s66, 15
    s_add_u32 s67, s66, 65536
    v_cvt_pk_bf16_f32 v238, v52, v53
    v_cvt_pk_bf16_f32 v239, v54, v55
    v_cvt_pk_bf16_f32 v240, v56, v57
    v_cvt_pk_bf16_f32 v241, v58, v59
    v_cvt_pk_bf16_f32 v242, v60, v61
    v_cvt_pk_bf16_f32 v243, v62, v63
    v_cvt_pk_bf16_f32 v244, v64, v65
    v_cvt_pk_bf16_f32 v245, v66, v67
    s_nop 1
    v_permlane32_swap_b32 v238, v240
    v_permlane32_swap_b32 v239, v241
    v_permlane32_swap_b32 v242, v244
    v_permlane32_swap_b32 v243, v245
    buffer_store_dwordx4 v[238:241], v100, s[28:31], s66 offen sc1
    buffer_store_dwordx4 v[242:245], v100, s[28:31], s67 offen sc1
    s_nop 1
    s_lshl_b32 s66, s55, 3
    s_add_u32 s66, s66, 4
    s_lshl_b32 s66, s66, 15
    s_add_u32 s67, s66, 65536
    v_cvt_pk_bf16_f32 v246, v68, v69
    v_cvt_pk_bf16_f32 v247, v70, v71
    v_cvt_pk_bf16_f32 v248, v72, v73
    v_cvt_pk_bf16_f32 v249, v74, v75
    v_cvt_pk_bf16_f32 v250, v76, v77
    v_cvt_pk_bf16_f32 v251, v78, v79
    v_cvt_pk_bf16_f32 v252, v80, v81
    v_cvt_pk_bf16_f32 v253, v82, v83
    s_nop 1
    v_permlane32_swap_b32 v246, v248
    v_permlane32_swap_b32 v247, v249
    v_permlane32_swap_b32 v250, v252
    v_permlane32_swap_b32 v251, v253
    buffer_store_dwordx4 v[246:249], v100, s[28:31], s66 offen sc1
    buffer_store_dwordx4 v[250:253], v100, s[28:31], s67 offen sc1
    s_nop 1
    s_add_u32 s68, s54, 32
    s_lshl_b32 s68, s68, 8
    s_lshl_b32 s69, s55, 2
    s_add_u32 s68, s68, s69
    s_waitcnt vmcnt(0)
    v_mov_b32 v104, 3848
    v_mov_b32 v105, 1
    s_mov_b64 exec, 1
    ds_add_rtn_u32 v105, v104, v105
    s_waitcnt lgkmcnt(0)
    v_cmp_eq_u32 vcc, 3, v105
    s_cmp_eq_u64 vcc, 0
    s_cbranch_scc1 nopub_78
    v_add_u32 v105, 1, v2
    v_mov_b32 v104, s68
    buffer_store_dword v105, v104, s[48:51], 0 offen sc1
nopub_78:
    s_mov_b64 exec, -1
    s_barrier
c_nowo_71:
    s_cmp_ge_u32 s58, 7
    s_cbranch_scc1 c_end_72
    s_lshl_b32 s59, s54, 7
    s_lshl_b32 s60, s56, 8
    s_add_u32 s61, s54, s56
    s_mul_i32 s62, s61, 26
    s_lshr_b32 s62, s62, 8
    s_mul_i32 s62, s62, 10
    s_sub_u32 s61, s61, s62
    s_mov_b32 s28, s14
    s_and_b32 s29, s15, 0xffff
    s_mov_b32 s30, 3456
    s_mov_b32 s31, 0x20000
    s_add_u32 s32, s22, 13107200
    s_addc_u32 s33, s23, 0
    s_and_b32 s33, s33, 0xffff
    s_mov_b32 s34, 7077888
    s_mov_b32 s35, 0x20000
    s_add_u32 s36, s22, 20185088
    s_addc_u32 s37, s23, 0
    s_and_b32 s37, s37, 0xffff
    s_mov_b32 s38, 983040
    s_mov_b32 s39, 0x20000
    v_and_b32 v8, 31, v1
    v_lshrrev_b32 v9, 5, v1
    s_lshr_b32 s67, s24, 1
    s_and_b32 s68, s24, 1
    s_lshl_b32 s63, s67, 1
    s_add_u32 s63, s63, s68
    s_xor_b32 s64, s63, 1
    s_lshl_b32 s65, s68, 1
    s_add_u32 s65, s65, s67
    s_xor_b32 s66, s65, 1
    s_lshl_b32 s67, s63, 9
    s_add_u32 s67, s67, 4096
    v_lshlrev_b32 v4, 4, v8
    v_lshl_add_u32 v4, v9, 11, v4
    v_add_u32 v10, s67, v4
    s_lshl_b32 s67, s64, 9
    s_add_u32 s67, s67, 4096
    v_lshlrev_b32 v4, 4, v8
    v_lshl_add_u32 v4, v9, 11, v4
    v_add_u32 v11, s67, v4
    v_bfe_u32 v4, v1, 2, 2
    v_xor_b32 v5, s65, v4
    v_lshlrev_b32 v5, 2, v5
    v_bfe_u32 v6, v1, 4, 1
    v_lshl_add_u32 v5, v6, 1, v5
    v_bfe_u32 v6, v1, 1, 1
    v_add_u32 v5, v5, v6
    v_lshlrev_b32 v5, 4, v5
    v_and_b32 v6, 1, v1
    v_lshl_add_u32 v5, v6, 3, v5
    v_lshl_add_u32 v4, v9, 3, v4
    v_mul_u32_u24 v4, 256, v4
    v_add_u32 v4, v4, v5
    v_add_u32 v12, 75776, v4
    v_add_u32 v13, 65536, v12
    v_bfe_u32 v4, v1, 2, 2
    v_xor_b32 v5, s66, v4
    v_lshlrev_b32 v5, 2, v5
    v_bfe_u32 v6, v1, 4, 1
    v_lshl_add_u32 v5, v6, 1, v5
    v_bfe_u32 v6, v1, 1, 1
    v_add_u32 v5, v5, v6
    v_lshlrev_b32 v5, 4, v5
    v_and_b32 v6, 1, v1
    v_lshl_add_u32 v5, v6, 3, v5
    v_lshl_add_u32 v4, v9, 3, v4
    v_mul_u32_u24 v4, 256, v4
    v_add_u32 v4, v4, v5
    v_add_u32 v14, 75776, v4
    v_add_u32 v15, 65536, v14
    s_mov_b32 s69, 0x3f803f80
    v_mov_b32 v112, 0
    v_mov_b32 v113, 0
    v_mov_b32 v114, 0
    v_mov_b32 v115, 0
    v_mov_b32 v116, 0
    v_mov_b32 v117, 0
    s_mul_i32 s67, s54, 10
    s_add_u32 s67, s67, s61
    s_lshl_b32 s67, s67, 2
    s_add_u32 s67, s67, s63
    s_lshl_b32 s67, s67, 9
    s_add_u32 s67, s67, 491520
    s_cmp_lt_u32 s56, 10
    s_cselect_b32 s68, 0, 1073741824
    s_add_u32 s67, s67, s68
    v_lshl_add_u32 v4, v8, 4, s67
    v_lshl_add_u32 v118, v9, 3, v4
    s_mul_i32 s67, s56, 10
    s_add_u32 s67, s67, s61
    s_lshl_b32 s67, s67, 2
    s_add_u32 s67, s67, s65
    s_lshl_b32 s67, s67, 8
    s_add_u32 s67, s67, 819200
    s_cmp_lt_u32 s54, 10
    s_cselect_b32 s68, 0, 1073741824
    s_add_u32 s67, s67, s68
    v_lshl_add_u32 v4, v8, 3, s67
    v_lshl_add_u32 v119, v9, 30, v4
    s_mul_i32 s67, s54, 20480
    s_add_u32 s67, s67, 491520
    v_mov_b32 v4, s63
    v_xor_b32 v4, v4, v9
    v_lshl_add_u32 v4, v4, 5, v8
    v_lshl_add_u32 v120, v4, 4, s67
    s_mul_i32 s67, s56, 10240
    s_add_u32 s67, s67, 819200
    v_mov_b32 v4, s65
    v_xor_b32 v4, v4, v9
    v_lshl_add_u32 v4, v4, 5, v8
    v_lshl_add_u32 v121, v4, 3, s67
    v_mov_b32 v4, s63
    v_xor_b32 v4, v4, v9
    v_lshl_add_u32 v4, v4, 5, v8
    v_lshlrev_b32 v4, 4, v4
    v_add_u32 v122, 36864, v4
    v_add_u32 v123, 92160, v4
    v_mov_b32 v4, s65
    v_xor_b32 v4, v4, v9
    v_lshl_add_u32 v4, v4, 5, v8
    v_lshlrev_b32 v4, 3, v4
    v_add_u32 v124, 96256, v4
    s_mul_i32 s76, s24, 768
    s_lshl_b32 s67, s63, 5
    s_add_u32 s67, s67, s59
    v_add_u32 v226, s67, v8
    v_lshlrev_b32 v226, 4, v226
    v_lshl_add_u32 v226, v9, 15, v226
    s_lshl_b32 s67, s64, 5
    s_add_u32 s67, s67, s59
    v_add_u32 v227, s67, v8
    v_lshlrev_b32 v227, 4, v227
    v_lshl_add_u32 v227, v9, 15, v227
    s_lshl_b32 s72, s56, 2
    s_add_u32 s72, s72, s65
    s_lshl_b32 s72, s72, 17
    s_add_u32 s73, s72, 65536
    s_lshl_b32 s74, s56, 2
    s_add_u32 s74, s74, s66
    s_lshl_b32 s74, s74, 17
    s_add_u32 s75, s74, 65536
    s_lshl_b32 s67, s65, 6
    s_add_u32 s67, s67, s60
    v_lshl_add_u32 v228, v9, 3, s67
    buffer_load_dwordx2 v[210:211], v228, s[28:31], 0 offen offset:0
    buffer_load_dwordx2 v[212:213], v228, s[28:31], 0 offen offset:16
    buffer_load_dwordx2 v[214:215], v228, s[28:31], 0 offen offset:32
    buffer_load_dwordx2 v[216:217], v228, s[28:31], 0 offen offset:48
    s_lshl_b32 s67, s66, 6
    s_add_u32 s67, s67, s60
    v_lshl_add_u32 v228, v9, 3, s67
    buffer_load_dwordx2 v[218:219], v228, s[28:31], 0 offen offset:0
    buffer_load_dwordx2 v[220:221], v228, s[28:31], 0 offen offset:16
    buffer_load_dwordx2 v[222:223], v228, s[28:31], 0 offen offset:32
    buffer_load_dwordx2 v[224:225], v228, s[28:31], 0 offen offset:48
    s_cmp_lg_u32 s24, 0
    s_cbranch_scc1 nopoll_79
    s_add_u32 s77, s54, 32
    s_lshl_b32 s77, s77, 8
    v_lshl_add_u32 v230, v1, 2, s77
    s_mov_b32 s78, 0x3ff
    s_mov_b32 s79, 0
    s_waitcnt vmcnt(0)
    s_mov_b32 s80, 400000
    s_mov_b64 exec, s[78:79]
poll_80:
    buffer_load_dword v231, v230, s[48:51], 0 offen sc1
    s_waitcnt vmcnt(0)
    v_subrev_u32 v231, v2, v231
    v_cmp_ne_u32 vcc, 1, v231
    s_cmp_eq_u64 vcc, 0
    s_cbranch_scc1 polled_81
    s_sub_u32 s80, s80, 1
    s_cmp_lg_u32 s80, 0
    s_cbranch_scc1 poll_80
polled_81:
    s_mov_b64 exec, -1
nopoll_79:
    s_barrier
    s_barrier
    ds_read_b128 v[16:19], v10 offset:0
    ds_read_b128 v[20:23], v11 offset:0
    ds_read_b64_tr_b16 v[32:33], v12 offset:0
    ds_read_b64_tr_b16 v[34:35], v12 offset:1024
    ds_read_b64_tr_b16 v[36:37], v14 offset:0
    ds_read_b64_tr_b16 v[38:39], v14 offset:1024
    s_waitcnt lgkmcnt(0)
    v_mfma_f32_32x32x16_bf16 v[48:63], v[32:35], v[16:19], 0
    ds_read_b128 v[24:27], v10 offset:4096
    ds_read_b128 v[28:31], v11 offset:4096
    ds_read_b64_tr_b16 v[40:41], v12 offset:4096
    v_mfma_f32_32x32x16_bf16 v[64:79], v[36:39], v[16:19], 0
    ds_read_b64_tr_b16 v[42:43], v12 offset:5120
    ds_read_b64_tr_b16 v[44:45], v14 offset:4096
    ds_read_b64_tr_b16 v[46:47], v14 offset:5120
    v_mfma_f32_32x32x16_bf16 v[80:95], v[32:35], v[20:23], 0
    v_mfma_f32_32x32x16_bf16 v[96:111], v[36:39], v[20:23], 0
    v_dot2c_f32_bf16 v112, s69, v16
    v_dot2c_f32_bf16 v114, v16, v16
    v_dot2c_f32_bf16 v116, s69, v32
    v_dot2c_f32_bf16 v113, s69, v17
    v_dot2c_f32_bf16 v115, v17, v17
    v_dot2c_f32_bf16 v117, s69, v33
    v_dot2c_f32_bf16 v112, s69, v18
    v_dot2c_f32_bf16 v114, v18, v18
    v_dot2c_f32_bf16 v116, s69, v34
    v_dot2c_f32_bf16 v113, s69, v19
    v_dot2c_f32_bf16 v115, v19, v19
    v_dot2c_f32_bf16 v117, s69, v35
    s_waitcnt lgkmcnt(0)
    v_mfma_f32_32x32x16_bf16 v[48:63], v[40:43], v[24:27], v[48:63]
    ds_read_b128 v[16:19], v10 offset:8192
    ds_read_b128 v[20:23], v11 offset:8192
    ds_read_b64_tr_b16 v[32:33], v12 offset:8192
    v_mfma_f32_32x32x16_bf16 v[64:79], v[44:47], v[24:27], v[64:79]
    ds_read_b64_tr_b16 v[34:35], v12 offset:9216
    ds_read_b64_tr_b16 v[36:37], v14 offset:8192
    ds_read_b64_tr_b16 v[38:39], v14 offset:9216
    v_mfma_f32_32x32x16_bf16 v[80:95], v[40:43], v[28:31], v[80:95]
    v_mfma_f32_32x32x16_bf16 v[96:111], v[44:47], v[28:31], v[96:111]
    v_dot2c_f32_bf16 v112, s69, v24
    v_dot2c_f32_bf16 v114, v24, v24
    v_dot2c_f32_bf16 v116, s69, v40
    v_dot2c_f32_bf16 v113, s69, v25
    v_dot2c_f32_bf16 v115, v25, v25
    v_dot2c_f32_bf16 v117, s69, v41
    v_dot2c_f32_bf16 v112, s69, v26
    v_dot2c_f32_bf16 v114, v26, v26
    v_dot2c_f32_bf16 v116, s69, v42
    v_dot2c_f32_bf16 v113, s69, v27
    v_dot2c_f32_bf16 v115, v27, v27
    v_dot2c_f32_bf16 v117, s69, v43
    s_waitcnt lgkmcnt(0)
    v_mfma_f32_32x32x16_bf16 v[48:63], v[32:35], v[16:19], v[48:63]
    ds_read_b128 v[24:27], v10 offset:12288
    ds_read_b128 v[28:31], v11 offset:12288
    ds_read_b64_tr_b16 v[40:41], v12 offset:12288
    v_mfma_f32_32x32x16_bf16 v[64:79], v[36:39], v[16:19], v[64:79]
    ds_read_b64_tr_b16 v[42:43], v12 offset:13312
    ds_read_b64_tr_b16 v[44:45], v14 offset:12288
    ds_read_b64_tr_b16 v[46:47], v14 offset:13312
    v_mfma_f32_32x32x16_bf16 v[80:95], v[32:35], v[20:23], v[80:95]
    v_mfma_f32_32x32x16_bf16 v[96:111], v[36:39], v[20:23], v[96:111]
    v_dot2c_f32_bf16 v112, s69, v16
    v_dot2c_f32_bf16 v114, v16, v16
    v_dot2c_f32_bf16 v116, s69, v32
    v_dot2c_f32_bf16 v113, s69, v17
    v_dot2c_f32_bf16 v115, v17, v17
    v_dot2c_f32_bf16 v117, s69, v33
    v_dot2c_f32_bf16 v112, s69, v18
    v_dot2c_f32_bf16 v114, v18, v18
    v_dot2c_f32_bf16 v116, s69, v34
    v_dot2c_f32_bf16 v113, s69, v19
    v_dot2c_f32_bf16 v115, v19, v19
    v_dot2c_f32_bf16 v117, s69, v35
    s_waitcnt lgkmcnt(0)
    s_barrier
    v_mfma_f32_32x32x16_bf16 v[48:63], v[40:43], v[24:27], v[48:63]
    ds_read_b128 v[16:19], v10 offset:16384
    ds_read_b128 v[20:23], v11 offset:16384
    ds_read_b64_tr_b16 v[32:33], v12 offset:16384
    v_mfma_f32_32x32x16_bf16 v[64:79], v[44:47], v[24:27], v[64:79]
    ds_read_b64_tr_b16 v[34:35], v12 offset:17408
    ds_read_b64_tr_b16 v[36:37], v14 offset:16384
    ds_read_b64_tr_b16 v[38:39], v14 offset:17408
    v_mfma_f32_32x32x16_bf16 v[80:95], v[40:43], v[28:31], v[80:95]
    v_mfma_f32_32x32x16_bf16 v[96:111], v[44:47], v[28:31], v[96:111]
    v_dot2c_f32_bf16 v112, s69, v24
    v_dot2c_f32_bf16 v114, v24, v24
    v_dot2c_f32_bf16 v116, s69, v40
    v_dot2c_f32_bf16 v113, s69, v25
    v_dot2c_f32_bf16 v115, v25, v25
    v_dot2c_f32_bf16 v117, s69, v41
    v_dot2c_f32_bf16 v112, s69, v26
    v_dot2c_f32_bf16 v114, v26, v26
    v_dot2c_f32_bf16 v116, s69, v42
    v_dot2c_f32_bf16 v113, s69, v27
    v_dot2c_f32_bf16 v115, v27, v27
    v_dot2c_f32_bf16 v117, s69, v43
    s_waitcnt lgkmcnt(0)
    v_mfma_f32_32x32x16_bf16 v[48:63], v[32:35], v[16:19], v[48:63]
    ds_read_b128 v[24:27], v10 offset:20480
    ds_read_b128 v[28:31], v11 offset:20480
    ds_read_b64_tr_b16 v[40:41], v12 offset:20480
    v_mfma_f32_32x32x16_bf16 v[64:79], v[36:39], v[16:19], v[64:79]
    ds_read_b64_tr_b16 v[42:43], v12 offset:21504
    ds_read_b64_tr_b16 v[44:45], v14 offset:20480
    ds_read_b64_tr_b16 v[46:47], v14 offset:21504
    v_mfma_f32_32x32x16_bf16 v[80:95], v[32:35], v[20:23], v[80:95]
    v_mfma_f32_32x32x16_bf16 v[96:111], v[36:39], v[20:23], v[96:111]
    s_waitcnt vmcnt(0)
    v_add_u32 v186, 1, v2
    v_add_f32 v112, v112, v113
    v_add_f32 v114, v114, v115
    v_add_f32 v116, v116, v117
    v_mov_b32 v4, v112
    v_mov_b32 v5, v114
    v_mov_b32 v6, v116
    s_nop 1
    v_permlane32_swap_b32 v4, v112
    v_permlane32_swap_b32 v5, v114
    v_permlane32_swap_b32 v6, v116
    v_cmp_eq_u32 vcc, 0, v9
    v_mov_b32 v191, v186
    v_mov_b32 v193, v186
    v_add_f32 v112, v112, v4
    v_add_f32 v114, v114, v5
    v_add_f32 v192, v116, v6
    v_cndmask_b32 v190, v114, v112, vcc
    buffer_store_dwordx2 v[192:193], v119, s[36:39], 0 offen sc1
    buffer_store_dwordx2 v[190:191], v118, s[36:39], 0 offen sc1
    s_waitcnt lgkmcnt(0)
    v_mfma_f32_32x32x16_bf16 v[48:63], v[40:43], v[24:27], v[48:63]
    ds_read_b128 v[16:19], v10 offset:24576
    ds_read_b128 v[20:23], v11 offset:24576
    ds_read_b64_tr_b16 v[32:33], v12 offset:24576
    v_mfma_f32_32x32x16_bf16 v[64:79], v[44:47], v[24:27], v[64:79]
    ds_read_b64_tr_b16 v[34:35], v12 offset:25600
    ds_read_b64_tr_b16 v[36:37], v14 offset:24576
    ds_read_b64_tr_b16 v[38:39], v14 offset:25600
    v_mfma_f32_32x32x16_bf16 v[80:95], v[40:43], v[28:31], v[80:95]
    v_mfma_f32_32x32x16_bf16 v[96:111], v[44:47], v[28:31], v[96:111]
    s_waitcnt lgkmcnt(0)
    v_mfma_f32_32x32x16_bf16 v[48:63], v[32:35], v[16:19], v[48:63]
    ds_read_b128 v[24:27], v10 offset:28672
    ds_read_b128 v[28:31], v11 offset:28672
    ds_read_b64_tr_b16 v[40:41], v12 offset:28672
    v_lshlrev_b32 v194, 16, v210
    v_mfma_f32_32x32x16_bf16 v[64:79], v[36:39], v[16:19], v[64:79]
    ds_read_b64_tr_b16 v[42:43], v12 offset:29696
    ds_read_b64_tr_b16 v[44:45], v14 offset:28672
    ds_read_b64_tr_b16 v[46:47], v14 offset:29696
    v_and_b32 v195, 0xffff0000, v210
    v_mfma_f32_32x32x16_bf16 v[80:95], v[32:35], v[20:23], v[80:95]
    v_lshlrev_b32 v196, 16, v211
    v_and_b32 v197, 0xffff0000, v211
    v_mfma_f32_32x32x16_bf16 v[96:111], v[36:39], v[20:23], v[96:111]
    s_waitcnt lgkmcnt(0)
    s_barrier
    v_mfma_f32_32x32x16_bf16 v[48:63], v[40:43], v[24:27], v[48:63]
    ds_read_b128 v[16:19], v10 offset:32768
    ds_read_b128 v[20:23], v11 offset:32768
    ds_read_b64_tr_b16 v[32:33], v12 offset:32768
    v_lshlrev_b32 v198, 16, v212
    v_mfma_f32_32x32x16_bf16 v[64:79], v[44:47], v[24:27], v[64:79]
    ds_read_b64_tr_b16 v[34:35], v12 offset:33792
    ds_read_b64_tr_b16 v[36:37], v14 offset:32768
    ds_read_b64_tr_b16 v[38:39], v14 offset:33792
    v_and_b32 v199, 0xffff0000, v212
    v_mfma_f32_32x32x16_bf16 v[80:95], v[40:43], v[28:31], v[80:95]
    v_lshlrev_b32 v200, 16, v213
    v_and_b32 v201, 0xffff0000, v213
    v_mfma_f32_32x32x16_bf16 v[96:111], v[44:47], v[28:31], v[96:111]
    s_waitcnt lgkmcnt(0)
    v_mfma_f32_32x32x16_bf16 v[48:63], v[32:35], v[16:19], v[48:63]
    ds_read_b128 v[24:27], v10 offset:36864
    ds_read_b128 v[28:31], v11 offset:36864
    ds_read_b64_tr_b16 v[40:41], v12 offset:36864
    v_lshlrev_b32 v202, 16, v214
    v_mfma_f32_32x32x16_bf16 v[64:79], v[36:39], v[16:19], v[64:79]
    ds_read_b64_tr_b16 v[42:43], v12 offset:37888
    ds_read_b64_tr_b16 v[44:45], v14 offset:36864
    ds_read_b64_tr_b16 v[46:47], v14 offset:37888
    v_and_b32 v203, 0xffff0000, v214
    v_mfma_f32_32x32x16_bf16 v[80:95], v[32:35], v[20:23], v[80:95]
    v_lshlrev_b32 v204, 16, v215
    v_and_b32 v205, 0xffff0000, v215
    v_mfma_f32_32x32x16_bf16 v[96:111], v[36:39], v[20:23], v[96:111]
    s_waitcnt lgkmcnt(0)
    v_mfma_f32_32x32x16_bf16 v[48:63], v[40:43], v[24:27], v[48:63]
    ds_read_b128 v[16:19], v10 offset:40960
    ds_read_b128 v[20:23], v11 offset:40960
    ds_read_b64_tr_b16 v[32:33], v12 offset:40960
    v_lshlrev_b32 v206, 16, v216
    v_mfma_f32_32x32x16_bf16 v[64:79], v[44:47], v[24:27], v[64:79]
    ds_read_b64_tr_b16 v[34:35], v12 offset:41984
    ds_read_b64_tr_b16 v[36:37], v14 offset:40960
    ds_read_b64_tr_b16 v[38:39], v14 offset:41984
    v_and_b32 v207, 0xffff0000, v216
    v_mfma_f32_32x32x16_bf16 v[80:95], v[40:43], v[28:31], v[80:95]
    v_lshlrev_b32 v208, 16, v217
    v_and_b32 v209, 0xffff0000, v217
    v_mfma_f32_32x32x16_bf16 v[96:111], v[44:47], v[28:31], v[96:111]
    s_waitcnt lgkmcnt(0)
    v_mfma_f32_32x32x16_bf16 v[48:63], v[32:35], v[16:19], v[48:63]
    ds_read_b128 v[24:27], v10 offset:45056
    ds_read_b128 v[28:31], v11 offset:45056
    ds_read_b64_tr_b16 v[40:41], v12 offset:45056
    v_lshlrev_b32 v210, 16, v218
    v_mfma_f32_32x32x16_bf16 v[64:79], v[36:39], v[16:19], v[64:79]
    ds_read_b64_tr_b16 v[42:43], v12 offset:46080
    ds_read_b64_tr_b16 v[44:45], v14 offset:45056
    ds_read_b64_tr_b16 v[46:47], v14 offset:46080
    v_and_b32 v211, 0xffff0000, v218
    v_mfma_f32_32x32x16_bf16 v[80:95], v[32:35], v[20:23], v[80:95]
    v_lshlrev_b32 v212, 16, v219
    v_and_b32 v213, 0xffff0000, v219
    v_mfma_f32_32x32x16_bf16 v[96:111], v[36:39], v[20:23], v[96:111]
    s_waitcnt lgkmcnt(0)
    s_barrier
    v_mfma_f32_32x32x16_bf16 v[48:63], v[40:43], v[24:27], v[48:63]
    ds_read_b128 v[16:19], v10 offset:49152
    ds_read_b128 v[20:23], v11 offset:49152
    ds_read_b64_tr_b16 v[32:33], v12 offset:49152
    v_lshlrev_b32 v214, 16, v220
    v_mfma_f32_32x32x16_bf16 v[64:79], v[44:47], v[24:27], v[64:79]
    ds_read_b64_tr_b16 v[34:35], v12 offset:50176
    ds_read_b64_tr_b16 v[36:37], v14 offset:49152
    ds_read_b64_tr_b16 v[38:39], v14 offset:50176
    v_and_b32 v215, 0xffff0000, v220
    v_mfma_f32_32x32x16_bf16 v[80:95], v[40:43], v[28:31], v[80:95]
    v_lshlrev_b32 v216, 16, v221
    v_and_b32 v217, 0xffff0000, v221
    v_mfma_f32_32x32x16_bf16 v[96:111], v[44:47], v[28:31], v[96:111]
    s_waitcnt lgkmcnt(0)
    v_mfma_f32_32x32x16_bf16 v[48:63], v[32:35], v[16:19], v[48:63]
    ds_read_b128 v[24:27], v10 offset:53248
    ds_read_b128 v[28:31], v11 offset:53248
    ds_read_b64_tr_b16 v[40:41], v12 offset:53248
    v_lshlrev_b32 v218, 16, v222
    v_mfma_f32_32x32x16_bf16 v[64:79], v[36:39], v[16:19], v[64:79]
    ds_read_b64_tr_b16 v[42:43], v12 offset:54272
    ds_read_b64_tr_b16 v[44:45], v14 offset:53248
    ds_read_b64_tr_b16 v[46:47], v14 offset:54272
    v_and_b32 v219, 0xffff0000, v222
    v_mfma_f32_32x32x16_bf16 v[80:95], v[32:35], v[20:23], v[80:95]
    v_lshlrev_b32 v220, 16, v223
    v_and_b32 v221, 0xffff0000, v223
    v_mfma_f32_32x32x16_bf16 v[96:111], v[36:39], v[20:23], v[96:111]
    s_waitcnt lgkmcnt(0)
    v_mfma_f32_32x32x16_bf16 v[48:63], v[40:43], v[24:27], v[48:63]
    ds_read_b128 v[16:19], v10 offset:57344
    ds_read_b128 v[20:23], v11 offset:57344
    ds_read_b64_tr_b16 v[32:33], v12 offset:57344
    v_lshlrev_b32 v222, 16, v224
    v_mfma_f32_32x32x16_bf16 v[64:79], v[44:47], v[24:27], v[64:79]
    ds_read_b64_tr_b16 v[34:35], v12 offset:58368
    ds_read_b64_tr_b16 v[36:37], v14 offset:57344
    ds_read_b64_tr_b16 v[38:39], v14 offset:58368
    v_and_b32 v223, 0xffff0000, v224
    v_mfma_f32_32x32x16_bf16 v[80:95], v[40:43], v[28:31], v[80:95]
    v_lshlrev_b32 v224, 16, v225
    v_and_b32 v225, 0xffff0000, v225
    v_mfma_f32_32x32x16_bf16 v[96:111], v[44:47], v[28:31], v[96:111]
    s_waitcnt lgkmcnt(0)
    v_mfma_f32_32x32x16_bf16 v[48:63], v[32:35], v[16:19], v[48:63]
    ds_read_b128 v[24:27], v10 offset:61440
    ds_read_b128 v[28:31], v11 offset:61440
    ds_read_b64_tr_b16 v[40:41], v12 offset:61440
    v_mfma_f32_32x32x16_bf16 v[64:79], v[36:39], v[16:19], v[64:79]
    ds_read_b64_tr_b16 v[42:43], v12 offset:62464
    ds_read_b64_tr_b16 v[44:45], v14 offset:61440
    ds_read_b64_tr_b16 v[46:47], v14 offset:62464
    v_mfma_f32_32x32x16_bf16 v[80:95], v[32:35], v[20:23], v[80:95]
    v_mfma_f32_32x32x16_bf16 v[96:111], v[36:39], v[20:23], v[96:111]
    s_waitcnt lgkmcnt(0)
    s_barrier
    v_mfma_f32_32x32x16_bf16 v[48:63], v[40:43], v[24:27], v[48:63]
    ds_read_b128 v[16:19], v10 offset:0
    ds_read_b128 v[20:23], v11 offset:0
    ds_read_b64_tr_b16 v[32:33], v13 offset:0
    v_mfma_f32_32x32x16_bf16 v[64:79], v[44:47], v[24:27], v[64:79]
    ds_read_b64_tr_b16 v[34:35], v13 offset:1024
    ds_read_b64_tr_b16 v[36:37], v15 offset:0
    ds_read_b64_tr_b16 v[38:39], v15 offset:1024
    v_mfma_f32_32x32x16_bf16 v[80:95], v[40:43], v[28:31], v[80:95]
    v_mfma_f32_32x32x16_bf16 v[96:111], v[44:47], v[28:31], v[96:111]
    s_waitcnt lgkmcnt(0)
    v_mfma_f32_32x32x16_bf16 v[48:63], v[32:35], v[16:19], v[48:63]
    ds_read_b128 v[24:27], v10 offset:4096
    ds_read_b128 v[28:31], v11 offset:4096
    ds_read_b64_tr_b16 v[40:41], v13 offset:4096
    v_mfma_f32_32x32x16_bf16 v[64:79], v[36:39], v[16:19], v[64:79]
    ds_read_b64_tr_b16 v[42:43], v13 offset:5120
    ds_read_b64_tr_b16 v[44:45], v15 offset:4096
    ds_read_b64_tr_b16 v[46:47], v15 offset:5120
    v_mfma_f32_32x32x16_bf16 v[80:95], v[32:35], v[20:23], v[80:95]
    v_mfma_f32_32x32x16_bf16 v[96:111], v[36:39], v[20:23], v[96:111]
    s_waitcnt lgkmcnt(0)
    v_mfma_f32_32x32x16_bf16 v[48:63], v[40:43], v[24:27], v[48:63]
    ds_read_b128 v[16:19], v10 offset:8192
    ds_read_b128 v[20:23], v11 offset:8192
    ds_read_b64_tr_b16 v[32:33], v13 offset:8192
    v_mfma_f32_32x32x16_bf16 v[64:79], v[44:47], v[24:27], v[64:79]
    ds_read_b64_tr_b16 v[34:35], v13 offset:9216
    ds_read_b64_tr_b16 v[36:37], v15 offset:8192
    ds_read_b64_tr_b16 v[38:39], v15 offset:9216
    v_mfma_f32_32x32x16_bf16 v[80:95], v[40:43], v[28:31], v[80:95]
    v_mfma_f32_32x32x16_bf16 v[96:111], v[44:47], v[28:31], v[96:111]
    s_waitcnt lgkmcnt(0)
    v_mfma_f32_32x32x16_bf16 v[48:63], v[32:35], v[16:19], v[48:63]
    ds_read_b128 v[24:27], v10 offset:12288
    ds_read_b128 v[28:31], v11 offset:12288
    ds_read_b64_tr_b16 v[40:41], v13 offset:12288
    v_mfma_f32_32x32x16_bf16 v[64:79], v[36:39], v[16:19], v[64:79]
    ds_read_b64_tr_b16 v[42:43], v13 offset:13312
    ds_read_b64_tr_b16 v[44:45], v15 offset:12288
    ds_read_b64_tr_b16 v[46:47], v15 offset:13312
    v_mfma_f32_32x32x16_bf16 v[80:95], v[32:35], v[20:23], v[80:95]
    v_mfma_f32_32x32x16_bf16 v[96:111], v[36:39], v[20:23], v[96:111]
    s_waitcnt lgkmcnt(0)
    s_barrier
    v_mfma_f32_32x32x16_bf16 v[48:63], v[40:43], v[24:27], v[48:63]
    ds_read_b128 v[16:19], v10 offset:16384
    ds_read_b128 v[20:23], v11 offset:16384
    ds_read_b64_tr_b16 v[32:33], v12 offset:0
    v_mfma_f32_32x32x16_bf16 v[64:79], v[44:47], v[24:27], v[64:79]
    ds_read_b64_tr_b16 v[34:35], v12 offset:1024
    ds_read_b64_tr_b16 v[36:37], v14 offset:0
    ds_read_b64_tr_b16 v[38:39], v14 offset:1024
    v_mfma_f32_32x32x16_bf16 v[80:95], v[40:43], v[28:31], v[80:95]
    v_mfma_f32_32x32x16_bf16 v[96:111], v[44:47], v[28:31], v[96:111]
    s_waitcnt lgkmcnt(0)
    v_mfma_f32_32x32x16_bf16 v[48:63], v[32:35], v[16:19], v[48:63]
    ds_read_b128 v[24:27], v10 offset:20480
    ds_read_b128 v[28:31], v11 offset:20480
    ds_read_b64_tr_b16 v[40:41], v12 offset:4096
    v_mfma_f32_32x32x16_bf16 v[64:79], v[36:39], v[16:19], v[64:79]
    ds_read_b64_tr_b16 v[42:43], v12 offset:5120
    ds_read_b64_tr_b16 v[44:45], v14 offset:4096
    ds_read_b64_tr_b16 v[46:47], v14 offset:5120
    v_mfma_f32_32x32x16_bf16 v[80:95], v[32:35], v[20:23], v[80:95]
    v_mfma_f32_32x32x16_bf16 v[96:111], v[36:39], v[20:23], v[96:111]
    s_waitcnt lgkmcnt(0)
    v_mfma_f32_32x32x16_bf16 v[48:63], v[40:43], v[24:27], v[48:63]
    ds_read_b128 v[16:19], v10 offset:24576
    ds_read_b128 v[20:23], v11 offset:24576
    ds_read_b64_tr_b16 v[32:33], v12 offset:8192
    v_mfma_f32_32x32x16_bf16 v[64:79], v[44:47], v[24:27], v[64:79]
    ds_read_b64_tr_b16 v[34:35], v12 offset:9216
    ds_read_b64_tr_b16 v[36:37], v14 offset:8192
    ds_read_b64_tr_b16 v[38:39], v14 offset:9216
    v_mfma_f32_32x32x16_bf16 v[80:95], v[40:43], v[28:31], v[80:95]
    v_mfma_f32_32x32x16_bf16 v[96:111], v[44:47], v[28:31], v[96:111]
    s_waitcnt lgkmcnt(0)
    v_mfma_f32_32x32x16_bf16 v[48:63], v[32:35], v[16:19], v[48:63]
    ds_read_b128 v[24:27], v10 offset:28672
    ds_read_b128 v[28:31], v11 offset:28672
    ds_read_b64_tr_b16 v[40:41], v12 offset:12288
    v_mfma_f32_32x32x16_bf16 v[64:79], v[36:39], v[16:19], v[64:79]
    ds_read_b64_tr_b16 v[42:43], v12 offset:13312
    ds_read_b64_tr_b16 v[44:45], v14 offset:12288
    ds_read_b64_tr_b16 v[46:47], v14 offset:13312
    v_mfma_f32_32x32x16_bf16 v[80:95], v[32:35], v[20:23], v[80:95]
    v_mfma_f32_32x32x16_bf16 v[96:111], v[36:39], v[20:23], v[96:111]
    s_waitcnt lgkmcnt(0)
    s_barrier
    v_mfma_f32_32x32x16_bf16 v[48:63], v[40:43], v[24:27], v[48:63]
    ds_read_b128 v[16:19], v10 offset:32768
    ds_read_b128 v[20:23], v11 offset:32768
    ds_read_b64_tr_b16 v[32:33], v12 offset:16384
    v_mfma_f32_32x32x16_bf16 v[64:79], v[44:47], v[24:27], v[64:79]
    ds_read_b64_tr_b16 v[34:35], v12 offset:17408
    ds_read_b64_tr_b16 v[36:37], v14 offset:16384
    ds_read_b64_tr_b16 v[38:39], v14 offset:17408
    v_mfma_f32_32x32x16_bf16 v[80:95], v[40:43], v[28:31], v[80:95]
    v_mfma_f32_32x32x16_bf16 v[96:111], v[44:47], v[28:31], v[96:111]
    s_waitcnt lgkmcnt(0)
    v_mfma_f32_32x32x16_bf16 v[48:63], v[32:35], v[16:19], v[48:63]
    ds_read_b128 v[24:27], v10 offset:36864
    ds_read_b128 v[28:31], v11 offset:36864
    ds_read_b64_tr_b16 v[40:41], v12 offset:20480
    v_mfma_f32_32x32x16_bf16 v[64:79], v[36:39], v[16:19], v[64:79]
    ds_read_b64_tr_b16 v[42:43], v12 offset:21504
    ds_read_b64_tr_b16 v[44:45], v14 offset:20480
    ds_read_b64_tr_b16 v[46:47], v14 offset:21504
    v_mfma_f32_32x32x16_bf16 v[80:95], v[32:35], v[20:23], v[80:95]
    v_mfma_f32_32x32x16_bf16 v[96:111], v[36:39], v[20:23], v[96:111]
    s_waitcnt lgkmcnt(0)
    v_mfma_f32_32x32x16_bf16 v[48:63], v[40:43], v[24:27], v[48:63]
    ds_read_b128 v[16:19], v10 offset:40960
    ds_read_b128 v[20:23], v11 offset:40960
    ds_read_b64_tr_b16 v[32:33], v12 offset:24576
    v_mfma_f32_32x32x16_bf16 v[64:79], v[44:47], v[24:27], v[64:79]
    ds_read_b64_tr_b16 v[34:35], v12 offset:25600
    ds_read_b64_tr_b16 v[36:37], v14 offset:24576
    ds_read_b64_tr_b16 v[38:39], v14 offset:25600
    v_mfma_f32_32x32x16_bf16 v[80:95], v[40:43], v[28:31], v[80:95]
    v_mfma_f32_32x32x16_bf16 v[96:111], v[44:47], v[28:31], v[96:111]
    s_waitcnt lgkmcnt(0)
    v_mfma_f32_32x32x16_bf16 v[48:63], v[32:35], v[16:19], v[48:63]
    ds_read_b128 v[24:27], v10 offset:45056
    ds_read_b128 v[28:31], v11 offset:45056
    ds_read_b64_tr_b16 v[40:41], v12 offset:28672
    v_mfma_f32_32x32x16_bf16 v[64:79], v[36:39], v[16:19], v[64:79]
    ds_read_b64_tr_b16 v[42:43], v12 offset:29696
    ds_read_b64_tr_b16 v[44:45], v14 offset:28672
    ds_read_b64_tr_b16 v[46:47], v14 offset:29696
    v_mfma_f32_32x32x16_bf16 v[80:95], v[32:35], v[20:23], v[80:95]
    v_mfma_f32_32x32x16_bf16 v[96:111], v[36:39], v[20:23], v[96:111]
    s_waitcnt lgkmcnt(0)
    s_barrier
    v_mfma_f32_32x32x16_bf16 v[48:63], v[40:43], v[24:27], v[48:63]
    ds_read_b128 v[16:19], v10 offset:49152
    ds_read_b128 v[20:23], v11 offset:49152
    ds_read_b64_tr_b16 v[32:33], v12 offset:32768
    v_mfma_f32_32x32x16_bf16 v[64:79], v[44:47], v[24:27], v[64:79]
    ds_read_b64_tr_b16 v[34:35], v12 offset:33792
    ds_read_b64_tr_b16 v[36:37], v14 offset:32768
    ds_read_b64_tr_b16 v[38:39], v14 offset:33792
    v_mfma_f32_32x32x16_bf16 v[80:95], v[40:43], v[28:31], v[80:95]
    v_mfma_f32_32x32x16_bf16 v[96:111], v[44:47], v[28:31], v[96:111]
    s_waitcnt lgkmcnt(0)
    v_mfma_f32_32x32x16_bf16 v[48:63], v[32:35], v[16:19], v[48:63]
    ds_read_b128 v[24:27], v10 offset:53248
    ds_read_b128 v[28:31], v11 offset:53248
    ds_read_b64_tr_b16 v[40:41], v12 offset:36864
    v_mfma_f32_32x32x16_bf16 v[64:79], v[36:39], v[16:19], v[64:79]
    ds_read_b64_tr_b16 v[42:43], v12 offset:37888
    ds_read_b64_tr_b16 v[44:45], v14 offset:36864
    ds_read_b64_tr_b16 v[46:47], v14 offset:37888
    v_mfma_f32_32x32x16_bf16 v[80:95], v[32:35], v[20:23], v[80:95]
    v_mfma_f32_32x32x16_bf16 v[96:111], v[36:39], v[20:23], v[96:111]
    s_waitcnt lgkmcnt(0)
    v_mfma_f32_32x32x16_bf16 v[48:63], v[40:43], v[24:27], v[48:63]
    ds_read_b128 v[16:19], v10 offset:57344
    ds_read_b128 v[20:23], v11 offset:57344
    ds_read_b64_tr_b16 v[32:33], v12 offset:40960
    v_mfma_f32_32x32x16_bf16 v[64:79], v[44:47], v[24:27], v[64:79]
    ds_read_b64_tr_b16 v[34:35], v12 offset:41984
    ds_read_b64_tr_b16 v[36:37], v14 offset:40960
    ds_read_b64_tr_b16 v[38:39], v14 offset:41984
    v_mfma_f32_32x32x16_bf16 v[80:95], v[40:43], v[28:31], v[80:95]
    v_mfma_f32_32x32x16_bf16 v[96:111], v[44:47], v[28:31], v[96:111]
    s_waitcnt lgkmcnt(0)
    v_mfma_f32_32x32x16_bf16 v[48:63], v[32:35], v[16:19], v[48:63]
    ds_read_b128 v[24:27], v10 offset:61440
    ds_read_b128 v[28:31], v11 offset:61440
    ds_read_b64_tr_b16 v[40:41], v12 offset:45056
    v_mfma_f32_32x32x16_bf16 v[64:79], v[36:39], v[16:19], v[64:79]
    ds_read_b64_tr_b16 v[42:43], v12 offset:46080
    ds_read_b64_tr_b16 v[44:45], v14 offset:45056
    ds_read_b64_tr_b16 v[46:47], v14 offset:46080
    v_mfma_f32_32x32x16_bf16 v[80:95], v[32:35], v[20:23], v[80:95]
    v_mfma_f32_32x32x16_bf16 v[96:111], v[36:39], v[20:23], v[96:111]
    s_waitcnt lgkmcnt(0)
    s_barrier
    v_mfma_f32_32x32x16_bf16 v[48:63], v[40:43], v[24:27], v[48:63]
    ds_read_b128 v[16:19], v10 offset:0
    ds_read_b128 v[20:23], v11 offset:0
    ds_read_b64_tr_b16 v[32:33], v12 offset:49152
    v_mfma_f32_32x32x16_bf16 v[64:79], v[44:47], v[24:27], v[64:79]
    ds_read_b64_tr_b16 v[34:35], v12 offset:50176
    ds_read_b64_tr_b16 v[36:37], v14 offset:49152
    ds_read_b64_tr_b16 v[38:39], v14 offset:50176
    v_mfma_f32_32x32x16_bf16 v[80:95], v[40:43], v[28:31], v[80:95]
    v_mfma_f32_32x32x16_bf16 v[96:111], v[44:47], v[28:31], v[96:111]
    s_waitcnt lgkmcnt(0)
    v_mfma_f32_32x32x16_bf16 v[48:63], v[32:35], v[16:19], v[48:63]
    ds_read_b128 v[24:27], v10 offset:4096
    ds_read_b128 v[28:31], v11 offset:4096
    ds_read_b64_tr_b16 v[40:41], v12 offset:53248
    v_mfma_f32_32x32x16_bf16 v[64:79], v[36:39], v[16:19], v[64:79]
    ds_read_b64_tr_b16 v[42:43], v12 offset:54272
    ds_read_b64_tr_b16 v[44:45], v14 offset:53248
    ds_read_b64_tr_b16 v[46:47], v14 offset:54272
    v_mfma_f32_32x32x16_bf16 v[80:95], v[32:35], v[20:23], v[80:95]
    v_mfma_f32_32x32x16_bf16 v[96:111], v[36:39], v[20:23], v[96:111]
    s_waitcnt lgkmcnt(0)
    v_mfma_f32_32x32x16_bf16 v[48:63], v[40:43], v[24:27], v[48:63]
    ds_read_b128 v[16:19], v10 offset:8192
    ds_read_b128 v[20:23], v11 offset:8192
    ds_read_b64_tr_b16 v[32:33], v12 offset:57344
    v_mfma_f32_32x32x16_bf16 v[64:79], v[44:47], v[24:27], v[64:79]
    ds_read_b64_tr_b16 v[34:35], v12 offset:58368
    ds_read_b64_tr_b16 v[36:37], v14 offset:57344
    ds_read_b64_tr_b16 v[38:39], v14 offset:58368
    v_mfma_f32_32x32x16_bf16 v[80:95], v[40:43], v[28:31], v[80:95]
    v_mfma_f32_32x32x16_bf16 v[96:111], v[44:47], v[28:31], v[96:111]
    s_waitcnt lgkmcnt(0)
    v_mfma_f32_32x32x16_bf16 v[48:63], v[32:35], v[16:19], v[48:63]
    ds_read_b128 v[24:27], v10 offset:12288
    ds_read_b128 v[28:31], v11 offset:12288
    ds_read_b64_tr_b16 v[40:41], v12 offset:61440
    v_mfma_f32_32x32x16_bf16 v[64:79], v[36:39], v[16:19], v[64:79]
    ds_read_b64_tr_b16 v[42:43], v12 offset:62464
    ds_read_b64_tr_b16 v[44:45], v14 offset:61440
    ds_read_b64_tr_b16 v[46:47], v14 offset:62464
    v_mfma_f32_32x32x16_bf16 v[80:95], v[32:35], v[20:23], v[80:95]
    v_mfma_f32_32x32x16_bf16 v[96:111], v[36:39], v[20:23], v[96:111]
    s_waitcnt lgkmcnt(0)
    s_barrier
    v_mfma_f32_32x32x16_bf16 v[48:63], v[40:43], v[24:27], v[48:63]
    ds_read_b128 v[16:19], v10 offset:16384
    ds_read_b128 v[20:23], v11 offset:16384
    ds_read_b64_tr_b16 v[32:33], v13 offset:0
    ds_read_b128 v[126:129], v122 offset:0
    ds_read_b128 v[130:133], v122 offset:2048
    v_mfma_f32_32x32x16_bf16 v[64:79], v[44:47], v[24:27], v[64:79]
    ds_read_b64_tr_b16 v[34:35], v13 offset:1024
    ds_read_b64_tr_b16 v[36:37], v15 offset:0
    ds_read_b64_tr_b16 v[38:39], v15 offset:1024
    ds_read_b128 v[134:137], v122 offset:4096
    ds_read_b128 v[138:141], v122 offset:6144
    v_mfma_f32_32x32x16_bf16 v[80:95], v[40:43], v[28:31], v[80:95]
    ds_read_b128 v[142:145], v122 offset:8192
    ds_read_b128 v[146:149], v122 offset:10240
    ds_read_b128 v[150:153], v122 offset:12288
    ds_read_b128 v[154:157], v122 offset:14336
    v_mfma_f32_32x32x16_bf16 v[96:111], v[44:47], v[28:31], v[96:111]
    ds_read_b128 v[158:161], v123 offset:0
    ds_read_b128 v[162:165], v123 offset:2048
    s_waitcnt lgkmcnt(0)
    v_mfma_f32_32x32x16_bf16 v[48:63], v[32:35], v[16:19], v[48:63]
    ds_read_b128 v[24:27], v10 offset:20480
    ds_read_b128 v[28:31], v11 offset:20480
    ds_read_b64_tr_b16 v[40:41], v13 offset:4096
    ds_read_b64 v[166:167], v124 offset:0
    ds_read_b64 v[168:169], v124 offset:1024
    v_mfma_f32_32x32x16_bf16 v[64:79], v[36:39], v[16:19], v[64:79]
    ds_read_b64_tr_b16 v[42:43], v13 offset:5120
    ds_read_b64_tr_b16 v[44:45], v15 offset:4096
    ds_read_b64_tr_b16 v[46:47], v15 offset:5120
    ds_read_b64 v[170:171], v124 offset:2048
    ds_read_b64 v[172:173], v124 offset:3072
    v_mfma_f32_32x32x16_bf16 v[80:95], v[32:35], v[20:23], v[80:95]
    ds_read_b64 v[174:175], v124 offset:4096
    ds_read_b64 v[176:177], v124 offset:5120
    ds_read_b64 v[178:179], v124 offset:6144
    ds_read_b64 v[180:181], v124 offset:7168
    v_mfma_f32_32x32x16_bf16 v[96:111], v[36:39], v[20:23], v[96:111]
    ds_read_b64 v[182:183], v124 offset:8192
    ds_read_b64 v[184:185], v124 offset:9216
    s_waitcnt lgkmcnt(0)
    v_mfma_f32_32x32x16_bf16 v[48:63], v[40:43], v[24:27], v[48:63]
    ds_read_b128 v[16:19], v10 offset:24576
    ds_read_b128 v[20:23], v11 offset:24576
    ds_read_b64_tr_b16 v[32:33], v13 offset:8192
    v_min_u32 v187, v127, v131
    v_max_u32 v188, v127, v131
    v_add_f32 v126, v126, v130
    v_mfma_f32_32x32x16_bf16 v[64:79], v[44:47], v[24:27], v[64:79]
    ds_read_b64_tr_b16 v[34:35], v13 offset:9216
    ds_read_b64_tr_b16 v[36:37], v15 offset:8192
    ds_read_b64_tr_b16 v[38:39], v15 offset:9216
    v_min3_u32 v187, v135, v139, v187
    v_add_f32 v128, v128, v132
    v_max3_u32 v188, v135, v139, v188
    v_mfma_f32_32x32x16_bf16 v[80:95], v[40:43], v[28:31], v[80:95]
    v_add_f32 v166, v166, v168
    v_min3_u32 v187, v143, v147, v187
    v_add_f32 v126, v126, v134
    v_max3_u32 v188, v143, v147, v188
    v_add_f32 v128, v128, v136
    v_min3_u32 v187, v151, v155, v187
    v_add_f32 v166, v166, v170
    v_max3_u32 v188, v151, v155, v188
    v_add_f32 v126, v126, v138
    v_mfma_f32_32x32x16_bf16 v[96:111], v[44:47], v[28:31], v[96:111]
    v_min3_u32 v187, v159, v163, v187
    v_add_f32 v128, v128, v140
    v_max3_u32 v188, v159, v163, v188
    v_add_f32 v166, v166, v172
    v_min3_u32 v187, v129, v133, v187
    v_add_f32 v126, v126, v142
    v_max3_u32 v188, v129, v133, v188
    v_add_f32 v128, v128, v144
    s_waitcnt lgkmcnt(0)
    v_mfma_f32_32x32x16_bf16 v[48:63], v[32:35], v[16:19], v[48:63]
    ds_read_b128 v[24:27], v10 offset:28672
    ds_read_b128 v[28:31], v11 offset:28672
    ds_read_b64_tr_b16 v[40:41], v13 offset:12288
    v_min3_u32 v187, v137, v141, v187
    v_add_f32 v166, v166, v174
    v_max3_u32 v188, v137, v141, v188
    v_mfma_f32_32x32x16_bf16 v[64:79], v[36:39], v[16:19], v[64:79]
    ds_read_b64_tr_b16 v[42:43], v13 offset:13312
    ds_read_b64_tr_b16 v[44:45], v15 offset:12288
    ds_read_b64_tr_b16 v[46:47], v15 offset:13312
    v_add_f32 v126, v126, v146
    v_min3_u32 v187, v145, v149, v187
    v_add_f32 v128, v128, v148
    v_mfma_f32_32x32x16_bf16 v[80:95], v[32:35], v[20:23], v[80:95]
    v_max3_u32 v188, v145, v149, v188
    v_add_f32 v166, v166, v176
    v_min3_u32 v187, v153, v157, v187
    v_add_f32 v126, v126, v150
    v_max3_u32 v188, v153, v157, v188
    v_add_f32 v128, v128, v152
    v_min3_u32 v187, v161, v165, v187
    v_add_f32 v166, v166, v178
    v_max3_u32 v188, v161, v165, v188
    v_mfma_f32_32x32x16_bf16 v[96:111], v[36:39], v[20:23], v[96:111]
    v_add_f32 v126, v126, v154
    v_min3_u32 v187, v167, v169, v187
    v_add_f32 v128, v128, v156
    v_max3_u32 v188, v167, v169, v188
    v_add_f32 v166, v166, v180
    v_min3_u32 v187, v171, v173, v187
    v_add_f32 v126, v126, v158
    v_max3_u32 v188, v171, v173, v188
    s_waitcnt lgkmcnt(0)
    s_barrier
    v_mfma_f32_32x32x16_bf16 v[48:63], v[40:43], v[24:27], v[48:63]
    v_add_f32 v128, v128, v160
    v_min3_u32 v187, v175, v177, v187
    v_add_f32 v166, v166, v182
    v_mfma_f32_32x32x16_bf16 v[64:79], v[44:47], v[24:27], v[64:79]
    v_max3_u32 v188, v175, v177, v188
    v_add_f32 v126, v126, v162
    v_min3_u32 v187, v179, v181, v187
    v_mfma_f32_32x32x16_bf16 v[80:95], v[40:43], v[28:31], v[80:95]
    v_add_f32 v128, v128, v164
    v_max3_u32 v188, v179, v181, v188
    v_add_f32 v166, v166, v184
    v_min3_u32 v187, v183, v185, v187
    v_max3_u32 v188, v183, v185, v188
    v_mul_f32 v126, 0x3acccccd, v126
    v_mul_f32 v128, 0x3acccccd, v128
    v_fma_f32 v128, -v126, v126, v128
    v_max_f32 v128, 0, v128
    v_mfma_f32_32x32x16_bf16 v[96:111], v[44:47], v[28:31], v[96:111]
    v_add_f32 v128, 0x3727c5ac, v128
    v_rsq_f32 v128, v128
    v_xor_b32 v187, v187, v186
    v_xor_b32 v188, v188, v186
    v_mul_f32 v126, v126, v128
    v_or_b32 v187, v187, v188
    v_sub_f32 v126, 0, v126
    v_cmp_ne_u32 vcc, 0, v187
    s_cmp_eq_u64 vcc, 0
    s_cbranch_scc1 st_ok_82
    s_mov_b32 s71, 50000
st_retry_83:
    s_mov_b32 s70, 0
    buffer_load_dwordx4 v[126:129], v120, s[36:39], s70 offen sc1
    s_mov_b32 s70, 0
    buffer_load_dwordx2 v[166:167], v121, s[36:39], s70 offen sc1
    s_mov_b32 s70, 2048
    buffer_load_dwordx4 v[130:133], v120, s[36:39], s70 offen sc1
    s_mov_b32 s70, 1024
    buffer_load_dwordx2 v[168:169], v121, s[36:39], s70 offen sc1
    s_mov_b32 s70, 4096
    buffer_load_dwordx4 v[134:137], v120, s[36:39], s70 offen sc1
    s_mov_b32 s70, 2048
    buffer_load_dwordx2 v[170:171], v121, s[36:39], s70 offen sc1
    s_mov_b32 s70, 6144
    buffer_load_dwordx4 v[138:141], v120, s[36:39], s70 offen sc1
    s_mov_b32 s70, 3072
    buffer_load_dwordx2 v[172:173], v121, s[36:39], s70 offen sc1
    s_mov_b32 s70, 8192
    buffer_load_dwordx4 v[142:145], v120, s[36:39], s70 offen sc1
    s_mov_b32 s70, 4096
    buffer_load_dwordx2 v[174:175], v121, s[36:39], s70 offen sc1
    s_mov_b32 s70, 10240
    buffer_load_dwordx4 v[146:149], v120, s[36:39], s70 offen sc1
    s_mov_b32 s70, 5120
    buffer_load_dwordx2 v[176:177], v121, s[36:39], s70 offen sc1
    s_mov_b32 s70, 12288
    buffer_load_dwordx4 v[150:153], v120, s[36:39], s70 offen sc1
    s_mov_b32 s70, 6144
    buffer_load_dwordx2 v[178:179], v121, s[36:39], s70 offen sc1
    s_mov_b32 s70, 14336
    buffer_load_dwordx4 v[154:157], v120, s[36:39], s70 offen sc1
    s_mov_b32 s70, 7168
    buffer_load_dwordx2 v[180:181], v121, s[36:39], s70 offen sc1
    s_mov_b32 s70, 16384
    buffer_load_dwordx4 v[158:161], v120, s[36:39], s70 offen sc1
    s_mov_b32 s70, 8192
    buffer_load_dwordx2 v[182:183], v121, s[36:39], s70 offen sc1
    s_mov_b32 s70, 18432
    buffer_load_dwordx4 v[162:165], v120, s[36:39], s70 offen sc1
    s_mov_b32 s70, 9216
    buffer_load_dwordx2 v[184:185], v121, s[36:39], s70 offen sc1
    s_waitcnt vmcnt(0)
    v_min_u32 v187, v127, v131
    v_max_u32 v188, v127, v131
    v_add_f32 v126, v126, v130
    v_min3_u32 v187, v135, v139, v187
    v_add_f32 v128, v128, v132
    v_max3_u32 v188, v135, v139, v188
    v_add_f32 v166, v166, v168
    v_min3_u32 v187, v143, v147, v187
    v_add_f32 v126, v126, v134
    v_max3_u32 v188, v143, v147, v188
    v_add_f32 v128, v128, v136
    v_min3_u32 v187, v151, v155, v187
    v_add_f32 v166, v166, v170
    v_max3_u32 v188, v151, v155, v188
    v_add_f32 v126, v126, v138
    v_min3_u32 v187, v159, v163, v187
    v_add_f32 v128, v128, v140
    v_max3_u32 v188, v159, v163, v188
    v_add_f32 v166, v166, v172
    v_min3_u32 v187, v129, v133, v187
    v_add_f32 v126, v126, v142
    v_max3_u32 v188, v129, v133, v188
    v_add_f32 v128, v128, v144
    v_min3_u32 v187, v137, v141, v187
    v_add_f32 v166, v166, v174
    v_max3_u32 v188, v137, v141, v188
    v_add_f32 v126, v126, v146
    v_min3_u32 v187, v145, v149, v187
    v_add_f32 v128, v128, v148
    v_max3_u32 v188, v145, v149, v188
    v_add_f32 v166, v166, v176
    v_min3_u32 v187, v153, v157, v187
    v_add_f32 v126, v126, v150
    v_max3_u32 v188, v153, v157, v188
    v_add_f32 v128, v128, v152
    v_min3_u32 v187, v161, v165, v187
    v_add_f32 v166, v166, v178
    v_max3_u32 v188, v161, v165, v188
    v_add_f32 v126, v126, v154
    v_min3_u32 v187, v167, v169, v187
    v_add_f32 v128, v128, v156
    v_max3_u32 v188, v167, v169, v188
    v_add_f32 v166, v166, v180
    v_min3_u32 v187, v171, v173, v187
    v_add_f32 v126, v126, v158
    v_max3_u32 v188, v171, v173, v188
    v_add_f32 v128, v128, v160
    v_min3_u32 v187, v175, v177, v187
    v_add_f32 v166, v166, v182
    v_max3_u32 v188, v175, v177, v188
    v_add_f32 v126, v126, v162
    v_min3_u32 v187, v179, v181, v187
    v_add_f32 v128, v128, v164
    v_max3_u32 v188, v179, v181, v188
    v_add_f32 v166, v166, v184
    v_min3_u32 v187, v183, v185, v187
    v_max3_u32 v188, v183, v185, v188
    v_mul_f32 v126, 0x3acccccd, v126
    v_mul_f32 v128, 0x3acccccd, v128
    v_fma_f32 v128, -v126, v126, v128
    v_max_f32 v128, 0, v128
    v_add_f32 v128, 0x3727c5ac, v128
    v_rsq_f32 v128, v128
    s_nop 0
    v_xor_b32 v187, v187, v186
    v_xor_b32 v188, v188, v186
    v_mul_f32 v126, v126, v128
    v_or_b32 v187, v187, v188
    v_sub_f32 v126, 0, v126
    v_cmp_ne_u32 vcc, 0, v187
    s_cmp_eq_u64 vcc, 0
    s_cbranch_scc1 st_ok_82
    s_sub_u32 s71, s71, 1
    s_cmp_lg_u32 s71, 0
    s_cbranch_scc1 st_retry_83
st_ok_82:
    v_mov_b32 v32, v128
    v_mov_b32 v34, v128
    s_nop 1
    v_permlane32_swap_b32 v32, v34
    v_mov_b32 v36, v126
    v_mov_b32 v38, v126
    s_nop 1
    v_permlane32_swap_b32 v36, v38
    v_lshl_add_u32 v229, v1, 2, s76
    ds_write_b32 v229, v166
    v_lshl_add_u32 v229, v9, 4, s76
    s_waitcnt lgkmcnt(0)
    ds_read_b128 v[130:133], v229 offset:0
    ds_read_b128 v[134:137], v229 offset:32
    ds_read_b128 v[138:141], v229 offset:64
    ds_read_b128 v[142:145], v229 offset:96
    ds_read_b128 v[146:149], v229 offset:128
    ds_read_b128 v[150:153], v229 offset:160
    ds_read_b128 v[154:157], v229 offset:192
    ds_read_b128 v[158:161], v229 offset:224
    s_waitcnt lgkmcnt(4)
    v_pk_fma_f32 v[168:169], v[130:131], v[36:37], v[194:195] op_sel_hi:[1,0,1]
    v_pk_fma_f32 v[170:171], v[132:133], v[36:37], v[196:197] op_sel_hi:[1,0,1]
    v_pk_fma_f32 v[172:173], v[134:135], v[36:37], v[198:199] op_sel_hi:[1,0,1]
    v_pk_fma_f32 v[174:175], v[136:137], v[36:37], v[200:201] op_sel_hi:[1,0,1]
    v_pk_fma_f32 v[176:177], v[138:139], v[36:37], v[202:203] op_sel_hi:[1,0,1]
    v_pk_fma_f32 v[178:179], v[140:141], v[36:37], v[204:205] op_sel_hi:[1,0,1]
    v_pk_fma_f32 v[180:181], v[142:143], v[36:37], v[206:207] op_sel_hi:[1,0,1]
    v_pk_fma_f32 v[182:183], v[144:145], v[36:37], v[208:209] op_sel_hi:[1,0,1]
    v_pk_fma_f32 v[48:49], v[48:49], v[32:33], v[168:169] op_sel_hi:[1,0,1]
    v_pk_fma_f32 v[50:51], v[50:51], v[32:33], v[170:171] op_sel_hi:[1,0,1]
    v_pk_fma_f32 v[52:53], v[52:53], v[32:33], v[172:173] op_sel_hi:[1,0,1]
    v_pk_fma_f32 v[54:55], v[54:55], v[32:33], v[174:175] op_sel_hi:[1,0,1]
    v_pk_fma_f32 v[56:57], v[56:57], v[32:33], v[176:177] op_sel_hi:[1,0,1]
    v_pk_fma_f32 v[58:59], v[58:59], v[32:33], v[178:179] op_sel_hi:[1,0,1]
    v_pk_fma_f32 v[60:61], v[60:61], v[32:33], v[180:181] op_sel_hi:[1,0,1]
    v_pk_fma_f32 v[62:63], v[62:63], v[32:33], v[182:183] op_sel_hi:[1,0,1]
    v_max_f32 v48, 0, v48
    v_max_f32 v49, 0, v49
    v_max_f32 v50, 0, v50
    v_max_f32 v51, 0, v51
    v_max_f32 v52, 0, v52
    v_max_f32 v53, 0, v53
    v_max_f32 v54, 0, v54
    v_max_f32 v55, 0, v55
    v_max_f32 v56, 0, v56
    v_max_f32 v57, 0, v57
    v_max_f32 v58, 0, v58
    v_max_f32 v59, 0, v59
    v_max_f32 v60, 0, v60
    v_max_f32 v61, 0, v61
    v_max_f32 v62, 0, v62
    v_max_f32 v63, 0, v63
    v_pk_mul_f32 v[48:49], v[48:49], v[48:49]
    v_pk_mul_f32 v[50:51], v[50:51], v[50:51]
    v_pk_mul_f32 v[52:53], v[52:53], v[52:53]
    v_pk_mul_f32 v[54:55], v[54:55], v[54:55]
    v_pk_mul_f32 v[56:57], v[56:57], v[56:57]
    v_pk_mul_f32 v[58:59], v[58:59], v[58:59]
    v_pk_mul_f32 v[60:61], v[60:61], v[60:61]
    v_pk_mul_f32 v[62:63], v[62:63], v[62:63]
    v_cvt_pk_bf16_f32 v16, v48, v49
    v_cvt_pk_bf16_f32 v17, v50, v51
    v_cvt_pk_bf16_f32 v18, v52, v53
    v_cvt_pk_bf16_f32 v19, v54, v55
    v_cvt_pk_bf16_f32 v20, v56, v57
    v_cvt_pk_bf16_f32 v21, v58, v59
    v_cvt_pk_bf16_f32 v22, v60, v61
    v_cvt_pk_bf16_f32 v23, v62, v63
    s_nop 1
    v_permlane32_swap_b32 v16, v18
    v_permlane32_swap_b32 v17, v19
    v_permlane32_swap_b32 v20, v22
    v_permlane32_swap_b32 v21, v23
    buffer_store_dwordx4 v[16:19], v226, s[32:35], s72 offen sc1
    buffer_store_dwordx4 v[20:23], v226, s[32:35], s73 offen sc1
    v_pk_fma_f32 v[168:169], v[130:131], v[38:39], v[194:195] op_sel_hi:[1,0,1]
    v_pk_fma_f32 v[170:171], v[132:133], v[38:39], v[196:197] op_sel_hi:[1,0,1]
    v_pk_fma_f32 v[172:173], v[134:135], v[38:39], v[198:199] op_sel_hi:[1,0,1]
    v_pk_fma_f32 v[174:175], v[136:137], v[38:39], v[200:201] op_sel_hi:[1,0,1]
    v_pk_fma_f32 v[176:177], v[138:139], v[38:39], v[202:203] op_sel_hi:[1,0,1]
    v_pk_fma_f32 v[178:179], v[140:141], v[38:39], v[204:205] op_sel_hi:[1,0,1]
    v_pk_fma_f32 v[180:181], v[142:143], v[38:39], v[206:207] op_sel_hi:[1,0,1]
    v_pk_fma_f32 v[182:183], v[144:145], v[38:39], v[208:209] op_sel_hi:[1,0,1]
    v_pk_fma_f32 v[80:81], v[80:81], v[34:35], v[168:169] op_sel_hi:[1,0,1]
    v_pk_fma_f32 v[82:83], v[82:83], v[34:35], v[170:171] op_sel_hi:[1,0,1]
    v_pk_fma_f32 v[84:85], v[84:85], v[34:35], v[172:173] op_sel_hi:[1,0,1]
    v_pk_fma_f32 v[86:87], v[86:87], v[34:35], v[174:175] op_sel_hi:[1,0,1]
    v_pk_fma_f32 v[88:89], v[88:89], v[34:35], v[176:177] op_sel_hi:[1,0,1]
    v_pk_fma_f32 v[90:91], v[90:91], v[34:35], v[178:179] op_sel_hi:[1,0,1]
    v_pk_fma_f32 v[92:93], v[92:93], v[34:35], v[180:181] op_sel_hi:[1,0,1]
    v_pk_fma_f32 v[94:95], v[94:95], v[34:35], v[182:183] op_sel_hi:[1,0,1]
    v_max_f32 v80, 0, v80
    v_max_f32 v81, 0, v81
    v_max_f32 v82, 0, v82
    v_max_f32 v83, 0, v83
    v_max_f32 v84, 0, v84
    v_max_f32 v85, 0, v85
    v_max_f32 v86, 0, v86
    v_max_f32 v87, 0, v87
    v_max_f32 v88, 0, v88
    v_max_f32 v89, 0, v89
    v_max_f32 v90, 0, v90
    v_max_f32 v91, 0, v91
    v_max_f32 v92, 0, v92
    v_max_f32 v93, 0, v93
    v_max_f32 v94, 0, v94
    v_max_f32 v95, 0, v95
    v_pk_mul_f32 v[80:81], v[80:81], v[80:81]
    v_pk_mul_f32 v[82:83], v[82:83], v[82:83]
    v_pk_mul_f32 v[84:85], v[84:85], v[84:85]
    v_pk_mul_f32 v[86:87], v[86:87], v[86:87]
    v_pk_mul_f32 v[88:89], v[88:89], v[88:89]
    v_pk_mul_f32 v[90:91], v[90:91], v[90:91]
    v_pk_mul_f32 v[92:93], v[92:93], v[92:93]
    v_pk_mul_f32 v[94:95], v[94:95], v[94:95]
    v_cvt_pk_bf16_f32 v16, v80, v81
    v_cvt_pk_bf16_f32 v17, v82, v83
    v_cvt_pk_bf16_f32 v18, v84, v85
    v_cvt_pk_bf16_f32 v19, v86, v87
    v_cvt_pk_bf16_f32 v20, v88, v89
    v_cvt_pk_bf16_f32 v21, v90, v91
    v_cvt_pk_bf16_f32 v22, v92, v93
    v_cvt_pk_bf16_f32 v23, v94, v95
    s_nop 1
    v_permlane32_swap_b32 v16, v18
    v_permlane32_swap_b32 v17, v19
    v_permlane32_swap_b32 v20, v22
    v_permlane32_swap_b32 v21, v23
    buffer_store_dwordx4 v[16:19], v227, s[32:35], s72 offen sc1
    buffer_store_dwordx4 v[20:23], v227, s[32:35], s73 offen sc1
    s_waitcnt lgkmcnt(0)
    v_pk_fma_f32 v[168:169], v[146:147], v[36:37], v[210:211] op_sel_hi:[1,0,1]
    v_pk_fma_f32 v[170:171], v[148:149], v[36:37], v[212:213] op_sel_hi:[1,0,1]
    v_pk_fma_f32 v[172:173], v[150:151], v[36:37], v[214:215] op_sel_hi:[1,0,1]
    v_pk_fma_f32 v[174:175], v[152:153], v[36:37], v[216:217] op_sel_hi:[1,0,1]
    v_pk_fma_f32 v[176:177], v[154:155], v[36:37], v[218:219] op_sel_hi:[1,0,1]
    v_pk_fma_f32 v[178:179], v[156:157], v[36:37], v[220:221] op_sel_hi:[1,0,1]
    v_pk_fma_f32 v[180:181], v[158:159], v[36:37], v[222:223] op_sel_hi:[1,0,1]
    v_pk_fma_f32 v[182:183], v[160:161], v[36:37], v[224:225] op_sel_hi:[1,0,1]
    v_pk_fma_f32 v[64:65], v[64:65], v[32:33], v[168:169] op_sel_hi:[1,0,1]
    v_pk_fma_f32 v[66:67], v[66:67], v[32:33], v[170:171] op_sel_hi:[1,0,1]
    v_pk_fma_f32 v[68:69], v[68:69], v[32:33], v[172:173] op_sel_hi:[1,0,1]
    v_pk_fma_f32 v[70:71], v[70:71], v[32:33], v[174:175] op_sel_hi:[1,0,1]
    v_pk_fma_f32 v[72:73], v[72:73], v[32:33], v[176:177] op_sel_hi:[1,0,1]
    v_pk_fma_f32 v[74:75], v[74:75], v[32:33], v[178:179] op_sel_hi:[1,0,1]
    v_pk_fma_f32 v[76:77], v[76:77], v[32:33], v[180:181] op_sel_hi:[1,0,1]
    v_pk_fma_f32 v[78:79], v[78:79], v[32:33], v[182:183] op_sel_hi:[1,0,1]
    v_max_f32 v64, 0, v64
    v_max_f32 v65, 0, v65
    v_max_f32 v66, 0, v66
    v_max_f32 v67, 0, v67
    v_max_f32 v68, 0, v68
    v_max_f32 v69, 0, v69
    v_max_f32 v70, 0, v70
    v_max_f32 v71, 0, v71
    v_max_f32 v72, 0, v72
    v_max_f32 v73, 0, v73
    v_max_f32 v74, 0, v74
    v_max_f32 v75, 0, v75
    v_max_f32 v76, 0, v76
    v_max_f32 v77, 0, v77
    v_max_f32 v78, 0, v78
    v_max_f32 v79, 0, v79
    v_pk_mul_f32 v[64:65], v[64:65], v[64:65]
    v_pk_mul_f32 v[66:67], v[66:67], v[66:67]
    v_pk_mul_f32 v[68:69], v[68:69], v[68:69]
    v_pk_mul_f32 v[70:71], v[70:71], v[70:71]
    v_pk_mul_f32 v[72:73], v[72:73], v[72:73]
    v_pk_mul_f32 v[74:75], v[74:75], v[74:75]
    v_pk_mul_f32 v[76:77], v[76:77], v[76:77]
    v_pk_mul_f32 v[78:79], v[78:79], v[78:79]
    v_cvt_pk_bf16_f32 v16, v64, v65
    v_cvt_pk_bf16_f32 v17, v66, v67
    v_cvt_pk_bf16_f32 v18, v68, v69
    v_cvt_pk_bf16_f32 v19, v70, v71
    v_cvt_pk_bf16_f32 v20, v72, v73
    v_cvt_pk_bf16_f32 v21, v74, v75
    v_cvt_pk_bf16_f32 v22, v76, v77
    v_cvt_pk_bf16_f32 v23, v78, v79
    s_nop 1
    v_permlane32_swap_b32 v16, v18
    v_permlane32_swap_b32 v17, v19
    v_permlane32_swap_b32 v20, v22
    v_permlane32_swap_b32 v21, v23
    buffer_store_dwordx4 v[16:19], v226, s[32:35], s74 offen sc1
    buffer_store_dwordx4 v[20:23], v226, s[32:35], s75 offen sc1
    v_pk_fma_f32 v[168:169], v[146:147], v[38:39], v[210:211] op_sel_hi:[1,0,1]
    v_pk_fma_f32 v[170:171], v[148:149], v[38:39], v[212:213] op_sel_hi:[1,0,1]
    v_pk_fma_f32 v[172:173], v[150:151], v[38:39], v[214:215] op_sel_hi:[1,0,1]
    v_pk_fma_f32 v[174:175], v[152:153], v[38:39], v[216:217] op_sel_hi:[1,0,1]
    v_pk_fma_f32 v[176:177], v[154:155], v[38:39], v[218:219] op_sel_hi:[1,0,1]
    v_pk_fma_f32 v[178:179], v[156:157], v[38:39], v[220:221] op_sel_hi:[1,0,1]
    v_pk_fma_f32 v[180:181], v[158:159], v[38:39], v[222:223] op_sel_hi:[1,0,1]
    v_pk_fma_f32 v[182:183], v[160:161], v[38:39], v[224:225] op_sel_hi:[1,0,1]
    v_pk_fma_f32 v[96:97], v[96:97], v[34:35], v[168:169] op_sel_hi:[1,0,1]
    v_pk_fma_f32 v[98:99], v[98:99], v[34:35], v[170:171] op_sel_hi:[1,0,1]
    v_pk_fma_f32 v[100:101], v[100:101], v[34:35], v[172:173] op_sel_hi:[1,0,1]
    v_pk_fma_f32 v[102:103], v[102:103], v[34:35], v[174:175] op_sel_hi:[1,0,1]
    v_pk_fma_f32 v[104:105], v[104:105], v[34:35], v[176:177] op_sel_hi:[1,0,1]
    v_pk_fma_f32 v[106:107], v[106:107], v[34:35], v[178:179] op_sel_hi:[1,0,1]
    v_pk_fma_f32 v[108:109], v[108:109], v[34:35], v[180:181] op_sel_hi:[1,0,1]
    v_pk_fma_f32 v[110:111], v[110:111], v[34:35], v[182:183] op_sel_hi:[1,0,1]
    v_max_f32 v96, 0, v96
    v_max_f32 v97, 0, v97
    v_max_f32 v98, 0, v98
    v_max_f32 v99, 0, v99
    v_max_f32 v100, 0, v100
    v_max_f32 v101, 0, v101
    v_max_f32 v102, 0, v102
    v_max_f32 v103, 0, v103
    v_max_f32 v104, 0, v104
    v_max_f32 v105, 0, v105
    v_max_f32 v106, 0, v106
    v_max_f32 v107, 0, v107
    v_max_f32 v108, 0, v108
    v_max_f32 v109, 0, v109
    v_max_f32 v110, 0, v110
    v_max_f32 v111, 0, v111
    v_pk_mul_f32 v[96:97], v[96:97], v[96:97]
    v_pk_mul_f32 v[98:99], v[98:99], v[98:99]
    v_pk_mul_f32 v[100:101], v[100:101], v[100:101]
    v_pk_mul_f32 v[102:103], v[102:103], v[102:103]
    v_pk_mul_f32 v[104:105], v[104:105], v[104:105]
    v_pk_mul_f32 v[106:107], v[106:107], v[106:107]
    v_pk_mul_f32 v[108:109], v[108:109], v[108:109]
    v_pk_mul_f32 v[110:111], v[110:111], v[110:111]
    v_cvt_pk_bf16_f32 v16, v96, v97
    v_cvt_pk_bf16_f32 v17, v98, v99
    v_cvt_pk_bf16_f32 v18, v100, v101
    v_cvt_pk_bf16_f32 v19, v102, v103
    v_cvt_pk_bf16_f32 v20, v104, v105
    v_cvt_pk_bf16_f32 v21, v106, v107
    v_cvt_pk_bf16_f32 v22, v108, v109
    v_cvt_pk_bf16_f32 v23, v110, v111
    s_nop 1
    v_permlane32_swap_b32 v16, v18
    v_permlane32_swap_b32 v17, v19
    v_permlane32_swap_b32 v20, v22
    v_permlane32_swap_b32 v21, v23
    buffer_store_dwordx4 v[16:19], v227, s[32:35], s74 offen sc1
    buffer_store_dwordx4 v[20:23], v227, s[32:35], s75 offen sc1
    s_add_u32 s77, s54, 48
    s_lshl_b32 s77, s77, 8
    s_lshl_b32 s78, s56, 2
    s_add_u32 s77, s77, s78
    s_waitcnt vmcnt(0)
    v_mov_b32 v230, 3852
    v_mov_b32 v231, 1
    s_mov_b64 exec, 1
    ds_add_rtn_u32 v231, v230, v231
    s_waitcnt lgkmcnt(0)
    v_cmp_eq_u32 vcc, 3, v231
    s_cmp_eq_u64 vcc, 0
    s_cbranch_scc1 nopub_84
    v_add_u32 v231, 1, v2
    v_mov_b32 v230, s77
    buffer_store_dword v231, v230, s[48:51], 0 offen sc1
nopub_84:
    s_mov_b64 exec, -1
    s_barrier
    s_cmp_ge_u32 s58, 5
    s_cbranch_scc1 c_end_72
    s_lshl_b32 s59, s54, 7
    s_lshl_b32 s60, s55, 7
    s_mov_b32 s36, s20
    s_and_b32 s37, s21, 0xffff
    s_mov_b32 s38, 2621440
    s_mov_b32 s39, 0x20000
    v_and_b32 v8, 31, v1
    v_lshrrev_b32 v9, 5, v1
    s_mov_b32 s61, s24
    s_mov_b32 s62, 0
    s_mov_b32 s63, 1
    s_lshl_b32 s64, s61, 9
    s_add_u32 s64, s64, 4096
    v_lshlrev_b32 v4, 4, v8
    v_lshl_add_u32 v4, v9, 11, v4
    v_add_u32 v10, s64, v4
    v_bfe_u32 v4, v1, 2, 2
    v_lshrrev_b32 v5, 1, v4
    v_xor_b32 v5, s62, v5
    v_lshlrev_b32 v5, 2, v5
    v_bfe_u32 v6, v1, 4, 1
    v_lshl_add_u32 v5, v6, 1, v5
    v_bfe_u32 v6, v1, 1, 1
    v_add_u32 v5, v5, v6
    v_lshlrev_b32 v5, 4, v5
    v_and_b32 v6, 1, v1
    v_lshl_add_u32 v5, v6, 3, v5
    v_lshl_add_u32 v4, v9, 3, v4
    v_mul_u32_u24 v4, 128, v4
    v_add_u32 v4, v4, v5
    v_add_u32 v11, 75776, v4
    v_add_u32 v12, 65536, v11
    v_bfe_u32 v4, v1, 2, 2
    v_lshrrev_b32 v5, 1, v4
    v_xor_b32 v5, s63, v5
    v_lshlrev_b32 v5, 2, v5
    v_bfe_u32 v6, v1, 4, 1
    v_lshl_add_u32 v5, v6, 1, v5
    v_bfe_u32 v6, v1, 1, 1
    v_add_u32 v5, v5, v6
    v_lshlrev_b32 v5, 4, v5
    v_and_b32 v6, 1, v1
    v_lshl_add_u32 v5, v6, 3, v5
    v_lshl_add_u32 v4, v9, 3, v4
    v_mul_u32_u24 v4, 128, v4
    v_add_u32 v4, v4, v5
    v_add_u32 v13, 75776, v4
    v_add_u32 v14, 65536, v13
    v_lshlrev_b32 v116, 3, v9
    s_lshl_b32 s64, s24, 12
    s_add_u32 s64, s64, 4096
    v_lshl_add_u32 v4, v8, 7, s64
    v_lshl_add_u32 v4, v9, 3, v4
    v_bfe_u32 v5, v8, 1, 3
    v_xor_b32 v134, 0, v5
    v_lshl_add_u32 v134, v134, 4, v4
    v_xor_b32 v135, 1, v5
    v_lshl_add_u32 v135, v135, 4, v4
    v_xor_b32 v136, 2, v5
    v_lshl_add_u32 v136, v136, 4, v4
    v_xor_b32 v137, 3, v5
    v_lshl_add_u32 v137, v137, 4, v4
    v_xor_b32 v138, 4, v5
    v_lshl_add_u32 v138, v138, 4, v4
    v_xor_b32 v139, 5, v5
    v_lshl_add_u32 v139, v139, 4, v4
    v_xor_b32 v140, 6, v5
    v_lshl_add_u32 v140, v140, 4, v4
    v_xor_b32 v141, 7, v5
    v_lshl_add_u32 v141, v141, 4, v4
    v_lshrrev_b32 v4, 3, v1
    s_lshl_b32 s64, s24, 5
    s_add_u32 s64, s64, s59
    v_add_u32 v4, s64, v4
    v_mul_u32_u24 v4, 1280, v4
    v_add_u32 v4, s60, v4
    v_and_b32 v5, 7, v1
    v_lshrrev_b32 v6, 4, v1
    v_xor_b32 v5, v5, v6
    v_lshl_add_u32 v142, v5, 4, v4
    v_xor_b32 v5, 4, v5
    v_lshl_add_u32 v143, v5, 4, v4
    s_lshl_b32 s64, s24, 12
    s_add_u32 s64, s64, 4096
    v_lshl_add_u32 v144, v1, 4, s64
    s_cmp_lg_u32 s24, 0
    s_cbranch_scc1 nopoll_85
    s_add_u32 s66, s54, 48
    s_lshl_b32 s66, s66, 8
    v_lshl_add_u32 v145, v1, 2, s66
    s_mov_b32 s68, 0x3fff
    s_mov_b32 s69, 0
    s_waitcnt vmcnt(0)
    s_mov_b32 s70, 400000
    s_mov_b64 exec, s[68:69]
poll_86:
    buffer_load_dword v146, v145, s[48:51], 0 offen sc1
    s_waitcnt vmcnt(0)
    v_subrev_u32 v146, v2, v146
    v_cmp_ne_u32 vcc, 1, v146
    s_cmp_eq_u64 vcc, 0
    s_cbranch_scc1 polled_87
    s_sub_u32 s70, s70, 1
    s_cmp_lg_u32 s70, 0
    s_cbranch_scc1 poll_86
polled_87:
    s_mov_b64 exec, -1
nopoll_85:
    s_barrier
    ds_read_b64 v[84:85], v116 offset:3072
    ds_read_b64 v[86:87], v116 offset:3088
    ds_read_b64 v[88:89], v116 offset:3104
    ds_read_b64 v[90:91], v116 offset:3120
    ds_read_b64 v[92:93], v116 offset:3136
    ds_read_b64 v[94:95], v116 offset:3152
    ds_read_b64 v[96:97], v116 offset:3168
    ds_read_b64 v[98:99], v116 offset:3184
    v_permlane32_swap_b32 v238, v240
    v_permlane32_swap_b32 v239, v241
    v_permlane32_swap_b32 v242, v244
    v_permlane32_swap_b32 v243, v245
    v_permlane32_swap_b32 v246, v248
    v_permlane32_swap_b32 v247, v249
    v_permlane32_swap_b32 v250, v252
    v_permlane32_swap_b32 v251, v253
    s_waitcnt lgkmcnt(0)
    v_lshlrev_b32 v52, 16, v238
    v_and_b32 v53, 0xffff0000, v238
    v_lshlrev_b32 v4, 16, v84
    v_and_b32 v5, 0xffff0000, v84
    v_add_f32 v52, v52, v4
    v_add_f32 v53, v53, v5
    v_lshlrev_b32 v54, 16, v239
    v_and_b32 v55, 0xffff0000, v239
    v_lshlrev_b32 v4, 16, v85
    v_and_b32 v5, 0xffff0000, v85
    v_add_f32 v54, v54, v4
    v_add_f32 v55, v55, v5
    v_lshlrev_b32 v56, 16, v240
    v_and_b32 v57, 0xffff0000, v240
    v_lshlrev_b32 v4, 16, v86
    v_and_b32 v5, 0xffff0000, v86
    v_add_f32 v56, v56, v4
    v_add_f32 v57, v57, v5
    v_lshlrev_b32 v58, 16, v241
    v_and_b32 v59, 0xffff0000, v241
    v_lshlrev_b32 v4, 16, v87
    v_and_b32 v5, 0xffff0000, v87
    v_add_f32 v58, v58, v4
    v_add_f32 v59, v59, v5
    v_lshlrev_b32 v60, 16, v242
    v_and_b32 v61, 0xffff0000, v242
    v_lshlrev_b32 v4, 16, v88
    v_and_b32 v5, 0xffff0000, v88
    v_add_f32 v60, v60, v4
    v_add_f32 v61, v61, v5
    v_lshlrev_b32 v62, 16, v243
    v_and_b32 v63, 0xffff0000, v243
    v_lshlrev_b32 v4, 16, v89
    v_and_b32 v5, 0xffff0000, v89
    v_add_f32 v62, v62, v4
    v_add_f32 v63, v63, v5
    v_lshlrev_b32 v64, 16, v244
    v_and_b32 v65, 0xffff0000, v244
    v_lshlrev_b32 v4, 16, v90
    v_and_b32 v5, 0xffff0000, v90
    v_add_f32 v64, v64, v4
    v_add_f32 v65, v65, v5
    v_lshlrev_b32 v66, 16, v245
    v_and_b32 v67, 0xffff0000, v245
    v_lshlrev_b32 v4, 16, v91
    v_and_b32 v5, 0xffff0000, v91
    v_add_f32 v66, v66, v4
    v_add_f32 v67, v67, v5
    v_lshlrev_b32 v68, 16, v246
    v_and_b32 v69, 0xffff0000, v246
    v_lshlrev_b32 v4, 16, v92
    v_and_b32 v5, 0xffff0000, v92
    v_add_f32 v68, v68, v4
    v_add_f32 v69, v69, v5
    v_lshlrev_b32 v70, 16, v247
    v_and_b32 v71, 0xffff0000, v247
    v_lshlrev_b32 v4, 16, v93
    v_and_b32 v5, 0xffff0000, v93
    v_add_f32 v70, v70, v4
    v_add_f32 v71, v71, v5
    v_lshlrev_b32 v72, 16, v248
    v_and_b32 v73, 0xffff0000, v248
    v_lshlrev_b32 v4, 16, v94
    v_and_b32 v5, 0xffff0000, v94
    v_add_f32 v72, v72, v4
    v_add_f32 v73, v73, v5
    v_lshlrev_b32 v74, 16, v249
    v_and_b32 v75, 0xffff0000, v249
    v_lshlrev_b32 v4, 16, v95
    v_and_b32 v5, 0xffff0000, v95
    v_add_f32 v74, v74, v4
    v_add_f32 v75, v75, v5
    v_lshlrev_b32 v76, 16, v250
    v_and_b32 v77, 0xffff0000, v250
    v_lshlrev_b32 v4, 16, v96
    v_and_b32 v5, 0xffff0000, v96
    v_add_f32 v76, v76, v4
    v_add_f32 v77, v77, v5
    v_lshlrev_b32 v78, 16, v251
    v_and_b32 v79, 0xffff0000, v251
    v_lshlrev_b32 v4, 16, v97
    v_and_b32 v5, 0xffff0000, v97
    v_add_f32 v78, v78, v4
    v_add_f32 v79, v79, v5
    v_lshlrev_b32 v80, 16, v252
    v_and_b32 v81, 0xffff0000, v252
    v_lshlrev_b32 v4, 16, v98
    v_and_b32 v5, 0xffff0000, v98
    v_add_f32 v80, v80, v4
    v_add_f32 v81, v81, v5
    v_lshlrev_b32 v82, 16, v253
    v_and_b32 v83, 0xffff0000, v253
    v_lshlrev_b32 v4, 16, v99
    v_and_b32 v5, 0xffff0000, v99
    v_add_f32 v82, v82, v4
    v_add_f32 v83, v83, v5
    s_barrier
    ds_read_b128 v[16:19], v10 offset:0
    ds_read_b64_tr_b16 v[28:29], v11 offset:0
    ds_read_b64_tr_b16 v[30:31], v11 offset:512
    ds_read_b64_tr_b16 v[32:33], v13 offset:0
    ds_read_b64_tr_b16 v[34:35], v13 offset:512
    ds_read_b128 v[20:23], v10 offset:4096
    ds_read_b64_tr_b16 v[36:37], v11 offset:2048
    ds_read_b64_tr_b16 v[38:39], v11 offset:2560
    ds_read_b64_tr_b16 v[40:41], v13 offset:2048
    ds_read_b64_tr_b16 v[42:43], v13 offset:2560
    s_waitcnt lgkmcnt(5)
    v_mfma_f32_32x32x16_bf16 v[52:67], v[28:31], v[16:19], v[52:67]
    ds_read_b128 v[24:27], v10 offset:8192
    ds_read_b64_tr_b16 v[44:45], v11 offset:4096
    ds_read_b64_tr_b16 v[46:47], v11 offset:4608
    v_mfma_f32_32x32x16_bf16 v[68:83], v[32:35], v[16:19], v[68:83]
    ds_read_b64_tr_b16 v[48:49], v13 offset:4096
    ds_read_b64_tr_b16 v[50:51], v13 offset:4608
    s_waitcnt lgkmcnt(5)
    v_mfma_f32_32x32x16_bf16 v[52:67], v[36:39], v[20:23], v[52:67]
    ds_read_b128 v[16:19], v10 offset:12288
    ds_read_b64_tr_b16 v[28:29], v11 offset:6144
    ds_read_b64_tr_b16 v[30:31], v11 offset:6656
    v_mfma_f32_32x32x16_bf16 v[68:83], v[40:43], v[20:23], v[68:83]
    ds_read_b64_tr_b16 v[32:33], v13 offset:6144
    ds_read_b64_tr_b16 v[34:35], v13 offset:6656
    s_waitcnt lgkmcnt(0)
    s_barrier
    v_mfma_f32_32x32x16_bf16 v[52:67], v[44:47], v[24:27], v[52:67]
    ds_read_b128 v[20:23], v10 offset:16384
    ds_read_b64_tr_b16 v[36:37], v11 offset:8192
    ds_read_b64_tr_b16 v[38:39], v11 offset:8704
    v_mfma_f32_32x32x16_bf16 v[68:83], v[48:51], v[24:27], v[68:83]
    ds_read_b64_tr_b16 v[40:41], v13 offset:8192
    ds_read_b64_tr_b16 v[42:43], v13 offset:8704
    s_waitcnt lgkmcnt(5)
    v_mfma_f32_32x32x16_bf16 v[52:67], v[28:31], v[16:19], v[52:67]
    ds_read_b128 v[24:27], v10 offset:20480
    ds_read_b64_tr_b16 v[44:45], v11 offset:10240
    ds_read_b64_tr_b16 v[46:47], v11 offset:10752
    v_mfma_f32_32x32x16_bf16 v[68:83], v[32:35], v[16:19], v[68:83]
    ds_read_b64_tr_b16 v[48:49], v13 offset:10240
    ds_read_b64_tr_b16 v[50:51], v13 offset:10752
    s_waitcnt lgkmcnt(5)
    v_mfma_f32_32x32x16_bf16 v[52:67], v[36:39], v[20:23], v[52:67]
    ds_read_b128 v[16:19], v10 offset:24576
    ds_read_b64_tr_b16 v[28:29], v11 offset:12288
    ds_read_b64_tr_b16 v[30:31], v11 offset:12800
    v_mfma_f32_32x32x16_bf16 v[68:83], v[40:43], v[20:23], v[68:83]
    ds_read_b64_tr_b16 v[32:33], v13 offset:12288
    ds_read_b64_tr_b16 v[34:35], v13 offset:12800
    s_waitcnt lgkmcnt(5)
    v_mfma_f32_32x32x16_bf16 v[52:67], v[44:47], v[24:27], v[52:67]
    ds_read_b128 v[20:23], v10 offset:28672
    ds_read_b64_tr_b16 v[36:37], v11 offset:14336
    ds_read_b64_tr_b16 v[38:39], v11 offset:14848
    v_mfma_f32_32x32x16_bf16 v[68:83], v[48:51], v[24:27], v[68:83]
    ds_read_b64_tr_b16 v[40:41], v13 offset:14336
    ds_read_b64_tr_b16 v[42:43], v13 offset:14848
    s_waitcnt lgkmcnt(0)
    s_barrier
    v_mfma_f32_32x32x16_bf16 v[52:67], v[28:31], v[16:19], v[52:67]
    ds_read_b128 v[24:27], v10 offset:32768
    ds_read_b64_tr_b16 v[44:45], v11 offset:16384
    ds_read_b64_tr_b16 v[46:47], v11 offset:16896
    v_mfma_f32_32x32x16_bf16 v[68:83], v[32:35], v[16:19], v[68:83]
    ds_read_b64_tr_b16 v[48:49], v13 offset:16384
    ds_read_b64_tr_b16 v[50:51], v13 offset:16896
    s_waitcnt lgkmcnt(5)
    v_mfma_f32_32x32x16_bf16 v[52:67], v[36:39], v[20:23], v[52:67]
    ds_read_b128 v[16:19], v10 offset:36864
    ds_read_b64_tr_b16 v[28:29], v11 offset:18432
    ds_read_b64_tr_b16 v[30:31], v11 offset:18944
    v_mfma_f32_32x32x16_bf16 v[68:83], v[40:43], v[20:23], v[68:83]
    ds_read_b64_tr_b16 v[32:33], v13 offset:18432
    ds_read_b64_tr_b16 v[34:35], v13 offset:18944
    s_waitcnt lgkmcnt(5)
    v_mfma_f32_32x32x16_bf16 v[52:67], v[44:47], v[24:27], v[52:67]
    ds_read_b128 v[20:23], v10 offset:40960
    ds_read_b64_tr_b16 v[36:37], v11 offset:20480
    ds_read_b64_tr_b16 v[38:39], v11 offset:20992
    v_mfma_f32_32x32x16_bf16 v[68:83], v[48:51], v[24:27], v[68:83]
    ds_read_b64_tr_b16 v[40:41], v13 offset:20480
    ds_read_b64_tr_b16 v[42:43], v13 offset:20992
    s_waitcnt lgkmcnt(5)
    v_mfma_f32_32x32x16_bf16 v[52:67], v[28:31], v[16:19], v[52:67]
    ds_read_b128 v[24:27], v10 offset:45056
    ds_read_b64_tr_b16 v[44:45], v11 offset:22528
    ds_read_b64_tr_b16 v[46:47], v11 offset:23040
    v_mfma_f32_32x32x16_bf16 v[68:83], v[32:35], v[16:19], v[68:83]
    ds_read_b64_tr_b16 v[48:49], v13 offset:22528
    ds_read_b64_tr_b16 v[50:51], v13 offset:23040
    s_waitcnt lgkmcnt(0)
    s_barrier
    v_mfma_f32_32x32x16_bf16 v[52:67], v[36:39], v[20:23], v[52:67]
    ds_read_b128 v[16:19], v10 offset:49152
    ds_read_b64_tr_b16 v[28:29], v11 offset:24576
    ds_read_b64_tr_b16 v[30:31], v11 offset:25088
    v_mfma_f32_32x32x16_bf16 v[68:83], v[40:43], v[20:23], v[68:83]
    ds_read_b64_tr_b16 v[32:33], v13 offset:24576
    ds_read_b64_tr_b16 v[34:35], v13 offset:25088
    s_waitcnt lgkmcnt(5)
    v_mfma_f32_32x32x16_bf16 v[52:67], v[44:47], v[24:27], v[52:67]
    ds_read_b128 v[20:23], v10 offset:53248
    ds_read_b64_tr_b16 v[36:37], v11 offset:26624
    ds_read_b64_tr_b16 v[38:39], v11 offset:27136
    v_mfma_f32_32x32x16_bf16 v[68:83], v[48:51], v[24:27], v[68:83]
    ds_read_b64_tr_b16 v[40:41], v13 offset:26624
    ds_read_b64_tr_b16 v[42:43], v13 offset:27136
    s_waitcnt lgkmcnt(5)
    v_mfma_f32_32x32x16_bf16 v[52:67], v[28:31], v[16:19], v[52:67]
    ds_read_b128 v[24:27], v10 offset:57344
    ds_read_b64_tr_b16 v[44:45], v11 offset:28672
    ds_read_b64_tr_b16 v[46:47], v11 offset:29184
    v_mfma_f32_32x32x16_bf16 v[68:83], v[32:35], v[16:19], v[68:83]
    ds_read_b64_tr_b16 v[48:49], v13 offset:28672
    ds_read_b64_tr_b16 v[50:51], v13 offset:29184
    s_waitcnt lgkmcnt(5)
    v_mfma_f32_32x32x16_bf16 v[52:67], v[36:39], v[20:23], v[52:67]
    ds_read_b128 v[16:19], v10 offset:61440
    ds_read_b64_tr_b16 v[28:29], v11 offset:30720
    ds_read_b64_tr_b16 v[30:31], v11 offset:31232
    v_mfma_f32_32x32x16_bf16 v[68:83], v[40:43], v[20:23], v[68:83]
    ds_read_b64_tr_b16 v[32:33], v13 offset:30720
    ds_read_b64_tr_b16 v[34:35], v13 offset:31232
    s_waitcnt lgkmcnt(0)
    s_barrier
    v_mfma_f32_32x32x16_bf16 v[52:67], v[44:47], v[24:27], v[52:67]
    ds_read_b128 v[20:23], v10 offset:0
    ds_read_b64_tr_b16 v[36:37], v11 offset:32768
    ds_read_b64_tr_b16 v[38:39], v11 offset:33280
    v_mfma_f32_32x32x16_bf16 v[68:83], v[48:51], v[24:27], v[68:83]
    ds_read_b64_tr_b16 v[40:41], v13 offset:32768
    ds_read_b64_tr_b16 v[42:43], v13 offset:33280
    s_waitcnt lgkmcnt(5)
    v_mfma_f32_32x32x16_bf16 v[52:67], v[28:31], v[16:19], v[52:67]
    ds_read_b128 v[24:27], v10 offset:4096
    ds_read_b64_tr_b16 v[44:45], v11 offset:34816
    ds_read_b64_tr_b16 v[46:47], v11 offset:35328
    v_mfma_f32_32x32x16_bf16 v[68:83], v[32:35], v[16:19], v[68:83]
    ds_read_b64_tr_b16 v[48:49], v13 offset:34816
    ds_read_b64_tr_b16 v[50:51], v13 offset:35328
    s_waitcnt lgkmcnt(5)
    v_mfma_f32_32x32x16_bf16 v[52:67], v[36:39], v[20:23], v[52:67]
    ds_read_b128 v[16:19], v10 offset:8192
    ds_read_b64_tr_b16 v[28:29], v11 offset:36864
    ds_read_b64_tr_b16 v[30:31], v11 offset:37376
    v_mfma_f32_32x32x16_bf16 v[68:83], v[40:43], v[20:23], v[68:83]
    ds_read_b64_tr_b16 v[32:33], v13 offset:36864
    ds_read_b64_tr_b16 v[34:35], v13 offset:37376
    s_waitcnt lgkmcnt(5)
    v_mfma_f32_32x32x16_bf16 v[52:67], v[44:47], v[24:27], v[52:67]
    ds_read_b128 v[20:23], v10 offset:12288
    ds_read_b64_tr_b16 v[36:37], v11 offset:38912
    ds_read_b64_tr_b16 v[38:39], v11 offset:39424
    v_mfma_f32_32x32x16_bf16 v[68:83], v[48:51], v[24:27], v[68:83]
    ds_read_b64_tr_b16 v[40:41], v13 offset:38912
    ds_read_b64_tr_b16 v[42:43], v13 offset:39424
    s_waitcnt lgkmcnt(0)
    s_barrier
    v_mfma_f32_32x32x16_bf16 v[52:67], v[28:31], v[16:19], v[52:67]
    ds_read_b128 v[24:27], v10 offset:16384
    ds_read_b64_tr_b16 v[44:45], v11 offset:40960
    ds_read_b64_tr_b16 v[46:47], v11 offset:41472
    v_mfma_f32_32x32x16_bf16 v[68:83], v[32:35], v[16:19], v[68:83]
    ds_read_b64_tr_b16 v[48:49], v13 offset:40960
    ds_read_b64_tr_b16 v[50:51], v13 offset:41472
    s_waitcnt lgkmcnt(5)
    v_mfma_f32_32x32x16_bf16 v[52:67], v[36:39], v[20:23], v[52:67]
    ds_read_b128 v[16:19], v10 offset:20480
    ds_read_b64_tr_b16 v[28:29], v11 offset:43008
    ds_read_b64_tr_b16 v[30:31], v11 offset:43520
    v_mfma_f32_32x32x16_bf16 v[68:83], v[40:43], v[20:23], v[68:83]
    ds_read_b64_tr_b16 v[32:33], v13 offset:43008
    ds_read_b64_tr_b16 v[34:35], v13 offset:43520
    s_waitcnt lgkmcnt(5)
    v_mfma_f32_32x32x16_bf16 v[52:67], v[44:47], v[24:27], v[52:67]
    ds_read_b128 v[20:23], v10 offset:24576
    ds_read_b64_tr_b16 v[36:37], v11 offset:45056
    ds_read_b64_tr_b16 v[38:39], v11 offset:45568
    v_mfma_f32_32x32x16_bf16 v[68:83], v[48:51], v[24:27], v[68:83]
    ds_read_b64_tr_b16 v[40:41], v13 offset:45056
    ds_read_b64_tr_b16 v[42:43], v13 offset:45568
    s_waitcnt lgkmcnt(5)
    v_mfma_f32_32x32x16_bf16 v[52:67], v[28:31], v[16:19], v[52:67]
    ds_read_b128 v[24:27], v10 offset:28672
    ds_read_b64_tr_b16 v[44:45], v11 offset:47104
    ds_read_b64_tr_b16 v[46:47], v11 offset:47616
    v_mfma_f32_32x32x16_bf16 v[68:83], v[32:35], v[16:19], v[68:83]
    ds_read_b64_tr_b16 v[48:49], v13 offset:47104
    ds_read_b64_tr_b16 v[50:51], v13 offset:47616
    s_waitcnt lgkmcnt(0)
    s_barrier
    v_mfma_f32_32x32x16_bf16 v[52:67], v[36:39], v[20:23], v[52:67]
    ds_read_b128 v[16:19], v10 offset:32768
    ds_read_b64_tr_b16 v[28:29], v11 offset:49152
    ds_read_b64_tr_b16 v[30:31], v11 offset:49664
    v_mfma_f32_32x32x16_bf16 v[68:83], v[40:43], v[20:23], v[68:83]
    ds_read_b64_tr_b16 v[32:33], v13 offset:49152
    ds_read_b64_tr_b16 v[34:35], v13 offset:49664
    s_waitcnt lgkmcnt(5)
    v_mfma_f32_32x32x16_bf16 v[52:67], v[44:47], v[24:27], v[52:67]
    ds_read_b128 v[20:23], v10 offset:36864
    ds_read_b64_tr_b16 v[36:37], v11 offset:51200
    ds_read_b64_tr_b16 v[38:39], v11 offset:51712
    v_mfma_f32_32x32x16_bf16 v[68:83], v[48:51], v[24:27], v[68:83]
    ds_read_b64_tr_b16 v[40:41], v13 offset:51200
    ds_read_b64_tr_b16 v[42:43], v13 offset:51712
    s_waitcnt lgkmcnt(5)
    v_mfma_f32_32x32x16_bf16 v[52:67], v[28:31], v[16:19], v[52:67]
    ds_read_b128 v[24:27], v10 offset:40960
    ds_read_b64_tr_b16 v[44:45], v11 offset:53248
    ds_read_b64_tr_b16 v[46:47], v11 offset:53760
    v_mfma_f32_32x32x16_bf16 v[68:83], v[32:35], v[16:19], v[68:83]
    ds_read_b64_tr_b16 v[48:49], v13 offset:53248
    ds_read_b64_tr_b16 v[50:51], v13 offset:53760
    s_waitcnt lgkmcnt(5)
    v_mfma_f32_32x32x16_bf16 v[52:67], v[36:39], v[20:23], v[52:67]
    ds_read_b128 v[16:19], v10 offset:45056
    ds_read_b64_tr_b16 v[28:29], v11 offset:55296
    ds_read_b64_tr_b16 v[30:31], v11 offset:55808
    v_mfma_f32_32x32x16_bf16 v[68:83], v[40:43], v[20:23], v[68:83]
    ds_read_b64_tr_b16 v[32:33], v13 offset:55296
    ds_read_b64_tr_b16 v[34:35], v13 offset:55808
    s_waitcnt lgkmcnt(0)
    s_barrier
    v_mfma_f32_32x32x16_bf16 v[52:67], v[44:47], v[24:27], v[52:67]
    ds_read_b128 v[20:23], v10 offset:49152
    ds_read_b64_tr_b16 v[36:37], v11 offset:57344
    ds_read_b64_tr_b16 v[38:39], v11 offset:57856
    v_mfma_f32_32x32x16_bf16 v[68:83], v[48:51], v[24:27], v[68:83]
    ds_read_b64_tr_b16 v[40:41], v13 offset:57344
    ds_read_b64_tr_b16 v[42:43], v13 offset:57856
    s_waitcnt lgkmcnt(5)
    v_mfma_f32_32x32x16_bf16 v[52:67], v[28:31], v[16:19], v[52:67]
    ds_read_b128 v[24:27], v10 offset:53248
    ds_read_b64_tr_b16 v[44:45], v11 offset:59392
    ds_read_b64_tr_b16 v[46:47], v11 offset:59904
    v_mfma_f32_32x32x16_bf16 v[68:83], v[32:35], v[16:19], v[68:83]
    ds_read_b64_tr_b16 v[48:49], v13 offset:59392
    ds_read_b64_tr_b16 v[50:51], v13 offset:59904
    s_waitcnt lgkmcnt(5)
    v_mfma_f32_32x32x16_bf16 v[52:67], v[36:39], v[20:23], v[52:67]
    ds_read_b128 v[16:19], v10 offset:57344
    ds_read_b64_tr_b16 v[28:29], v11 offset:61440
    ds_read_b64_tr_b16 v[30:31], v11 offset:61952
    v_mfma_f32_32x32x16_bf16 v[68:83], v[40:43], v[20:23], v[68:83]
    ds_read_b64_tr_b16 v[32:33], v13 offset:61440
    ds_read_b64_tr_b16 v[34:35], v13 offset:61952
    s_waitcnt lgkmcnt(5)
    v_mfma_f32_32x32x16_bf16 v[52:67], v[44:47], v[24:27], v[52:67]
    ds_read_b128 v[20:23], v10 offset:61440
    ds_read_b64_tr_b16 v[36:37], v11 offset:63488
    ds_read_b64_tr_b16 v[38:39], v11 offset:64000
    v_mfma_f32_32x32x16_bf16 v[68:83], v[48:51], v[24:27], v[68:83]
    ds_read_b64_tr_b16 v[40:41], v13 offset:63488
    ds_read_b64_tr_b16 v[42:43], v13 offset:64000
    s_waitcnt lgkmcnt(0)
    s_barrier
    v_mfma_f32_32x32x16_bf16 v[52:67], v[28:31], v[16:19], v[52:67]
    ds_read_b128 v[24:27], v10 offset:0
    ds_read_b64_tr_b16 v[44:45], v12 offset:0
    ds_read_b64_tr_b16 v[46:47], v12 offset:512
    v_mfma_f32_32x32x16_bf16 v[68:83], v[32:35], v[16:19], v[68:83]
    ds_read_b64_tr_b16 v[48:49], v14 offset:0
    ds_read_b64_tr_b16 v[50:51], v14 offset:512
    s_waitcnt lgkmcnt(5)
    v_mfma_f32_32x32x16_bf16 v[52:67], v[36:39], v[20:23], v[52:67]
    ds_read_b128 v[16:19], v10 offset:4096
    ds_read_b64_tr_b16 v[28:29], v12 offset:2048
    ds_read_b64_tr_b16 v[30:31], v12 offset:2560
    v_mfma_f32_32x32x16_bf16 v[68:83], v[40:43], v[20:23], v[68:83]
    ds_read_b64_tr_b16 v[32:33], v14 offset:2048
    ds_read_b64_tr_b16 v[34:35], v14 offset:2560
    s_waitcnt lgkmcnt(5)
    v_mfma_f32_32x32x16_bf16 v[52:67], v[44:47], v[24:27], v[52:67]
    ds_read_b128 v[20:23], v10 offset:8192
    ds_read_b64_tr_b16 v[36:37], v12 offset:4096
    ds_read_b64_tr_b16 v[38:39], v12 offset:4608
    v_mfma_f32_32x32x16_bf16 v[68:83], v[48:51], v[24:27], v[68:83]
    ds_read_b64_tr_b16 v[40:41], v14 offset:4096
    ds_read_b64_tr_b16 v[42:43], v14 offset:4608
    s_waitcnt lgkmcnt(5)
    v_mfma_f32_32x32x16_bf16 v[52:67], v[28:31], v[16:19], v[52:67]
    ds_read_b128 v[24:27], v10 offset:12288
    ds_read_b64_tr_b16 v[44:45], v12 offset:6144
    ds_read_b64_tr_b16 v[46:47], v12 offset:6656
    v_mfma_f32_32x32x16_bf16 v[68:83], v[32:35], v[16:19], v[68:83]
    ds_read_b64_tr_b16 v[48:49], v14 offset:6144
    ds_read_b64_tr_b16 v[50:51], v14 offset:6656
    s_waitcnt lgkmcnt(0)
    s_barrier
    v_mfma_f32_32x32x16_bf16 v[52:67], v[36:39], v[20:23], v[52:67]
    ds_read_b128 v[16:19], v10 offset:16384
    ds_read_b64_tr_b16 v[28:29], v12 offset:8192
    ds_read_b64_tr_b16 v[30:31], v12 offset:8704
    v_mfma_f32_32x32x16_bf16 v[68:83], v[40:43], v[20:23], v[68:83]
    ds_read_b64_tr_b16 v[32:33], v14 offset:8192
    ds_read_b64_tr_b16 v[34:35], v14 offset:8704
    s_waitcnt lgkmcnt(5)
    v_mfma_f32_32x32x16_bf16 v[52:67], v[44:47], v[24:27], v[52:67]
    ds_read_b128 v[20:23], v10 offset:20480
    ds_read_b64_tr_b16 v[36:37], v12 offset:10240
    ds_read_b64_tr_b16 v[38:39], v12 offset:10752
    v_mfma_f32_32x32x16_bf16 v[68:83], v[48:51], v[24:27], v[68:83]
    ds_read_b64_tr_b16 v[40:41], v14 offset:10240
    ds_read_b64_tr_b16 v[42:43], v14 offset:10752
    s_waitcnt lgkmcnt(5)
    v_mfma_f32_32x32x16_bf16 v[52:67], v[28:31], v[16:19], v[52:67]
    ds_read_b128 v[24:27], v10 offset:24576
    ds_read_b64_tr_b16 v[44:45], v12 offset:12288
    ds_read_b64_tr_b16 v[46:47], v12 offset:12800
    v_mfma_f32_32x32x16_bf16 v[68:83], v[32:35], v[16:19], v[68:83]
    ds_read_b64_tr_b16 v[48:49], v14 offset:12288
    ds_read_b64_tr_b16 v[50:51], v14 offset:12800
    s_waitcnt lgkmcnt(5)
    v_mfma_f32_32x32x16_bf16 v[52:67], v[36:39], v[20:23], v[52:67]
    ds_read_b128 v[16:19], v10 offset:28672
    ds_read_b64_tr_b16 v[28:29], v12 offset:14336
    ds_read_b64_tr_b16 v[30:31], v12 offset:14848
    v_mfma_f32_32x32x16_bf16 v[68:83], v[40:43], v[20:23], v[68:83]
    ds_read_b64_tr_b16 v[32:33], v14 offset:14336
    ds_read_b64_tr_b16 v[34:35], v14 offset:14848
    s_waitcnt lgkmcnt(0)
    s_barrier
    v_mfma_f32_32x32x16_bf16 v[52:67], v[44:47], v[24:27], v[52:67]
    ds_read_b128 v[20:23], v10 offset:32768
    ds_read_b64_tr_b16 v[36:37], v11 offset:0
    ds_read_b64_tr_b16 v[38:39], v11 offset:512
    v_mfma_f32_32x32x16_bf16 v[68:83], v[48:51], v[24:27], v[68:83]
    ds_read_b64_tr_b16 v[40:41], v13 offset:0
    ds_read_b64_tr_b16 v[42:43], v13 offset:512
    s_waitcnt lgkmcnt(5)
    v_mfma_f32_32x32x16_bf16 v[52:67], v[28:31], v[16:19], v[52:67]
    ds_read_b128 v[24:27], v10 offset:36864
    ds_read_b64_tr_b16 v[44:45], v11 offset:2048
    ds_read_b64_tr_b16 v[46:47], v11 offset:2560
    v_mfma_f32_32x32x16_bf16 v[68:83], v[32:35], v[16:19], v[68:83]
    ds_read_b64_tr_b16 v[48:49], v13 offset:2048
    ds_read_b64_tr_b16 v[50:51], v13 offset:2560
    s_waitcnt lgkmcnt(5)
    v_mfma_f32_32x32x16_bf16 v[52:67], v[36:39], v[20:23], v[52:67]
    ds_read_b128 v[16:19], v10 offset:40960
    ds_read_b64_tr_b16 v[28:29], v11 offset:4096
    ds_read_b64_tr_b16 v[30:31], v11 offset:4608
    v_mfma_f32_32x32x16_bf16 v[68:83], v[40:43], v[20:23], v[68:83]
    ds_read_b64_tr_b16 v[32:33], v13 offset:4096
    ds_read_b64_tr_b16 v[34:35], v13 offset:4608
    s_waitcnt lgkmcnt(5)
    v_mfma_f32_32x32x16_bf16 v[52:67], v[44:47], v[24:27], v[52:67]
    ds_read_b128 v[20:23], v10 offset:45056
    ds_read_b64_tr_b16 v[36:37], v11 offset:6144
    ds_read_b64_tr_b16 v[38:39], v11 offset:6656
    v_mfma_f32_32x32x16_bf16 v[68:83], v[48:51], v[24:27], v[68:83]
    ds_read_b64_tr_b16 v[40:41], v13 offset:6144
    ds_read_b64_tr_b16 v[42:43], v13 offset:6656
    s_waitcnt lgkmcnt(0)
    s_barrier
    v_mfma_f32_32x32x16_bf16 v[52:67], v[28:31], v[16:19], v[52:67]
    ds_read_b128 v[24:27], v10 offset:49152
    ds_read_b64_tr_b16 v[44:45], v11 offset:8192
    ds_read_b64_tr_b16 v[46:47], v11 offset:8704
    v_mfma_f32_32x32x16_bf16 v[68:83], v[32:35], v[16:19], v[68:83]
    ds_read_b64_tr_b16 v[48:49], v13 offset:8192
    ds_read_b64_tr_b16 v[50:51], v13 offset:8704
    s_waitcnt lgkmcnt(5)
    v_mfma_f32_32x32x16_bf16 v[52:67], v[36:39], v[20:23], v[52:67]
    ds_read_b128 v[16:19], v10 offset:53248
    ds_read_b64_tr_b16 v[28:29], v11 offset:10240
    ds_read_b64_tr_b16 v[30:31], v11 offset:10752
    v_mfma_f32_32x32x16_bf16 v[68:83], v[40:43], v[20:23], v[68:83]
    ds_read_b64_tr_b16 v[32:33], v13 offset:10240
    ds_read_b64_tr_b16 v[34:35], v13 offset:10752
    s_waitcnt lgkmcnt(5)
    v_mfma_f32_32x32x16_bf16 v[52:67], v[44:47], v[24:27], v[52:67]
    ds_read_b128 v[20:23], v10 offset:57344
    ds_read_b64_tr_b16 v[36:37], v11 offset:12288
    ds_read_b64_tr_b16 v[38:39], v11 offset:12800
    v_mfma_f32_32x32x16_bf16 v[68:83], v[48:51], v[24:27], v[68:83]
    ds_read_b64_tr_b16 v[40:41], v13 offset:12288
    ds_read_b64_tr_b16 v[42:43], v13 offset:12800
    s_waitcnt lgkmcnt(5)
    v_mfma_f32_32x32x16_bf16 v[52:67], v[28:31], v[16:19], v[52:67]
    ds_read_b128 v[24:27], v10 offset:61440
    ds_read_b64_tr_b16 v[44:45], v11 offset:14336
    ds_read_b64_tr_b16 v[46:47], v11 offset:14848
    v_mfma_f32_32x32x16_bf16 v[68:83], v[32:35], v[16:19], v[68:83]
    ds_read_b64_tr_b16 v[48:49], v13 offset:14336
    ds_read_b64_tr_b16 v[50:51], v13 offset:14848
    s_waitcnt lgkmcnt(0)
    s_barrier
    v_mfma_f32_32x32x16_bf16 v[52:67], v[36:39], v[20:23], v[52:67]
    ds_read_b128 v[16:19], v10 offset:0
    ds_read_b64_tr_b16 v[28:29], v11 offset:16384
    ds_read_b64_tr_b16 v[30:31], v11 offset:16896
    v_mfma_f32_32x32x16_bf16 v[68:83], v[40:43], v[20:23], v[68:83]
    ds_read_b64_tr_b16 v[32:33], v13 offset:16384
    ds_read_b64_tr_b16 v[34:35], v13 offset:16896
    s_waitcnt lgkmcnt(5)
    v_mfma_f32_32x32x16_bf16 v[52:67], v[44:47], v[24:27], v[52:67]
    ds_read_b128 v[20:23], v10 offset:4096
    ds_read_b64_tr_b16 v[36:37], v11 offset:18432
    ds_read_b64_tr_b16 v[38:39], v11 offset:18944
    v_mfma_f32_32x32x16_bf16 v[68:83], v[48:51], v[24:27], v[68:83]
    ds_read_b64_tr_b16 v[40:41], v13 offset:18432
    ds_read_b64_tr_b16 v[42:43], v13 offset:18944
    s_waitcnt lgkmcnt(5)
    v_mfma_f32_32x32x16_bf16 v[52:67], v[28:31], v[16:19], v[52:67]
    ds_read_b128 v[24:27], v10 offset:8192
    ds_read_b64_tr_b16 v[44:45], v11 offset:20480
    ds_read_b64_tr_b16 v[46:47], v11 offset:20992
    v_mfma_f32_32x32x16_bf16 v[68:83], v[32:35], v[16:19], v[68:83]
    ds_read_b64_tr_b16 v[48:49], v13 offset:20480
    ds_read_b64_tr_b16 v[50:51], v13 offset:20992
    s_waitcnt lgkmcnt(5)
    v_mfma_f32_32x32x16_bf16 v[52:67], v[36:39], v[20:23], v[52:67]
    ds_read_b128 v[16:19], v10 offset:12288
    ds_read_b64_tr_b16 v[28:29], v11 offset:22528
    ds_read_b64_tr_b16 v[30:31], v11 offset:23040
    v_mfma_f32_32x32x16_bf16 v[68:83], v[40:43], v[20:23], v[68:83]
    ds_read_b64_tr_b16 v[32:33], v13 offset:22528
    ds_read_b64_tr_b16 v[34:35], v13 offset:23040
    s_waitcnt lgkmcnt(0)
    s_barrier
    v_mfma_f32_32x32x16_bf16 v[52:67], v[44:47], v[24:27], v[52:67]
    ds_read_b128 v[20:23], v10 offset:16384
    ds_read_b64_tr_b16 v[36:37], v11 offset:24576
    ds_read_b64_tr_b16 v[38:39], v11 offset:25088
    v_mfma_f32_32x32x16_bf16 v[68:83], v[48:51], v[24:27], v[68:83]
    ds_read_b64_tr_b16 v[40:41], v13 offset:24576
    ds_read_b64_tr_b16 v[42:43], v13 offset:25088
    s_waitcnt lgkmcnt(5)
    v_mfma_f32_32x32x16_bf16 v[52:67], v[28:31], v[16:19], v[52:67]
    ds_read_b128 v[24:27], v10 offset:20480
    ds_read_b64_tr_b16 v[44:45], v11 offset:26624
    ds_read_b64_tr_b16 v[46:47], v11 offset:27136
    v_mfma_f32_32x32x16_bf16 v[68:83], v[32:35], v[16:19], v[68:83]
    ds_read_b64_tr_b16 v[48:49], v13 offset:26624
    ds_read_b64_tr_b16 v[50:51], v13 offset:27136
    s_waitcnt lgkmcnt(5)
    v_mfma_f32_32x32x16_bf16 v[52:67], v[36:39], v[20:23], v[52:67]
    ds_read_b128 v[16:19], v10 offset:24576
    ds_read_b64_tr_b16 v[28:29], v11 offset:28672
    ds_read_b64_tr_b16 v[30:31], v11 offset:29184
    v_mfma_f32_32x32x16_bf16 v[68:83], v[40:43], v[20:23], v[68:83]
    ds_read_b64_tr_b16 v[32:33], v13 offset:28672
    ds_read_b64_tr_b16 v[34:35], v13 offset:29184
    s_waitcnt lgkmcnt(5)
    v_mfma_f32_32x32x16_bf16 v[52:67], v[44:47], v[24:27], v[52:67]
    ds_read_b128 v[20:23], v10 offset:28672
    ds_read_b64_tr_b16 v[36:37], v11 offset:30720
    ds_read_b64_tr_b16 v[38:39], v11 offset:31232
    v_mfma_f32_32x32x16_bf16 v[68:83], v[48:51], v[24:27], v[68:83]
    ds_read_b64_tr_b16 v[40:41], v13 offset:30720
    ds_read_b64_tr_b16 v[42:43], v13 offset:31232
    s_waitcnt lgkmcnt(0)
    s_barrier
    v_mfma_f32_32x32x16_bf16 v[52:67], v[28:31], v[16:19], v[52:67]
    ds_read_b128 v[24:27], v10 offset:32768
    ds_read_b64_tr_b16 v[44:45], v11 offset:32768
    ds_read_b64_tr_b16 v[46:47], v11 offset:33280
    v_mfma_f32_32x32x16_bf16 v[68:83], v[32:35], v[16:19], v[68:83]
    ds_read_b64_tr_b16 v[48:49], v13 offset:32768
    ds_read_b64_tr_b16 v[50:51], v13 offset:33280
    s_waitcnt lgkmcnt(5)
    v_mfma_f32_32x32x16_bf16 v[52:67], v[36:39], v[20:23], v[52:67]
    ds_read_b128 v[16:19], v10 offset:36864
    ds_read_b64_tr_b16 v[28:29], v11 offset:34816
    ds_read_b64_tr_b16 v[30:31], v11 offset:35328
    v_mfma_f32_32x32x16_bf16 v[68:83], v[40:43], v[20:23], v[68:83]
    ds_read_b64_tr_b16 v[32:33], v13 offset:34816
    ds_read_b64_tr_b16 v[34:35], v13 offset:35328
    s_waitcnt lgkmcnt(5)
    v_mfma_f32_32x32x16_bf16 v[52:67], v[44:47], v[24:27], v[52:67]
    ds_read_b128 v[20:23], v10 offset:40960
    ds_read_b64_tr_b16 v[36:37], v11 offset:36864
    ds_read_b64_tr_b16 v[38:39], v11 offset:37376
    v_mfma_f32_32x32x16_bf16 v[68:83], v[48:51], v[24:27], v[68:83]
    ds_read_b64_tr_b16 v[40:41], v13 offset:36864
    ds_read_b64_tr_b16 v[42:43], v13 offset:37376
    s_waitcnt lgkmcnt(5)
    v_mfma_f32_32x32x16_bf16 v[52:67], v[28:31], v[16:19], v[52:67]
    ds_read_b128 v[24:27], v10 offset:45056
    ds_read_b64_tr_b16 v[44:45], v11 offset:38912
    ds_read_b64_tr_b16 v[46:47], v11 offset:39424
    v_mfma_f32_32x32x16_bf16 v[68:83], v[32:35], v[16:19], v[68:83]
    ds_read_b64_tr_b16 v[48:49], v13 offset:38912
    ds_read_b64_tr_b16 v[50:51], v13 offset:39424
    s_waitcnt lgkmcnt(0)
    s_barrier
    v_mfma_f32_32x32x16_bf16 v[52:67], v[36:39], v[20:23], v[52:67]
    ds_read_b128 v[16:19], v10 offset:49152
    ds_read_b64_tr_b16 v[28:29], v11 offset:40960
    ds_read_b64_tr_b16 v[30:31], v11 offset:41472
    v_mfma_f32_32x32x16_bf16 v[68:83], v[40:43], v[20:23], v[68:83]
    ds_read_b64_tr_b16 v[32:33], v13 offset:40960
    ds_read_b64_tr_b16 v[34:35], v13 offset:41472
    s_waitcnt lgkmcnt(5)
    v_mfma_f32_32x32x16_bf16 v[52:67], v[44:47], v[24:27], v[52:67]
    ds_read_b128 v[20:23], v10 offset:53248
    ds_read_b64_tr_b16 v[36:37], v11 offset:43008
    ds_read_b64_tr_b16 v[38:39], v11 offset:43520
    v_mfma_f32_32x32x16_bf16 v[68:83], v[48:51], v[24:27], v[68:83]
    ds_read_b64_tr_b16 v[40:41], v13 offset:43008
    ds_read_b64_tr_b16 v[42:43], v13 offset:43520
    s_waitcnt lgkmcnt(5)
    v_mfma_f32_32x32x16_bf16 v[52:67], v[28:31], v[16:19], v[52:67]
    ds_read_b128 v[24:27], v10 offset:57344
    ds_read_b64_tr_b16 v[44:45], v11 offset:45056
    ds_read_b64_tr_b16 v[46:47], v11 offset:45568
    v_mfma_f32_32x32x16_bf16 v[68:83], v[32:35], v[16:19], v[68:83]
    ds_read_b64_tr_b16 v[48:49], v13 offset:45056
    ds_read_b64_tr_b16 v[50:51], v13 offset:45568
    s_waitcnt lgkmcnt(5)
    v_mfma_f32_32x32x16_bf16 v[52:67], v[36:39], v[20:23], v[52:67]
    ds_read_b128 v[16:19], v10 offset:61440
    ds_read_b64_tr_b16 v[28:29], v11 offset:47104
    ds_read_b64_tr_b16 v[30:31], v11 offset:47616
    v_mfma_f32_32x32x16_bf16 v[68:83], v[40:43], v[20:23], v[68:83]
    ds_read_b64_tr_b16 v[32:33], v13 offset:47104
    ds_read_b64_tr_b16 v[34:35], v13 offset:47616
    s_waitcnt lgkmcnt(0)
    s_barrier
    v_mfma_f32_32x32x16_bf16 v[52:67], v[44:47], v[24:27], v[52:67]
    ds_read_b128 v[20:23], v10 offset:0
    ds_read_b64_tr_b16 v[36:37], v11 offset:49152
    ds_read_b64_tr_b16 v[38:39], v11 offset:49664
    v_mfma_f32_32x32x16_bf16 v[68:83], v[48:51], v[24:27], v[68:83]
    ds_read_b64_tr_b16 v[40:41], v13 offset:49152
    ds_read_b64_tr_b16 v[42:43], v13 offset:49664
    s_waitcnt lgkmcnt(5)
    v_mfma_f32_32x32x16_bf16 v[52:67], v[28:31], v[16:19], v[52:67]
    ds_read_b128 v[24:27], v10 offset:4096
    ds_read_b64_tr_b16 v[44:45], v11 offset:51200
    ds_read_b64_tr_b16 v[46:47], v11 offset:51712
    v_mfma_f32_32x32x16_bf16 v[68:83], v[32:35], v[16:19], v[68:83]
    ds_read_b64_tr_b16 v[48:49], v13 offset:51200
    ds_read_b64_tr_b16 v[50:51], v13 offset:51712
    s_waitcnt lgkmcnt(5)
    v_mfma_f32_32x32x16_bf16 v[52:67], v[36:39], v[20:23], v[52:67]
    ds_read_b128 v[16:19], v10 offset:8192
    ds_read_b64_tr_b16 v[28:29], v11 offset:53248
    ds_read_b64_tr_b16 v[30:31], v11 offset:53760
    v_mfma_f32_32x32x16_bf16 v[68:83], v[40:43], v[20:23], v[68:83]
    ds_read_b64_tr_b16 v[32:33], v13 offset:53248
    ds_read_b64_tr_b16 v[34:35], v13 offset:53760
    s_waitcnt lgkmcnt(5)
    v_mfma_f32_32x32x16_bf16 v[52:67], v[44:47], v[24:27], v[52:67]
    ds_read_b128 v[20:23], v10 offset:12288
    ds_read_b64_tr_b16 v[36:37], v11 offset:55296
    ds_read_b64_tr_b16 v[38:39], v11 offset:55808
    v_mfma_f32_32x32x16_bf16 v[68:83], v[48:51], v[24:27], v[68:83]
    ds_read_b64_tr_b16 v[40:41], v13 offset:55296
    ds_read_b64_tr_b16 v[42:43], v13 offset:55808
    s_waitcnt lgkmcnt(0)
    s_barrier
    v_mfma_f32_32x32x16_bf16 v[52:67], v[28:31], v[16:19], v[52:67]
    ds_read_b128 v[24:27], v10 offset:16384
    ds_read_b64_tr_b16 v[44:45], v11 offset:57344
    ds_read_b64_tr_b16 v[46:47], v11 offset:57856
    v_mfma_f32_32x32x16_bf16 v[68:83], v[32:35], v[16:19], v[68:83]
    ds_read_b64_tr_b16 v[48:49], v13 offset:57344
    ds_read_b64_tr_b16 v[50:51], v13 offset:57856
    s_waitcnt lgkmcnt(5)
    v_mfma_f32_32x32x16_bf16 v[52:67], v[36:39], v[20:23], v[52:67]
    ds_read_b128 v[16:19], v10 offset:20480
    ds_read_b64_tr_b16 v[28:29], v11 offset:59392
    ds_read_b64_tr_b16 v[30:31], v11 offset:59904
    v_mfma_f32_32x32x16_bf16 v[68:83], v[40:43], v[20:23], v[68:83]
    ds_read_b64_tr_b16 v[32:33], v13 offset:59392
    ds_read_b64_tr_b16 v[34:35], v13 offset:59904
    s_waitcnt lgkmcnt(5)
    v_mfma_f32_32x32x16_bf16 v[52:67], v[44:47], v[24:27], v[52:67]
    ds_read_b128 v[20:23], v10 offset:24576
    ds_read_b64_tr_b16 v[36:37], v11 offset:61440
    ds_read_b64_tr_b16 v[38:39], v11 offset:61952
    v_mfma_f32_32x32x16_bf16 v[68:83], v[48:51], v[24:27], v[68:83]
    ds_read_b64_tr_b16 v[40:41], v13 offset:61440
    ds_read_b64_tr_b16 v[42:43], v13 offset:61952
    s_waitcnt lgkmcnt(5)
    v_mfma_f32_32x32x16_bf16 v[52:67], v[28:31], v[16:19], v[52:67]
    ds_read_b128 v[24:27], v10 offset:28672
    ds_read_b64_tr_b16 v[44:45], v11 offset:63488
    ds_read_b64_tr_b16 v[46:47], v11 offset:64000
    v_mfma_f32_32x32x16_bf16 v[68:83], v[32:35], v[16:19], v[68:83]
    ds_read_b64_tr_b16 v[48:49], v13 offset:63488
    ds_read_b64_tr_b16 v[50:51], v13 offset:64000
    s_waitcnt lgkmcnt(0)
    s_barrier
    v_mfma_f32_32x32x16_bf16 v[52:67], v[36:39], v[20:23], v[52:67]
    ds_read_b128 v[16:19], v10 offset:32768
    ds_read_b64_tr_b16 v[28:29], v12 offset:0
    ds_read_b64_tr_b16 v[30:31], v12 offset:512
    v_mfma_f32_32x32x16_bf16 v[68:83], v[40:43], v[20:23], v[68:83]
    ds_read_b64_tr_b16 v[32:33], v14 offset:0
    ds_read_b64_tr_b16 v[34:35], v14 offset:512
    s_waitcnt lgkmcnt(5)
    v_mfma_f32_32x32x16_bf16 v[52:67], v[44:47], v[24:27], v[52:67]
    ds_read_b128 v[20:23], v10 offset:36864
    ds_read_b64_tr_b16 v[36:37], v12 offset:2048
    ds_read_b64_tr_b16 v[38:39], v12 offset:2560
    v_mfma_f32_32x32x16_bf16 v[68:83], v[48:51], v[24:27], v[68:83]
    ds_read_b64_tr_b16 v[40:41], v14 offset:2048
    ds_read_b64_tr_b16 v[42:43], v14 offset:2560
    s_waitcnt lgkmcnt(5)
    v_mfma_f32_32x32x16_bf16 v[52:67], v[28:31], v[16:19], v[52:67]
    ds_read_b128 v[24:27], v10 offset:40960
    ds_read_b64_tr_b16 v[44:45], v12 offset:4096
    ds_read_b64_tr_b16 v[46:47], v12 offset:4608
    v_mfma_f32_32x32x16_bf16 v[68:83], v[32:35], v[16:19], v[68:83]
    ds_read_b64_tr_b16 v[48:49], v14 offset:4096
    ds_read_b64_tr_b16 v[50:51], v14 offset:4608
    s_waitcnt lgkmcnt(5)
    v_mfma_f32_32x32x16_bf16 v[52:67], v[36:39], v[20:23], v[52:67]
    ds_read_b128 v[16:19], v10 offset:45056
    ds_read_b64_tr_b16 v[28:29], v12 offset:6144
    ds_read_b64_tr_b16 v[30:31], v12 offset:6656
    v_mfma_f32_32x32x16_bf16 v[68:83], v[40:43], v[20:23], v[68:83]
    ds_read_b64_tr_b16 v[32:33], v14 offset:6144
    ds_read_b64_tr_b16 v[34:35], v14 offset:6656
    s_waitcnt lgkmcnt(0)
    s_barrier
    v_mfma_f32_32x32x16_bf16 v[52:67], v[44:47], v[24:27], v[52:67]
    ds_read_b128 v[20:23], v10 offset:49152
    ds_read_b64_tr_b16 v[36:37], v12 offset:8192
    ds_read_b64_tr_b16 v[38:39], v12 offset:8704
    v_mfma_f32_32x32x16_bf16 v[68:83], v[48:51], v[24:27], v[68:83]
    ds_read_b64_tr_b16 v[40:41], v14 offset:8192
    ds_read_b64_tr_b16 v[42:43], v14 offset:8704
    s_waitcnt lgkmcnt(5)
    v_mfma_f32_32x32x16_bf16 v[52:67], v[28:31], v[16:19], v[52:67]
    ds_read_b128 v[24:27], v10 offset:53248
    ds_read_b64_tr_b16 v[44:45], v12 offset:10240
    ds_read_b64_tr_b16 v[46:47], v12 offset:10752
    v_mfma_f32_32x32x16_bf16 v[68:83], v[32:35], v[16:19], v[68:83]
    ds_read_b64_tr_b16 v[48:49], v14 offset:10240
    ds_read_b64_tr_b16 v[50:51], v14 offset:10752
    s_waitcnt lgkmcnt(5)
    v_mfma_f32_32x32x16_bf16 v[52:67], v[36:39], v[20:23], v[52:67]
    ds_read_b128 v[16:19], v10 offset:57344
    ds_read_b64_tr_b16 v[28:29], v12 offset:12288
    ds_read_b64_tr_b16 v[30:31], v12 offset:12800
    v_mfma_f32_32x32x16_bf16 v[68:83], v[40:43], v[20:23], v[68:83]
    ds_read_b64_tr_b16 v[32:33], v14 offset:12288
    ds_read_b64_tr_b16 v[34:35], v14 offset:12800
    s_waitcnt lgkmcnt(5)
    v_mfma_f32_32x32x16_bf16 v[52:67], v[44:47], v[24:27], v[52:67]
    ds_read_b128 v[20:23], v10 offset:61440
    ds_read_b64_tr_b16 v[36:37], v12 offset:14336
    ds_read_b64_tr_b16 v[38:39], v12 offset:14848
    v_mfma_f32_32x32x16_bf16 v[68:83], v[48:51], v[24:27], v[68:83]
    ds_read_b64_tr_b16 v[40:41], v14 offset:14336
    ds_read_b64_tr_b16 v[42:43], v14 offset:14848
    s_waitcnt lgkmcnt(0)
    s_barrier
    v_mfma_f32_32x32x16_bf16 v[52:67], v[28:31], v[16:19], v[52:67]
    ds_read_b128 v[24:27], v10 offset:0
    ds_read_b64_tr_b16 v[44:45], v11 offset:0
    ds_read_b64_tr_b16 v[46:47], v11 offset:512
    v_mfma_f32_32x32x16_bf16 v[68:83], v[32:35], v[16:19], v[68:83]
    ds_read_b64_tr_b16 v[48:49], v13 offset:0
    ds_read_b64_tr_b16 v[50:51], v13 offset:512
    s_waitcnt lgkmcnt(5)
    v_mfma_f32_32x32x16_bf16 v[52:67], v[36:39], v[20:23], v[52:67]
    ds_read_b128 v[16:19], v10 offset:4096
    ds_read_b64_tr_b16 v[28:29], v11 offset:2048
    ds_read_b64_tr_b16 v[30:31], v11 offset:2560
    v_mfma_f32_32x32x16_bf16 v[68:83], v[40:43], v[20:23], v[68:83]
    ds_read_b64_tr_b16 v[32:33], v13 offset:2048
    ds_read_b64_tr_b16 v[34:35], v13 offset:2560
    s_waitcnt lgkmcnt(5)
    v_mfma_f32_32x32x16_bf16 v[52:67], v[44:47], v[24:27], v[52:67]
    ds_read_b128 v[20:23], v10 offset:8192
    ds_read_b64_tr_b16 v[36:37], v11 offset:4096
    ds_read_b64_tr_b16 v[38:39], v11 offset:4608
    v_mfma_f32_32x32x16_bf16 v[68:83], v[48:51], v[24:27], v[68:83]
    ds_read_b64_tr_b16 v[40:41], v13 offset:4096
    ds_read_b64_tr_b16 v[42:43], v13 offset:4608
    s_waitcnt lgkmcnt(5)
    v_mfma_f32_32x32x16_bf16 v[52:67], v[28:31], v[16:19], v[52:67]
    ds_read_b128 v[24:27], v10 offset:12288
    ds_read_b64_tr_b16 v[44:45], v11 offset:6144
    ds_read_b64_tr_b16 v[46:47], v11 offset:6656
    v_mfma_f32_32x32x16_bf16 v[68:83], v[32:35], v[16:19], v[68:83]
    ds_read_b64_tr_b16 v[48:49], v13 offset:6144
    ds_read_b64_tr_b16 v[50:51], v13 offset:6656
    s_waitcnt lgkmcnt(0)
    s_barrier
    v_mfma_f32_32x32x16_bf16 v[52:67], v[36:39], v[20:23], v[52:67]
    ds_read_b128 v[16:19], v10 offset:16384
    ds_read_b64_tr_b16 v[28:29], v11 offset:8192
    ds_read_b64_tr_b16 v[30:31], v11 offset:8704
    v_mfma_f32_32x32x16_bf16 v[68:83], v[40:43], v[20:23], v[68:83]
    ds_read_b64_tr_b16 v[32:33], v13 offset:8192
    ds_read_b64_tr_b16 v[34:35], v13 offset:8704
    s_waitcnt lgkmcnt(5)
    v_mfma_f32_32x32x16_bf16 v[52:67], v[44:47], v[24:27], v[52:67]
    ds_read_b128 v[20:23], v10 offset:20480
    ds_read_b64_tr_b16 v[36:37], v11 offset:10240
    ds_read_b64_tr_b16 v[38:39], v11 offset:10752
    v_mfma_f32_32x32x16_bf16 v[68:83], v[48:51], v[24:27], v[68:83]
    ds_read_b64_tr_b16 v[40:41], v13 offset:10240
    ds_read_b64_tr_b16 v[42:43], v13 offset:10752
    s_waitcnt lgkmcnt(5)
    v_mfma_f32_32x32x16_bf16 v[52:67], v[28:31], v[16:19], v[52:67]
    ds_read_b128 v[24:27], v10 offset:24576
    ds_read_b64_tr_b16 v[44:45], v11 offset:12288
    ds_read_b64_tr_b16 v[46:47], v11 offset:12800
    v_mfma_f32_32x32x16_bf16 v[68:83], v[32:35], v[16:19], v[68:83]
    ds_read_b64_tr_b16 v[48:49], v13 offset:12288
    ds_read_b64_tr_b16 v[50:51], v13 offset:12800
    s_waitcnt lgkmcnt(5)
    v_mfma_f32_32x32x16_bf16 v[52:67], v[36:39], v[20:23], v[52:67]
    ds_read_b128 v[16:19], v10 offset:28672
    ds_read_b64_tr_b16 v[28:29], v11 offset:14336
    ds_read_b64_tr_b16 v[30:31], v11 offset:14848
    v_mfma_f32_32x32x16_bf16 v[68:83], v[40:43], v[20:23], v[68:83]
    ds_read_b64_tr_b16 v[32:33], v13 offset:14336
    ds_read_b64_tr_b16 v[34:35], v13 offset:14848
    s_waitcnt lgkmcnt(0)
    s_barrier
    v_mfma_f32_32x32x16_bf16 v[52:67], v[44:47], v[24:27], v[52:67]
    ds_read_b128 v[20:23], v10 offset:32768
    ds_read_b64_tr_b16 v[36:37], v11 offset:16384
    ds_read_b64_tr_b16 v[38:39], v11 offset:16896
    v_mfma_f32_32x32x16_bf16 v[68:83], v[48:51], v[24:27], v[68:83]
    ds_read_b64_tr_b16 v[40:41], v13 offset:16384
    ds_read_b64_tr_b16 v[42:43], v13 offset:16896
    s_waitcnt lgkmcnt(5)
    v_mfma_f32_32x32x16_bf16 v[52:67], v[28:31], v[16:19], v[52:67]
    ds_read_b128 v[24:27], v10 offset:36864
    ds_read_b64_tr_b16 v[44:45], v11 offset:18432
    ds_read_b64_tr_b16 v[46:47], v11 offset:18944
    v_mfma_f32_32x32x16_bf16 v[68:83], v[32:35], v[16:19], v[68:83]
    ds_read_b64_tr_b16 v[48:49], v13 offset:18432
    ds_read_b64_tr_b16 v[50:51], v13 offset:18944
    s_waitcnt lgkmcnt(5)
    v_mfma_f32_32x32x16_bf16 v[52:67], v[36:39], v[20:23], v[52:67]
    ds_read_b128 v[16:19], v10 offset:40960
    ds_read_b64_tr_b16 v[28:29], v11 offset:20480
    ds_read_b64_tr_b16 v[30:31], v11 offset:20992
    v_mfma_f32_32x32x16_bf16 v[68:83], v[40:43], v[20:23], v[68:83]
    ds_read_b64_tr_b16 v[32:33], v13 offset:20480
    ds_read_b64_tr_b16 v[34:35], v13 offset:20992
    s_waitcnt lgkmcnt(5)
    v_mfma_f32_32x32x16_bf16 v[52:67], v[44:47], v[24:27], v[52:67]
    ds_read_b128 v[20:23], v10 offset:45056
    ds_read_b64_tr_b16 v[36:37], v11 offset:22528
    ds_read_b64_tr_b16 v[38:39], v11 offset:23040
    v_mfma_f32_32x32x16_bf16 v[68:83], v[48:51], v[24:27], v[68:83]
    ds_read_b64_tr_b16 v[40:41], v13 offset:22528
    ds_read_b64_tr_b16 v[42:43], v13 offset:23040
    s_waitcnt lgkmcnt(0)
    s_barrier
    v_mfma_f32_32x32x16_bf16 v[52:67], v[28:31], v[16:19], v[52:67]
    ds_read_b128 v[24:27], v10 offset:49152
    ds_read_b64_tr_b16 v[44:45], v11 offset:24576
    ds_read_b64_tr_b16 v[46:47], v11 offset:25088
    v_mfma_f32_32x32x16_bf16 v[68:83], v[32:35], v[16:19], v[68:83]
    ds_read_b64_tr_b16 v[48:49], v13 offset:24576
    ds_read_b64_tr_b16 v[50:51], v13 offset:25088
    s_waitcnt lgkmcnt(5)
    v_mfma_f32_32x32x16_bf16 v[52:67], v[36:39], v[20:23], v[52:67]
    ds_read_b128 v[16:19], v10 offset:53248
    ds_read_b64_tr_b16 v[28:29], v11 offset:26624
    ds_read_b64_tr_b16 v[30:31], v11 offset:27136
    v_mfma_f32_32x32x16_bf16 v[68:83], v[40:43], v[20:23], v[68:83]
    ds_read_b64_tr_b16 v[32:33], v13 offset:26624
    ds_read_b64_tr_b16 v[34:35], v13 offset:27136
    s_waitcnt lgkmcnt(5)
    v_mfma_f32_32x32x16_bf16 v[52:67], v[44:47], v[24:27], v[52:67]
    ds_read_b128 v[20:23], v10 offset:57344
    ds_read_b64_tr_b16 v[36:37], v11 offset:28672
    ds_read_b64_tr_b16 v[38:39], v11 offset:29184
    v_mfma_f32_32x32x16_bf16 v[68:83], v[48:51], v[24:27], v[68:83]
    ds_read_b64_tr_b16 v[40:41], v13 offset:28672
    ds_read_b64_tr_b16 v[42:43], v13 offset:29184
    s_waitcnt lgkmcnt(5)
    v_mfma_f32_32x32x16_bf16 v[52:67], v[28:31], v[16:19], v[52:67]
    ds_read_b128 v[24:27], v10 offset:61440
    ds_read_b64_tr_b16 v[44:45], v11 offset:30720
    ds_read_b64_tr_b16 v[46:47], v11 offset:31232
    v_mfma_f32_32x32x16_bf16 v[68:83], v[32:35], v[16:19], v[68:83]
    ds_read_b64_tr_b16 v[48:49], v13 offset:30720
    ds_read_b64_tr_b16 v[50:51], v13 offset:31232
    s_waitcnt lgkmcnt(0)
    s_barrier
    v_mfma_f32_32x32x16_bf16 v[52:67], v[36:39], v[20:23], v[52:67]
    ds_read_b128 v[16:19], v10 offset:0
    ds_read_b64_tr_b16 v[28:29], v11 offset:32768
    ds_read_b64_tr_b16 v[30:31], v11 offset:33280
    v_mfma_f32_32x32x16_bf16 v[68:83], v[40:43], v[20:23], v[68:83]
    ds_read_b64_tr_b16 v[32:33], v13 offset:32768
    ds_read_b64_tr_b16 v[34:35], v13 offset:33280
    s_waitcnt lgkmcnt(5)
    v_mfma_f32_32x32x16_bf16 v[52:67], v[44:47], v[24:27], v[52:67]
    ds_read_b128 v[20:23], v10 offset:4096
    ds_read_b64_tr_b16 v[36:37], v11 offset:34816
    ds_read_b64_tr_b16 v[38:39], v11 offset:35328
    v_mfma_f32_32x32x16_bf16 v[68:83], v[48:51], v[24:27], v[68:83]
    ds_read_b64_tr_b16 v[40:41], v13 offset:34816
    ds_read_b64_tr_b16 v[42:43], v13 offset:35328
    s_waitcnt lgkmcnt(5)
    v_mfma_f32_32x32x16_bf16 v[52:67], v[28:31], v[16:19], v[52:67]
    ds_read_b128 v[24:27], v10 offset:8192
    ds_read_b64_tr_b16 v[44:45], v11 offset:36864
    ds_read_b64_tr_b16 v[46:47], v11 offset:37376
    v_mfma_f32_32x32x16_bf16 v[68:83], v[32:35], v[16:19], v[68:83]
    ds_read_b64_tr_b16 v[48:49], v13 offset:36864
    ds_read_b64_tr_b16 v[50:51], v13 offset:37376
    s_waitcnt lgkmcnt(5)
    v_mfma_f32_32x32x16_bf16 v[52:67], v[36:39], v[20:23], v[52:67]
    ds_read_b128 v[16:19], v10 offset:12288
    ds_read_b64_tr_b16 v[28:29], v11 offset:38912
    ds_read_b64_tr_b16 v[30:31], v11 offset:39424
    v_mfma_f32_32x32x16_bf16 v[68:83], v[40:43], v[20:23], v[68:83]
    ds_read_b64_tr_b16 v[32:33], v13 offset:38912
    ds_read_b64_tr_b16 v[34:35], v13 offset:39424
    s_waitcnt lgkmcnt(0)
    s_barrier
    v_mfma_f32_32x32x16_bf16 v[52:67], v[44:47], v[24:27], v[52:67]
    ds_read_b128 v[20:23], v10 offset:16384
    ds_read_b64_tr_b16 v[36:37], v11 offset:40960
    ds_read_b64_tr_b16 v[38:39], v11 offset:41472
    v_mfma_f32_32x32x16_bf16 v[68:83], v[48:51], v[24:27], v[68:83]
    ds_read_b64_tr_b16 v[40:41], v13 offset:40960
    ds_read_b64_tr_b16 v[42:43], v13 offset:41472
    s_waitcnt lgkmcnt(5)
    v_mfma_f32_32x32x16_bf16 v[52:67], v[28:31], v[16:19], v[52:67]
    ds_read_b128 v[24:27], v10 offset:20480
    ds_read_b64_tr_b16 v[44:45], v11 offset:43008
    ds_read_b64_tr_b16 v[46:47], v11 offset:43520
    v_mfma_f32_32x32x16_bf16 v[68:83], v[32:35], v[16:19], v[68:83]
    ds_read_b64_tr_b16 v[48:49], v13 offset:43008
    ds_read_b64_tr_b16 v[50:51], v13 offset:43520
    s_waitcnt lgkmcnt(5)
    v_mfma_f32_32x32x16_bf16 v[52:67], v[36:39], v[20:23], v[52:67]
    ds_read_b128 v[16:19], v10 offset:24576
    ds_read_b64_tr_b16 v[28:29], v11 offset:45056
    ds_read_b64_tr_b16 v[30:31], v11 offset:45568
    v_mfma_f32_32x32x16_bf16 v[68:83], v[40:43], v[20:23], v[68:83]
    ds_read_b64_tr_b16 v[32:33], v13 offset:45056
    ds_read_b64_tr_b16 v[34:35], v13 offset:45568
    s_waitcnt lgkmcnt(5)
    v_mfma_f32_32x32x16_bf16 v[52:67], v[44:47], v[24:27], v[52:67]
    ds_read_b128 v[20:23], v10 offset:28672
    ds_read_b64_tr_b16 v[36:37], v11 offset:47104
    ds_read_b64_tr_b16 v[38:39], v11 offset:47616
    v_mfma_f32_32x32x16_bf16 v[68:83], v[48:51], v[24:27], v[68:83]
    ds_read_b64_tr_b16 v[40:41], v13 offset:47104
    ds_read_b64_tr_b16 v[42:43], v13 offset:47616
    s_waitcnt lgkmcnt(0)
    s_barrier
    v_mfma_f32_32x32x16_bf16 v[52:67], v[28:31], v[16:19], v[52:67]
    ds_read_b128 v[24:27], v10 offset:32768
    ds_read_b64_tr_b16 v[44:45], v11 offset:49152
    ds_read_b64_tr_b16 v[46:47], v11 offset:49664
    v_mfma_f32_32x32x16_bf16 v[68:83], v[32:35], v[16:19], v[68:83]
    ds_read_b64_tr_b16 v[48:49], v13 offset:49152
    ds_read_b64_tr_b16 v[50:51], v13 offset:49664
    s_waitcnt lgkmcnt(5)
    v_mfma_f32_32x32x16_bf16 v[52:67], v[36:39], v[20:23], v[52:67]
    ds_read_b128 v[16:19], v10 offset:36864
    ds_read_b64_tr_b16 v[28:29], v11 offset:51200
    ds_read_b64_tr_b16 v[30:31], v11 offset:51712
    v_mfma_f32_32x32x16_bf16 v[68:83], v[40:43], v[20:23], v[68:83]
    ds_read_b64_tr_b16 v[32:33], v13 offset:51200
    ds_read_b64_tr_b16 v[34:35], v13 offset:51712
    s_waitcnt lgkmcnt(5)
    v_mfma_f32_32x32x16_bf16 v[52:67], v[44:47], v[24:27], v[52:67]
    ds_read_b128 v[20:23], v10 offset:40960
    ds_read_b64_tr_b16 v[36:37], v11 offset:53248
    ds_read_b64_tr_b16 v[38:39], v11 offset:53760
    v_mfma_f32_32x32x16_bf16 v[68:83], v[48:51], v[24:27], v[68:83]
    ds_read_b64_tr_b16 v[40:41], v13 offset:53248
    ds_read_b64_tr_b16 v[42:43], v13 offset:53760
    s_waitcnt lgkmcnt(5)
    v_mfma_f32_32x32x16_bf16 v[52:67], v[28:31], v[16:19], v[52:67]
    ds_read_b128 v[24:27], v10 offset:45056
    ds_read_b64_tr_b16 v[44:45], v11 offset:55296
    ds_read_b64_tr_b16 v[46:47], v11 offset:55808
    v_mfma_f32_32x32x16_bf16 v[68:83], v[32:35], v[16:19], v[68:83]
    ds_read_b64_tr_b16 v[48:49], v13 offset:55296
    ds_read_b64_tr_b16 v[50:51], v13 offset:55808
    s_waitcnt lgkmcnt(0)
    s_barrier
    v_mfma_f32_32x32x16_bf16 v[52:67], v[36:39], v[20:23], v[52:67]
    v_mfma_f32_32x32x16_bf16 v[68:83], v[40:43], v[20:23], v[68:83]
    s_waitcnt lgkmcnt(0)
    v_mfma_f32_32x32x16_bf16 v[52:67], v[44:47], v[24:27], v[52:67]
    v_mfma_f32_32x32x16_bf16 v[68:83], v[48:51], v[24:27], v[68:83]
    s_nop 11
    v_cvt_pk_bf16_f32 v100, v52, v53
    v_cvt_pk_bf16_f32 v101, v54, v55
    ds_write_b64 v134, v[100:101]
    v_cvt_pk_bf16_f32 v102, v56, v57
    v_cvt_pk_bf16_f32 v103, v58, v59
    ds_write_b64 v135, v[102:103]
    v_cvt_pk_bf16_f32 v104, v60, v61
    v_cvt_pk_bf16_f32 v105, v62, v63
    ds_write_b64 v136, v[104:105]
    v_cvt_pk_bf16_f32 v106, v64, v65
    v_cvt_pk_bf16_f32 v107, v66, v67
    ds_write_b64 v137, v[106:107]
    v_cvt_pk_bf16_f32 v108, v68, v69
    v_cvt_pk_bf16_f32 v109, v70, v71
    ds_write_b64 v138, v[108:109]
    v_cvt_pk_bf16_f32 v110, v72, v73
    v_cvt_pk_bf16_f32 v111, v74, v75
    ds_write_b64 v139, v[110:111]
    v_cvt_pk_bf16_f32 v112, v76, v77
    v_cvt_pk_bf16_f32 v113, v78, v79
    ds_write_b64 v140, v[112:113]
    v_cvt_pk_bf16_f32 v114, v80, v81
    v_cvt_pk_bf16_f32 v115, v82, v83
    ds_write_b64 v141, v[114:115]
    s_waitcnt lgkmcnt(0)
    ds_read_b128 v[118:121], v144 offset:0
    ds_read_b128 v[122:125], v144 offset:1024
    ds_read_b128 v[126:129], v144 offset:2048
    ds_read_b128 v[130:133], v144 offset:3072
    s_waitcnt lgkmcnt(3)
    s_mov_b32 s65, 0
    buffer_store_dwordx4 v[118:121], v142, s[36:39], s65 offen sc1
    s_waitcnt lgkmcnt(2)
    s_mov_b32 s65, 10240
    buffer_store_dwordx4 v[122:125], v143, s[36:39], s65 offen sc1
    s_waitcnt lgkmcnt(1)
    s_mov_b32 s65, 20480
    buffer_store_dwordx4 v[126:129], v142, s[36:39], s65 offen sc1
    s_waitcnt lgkmcnt(0)
    s_mov_b32 s65, 30720
    buffer_store_dwordx4 v[130:133], v143, s[36:39], s65 offen sc1
c_end_72:
    s_endpgm
sequential_preLN__sliding_block__dense_activation_squared_relu__prompt_kernel_lrest:
    s_cmp_ge_u32 s58, 7
    s_cbranch_scc1 l_end_89
    s_cmp_ge_u32 s58, 5
    s_cbranch_scc1 l_classB_88
    s_lshl_b32 s59, s54, 7
    s_lshl_b32 s60, s55, 7
    s_mov_b32 s32, s8
    s_and_b32 s33, s9, 0xffff
    s_mov_b32 s34, 819200
    s_mov_b32 s35, 0x20000
    s_sub_u32 s61, s24, 4
    v_lshrrev_b32 v4, 3, v1
    v_and_b32 v5, 7, v1
    v_bfe_u32 v6, v1, 4, 1
    v_lshlrev_b32 v6, 2, v6
    v_xor_b32 v5, v5, v6
    s_lshl_b32 s62, s61, 4
    v_add_u32 v4, s62, v4
    v_mul_u32_u24 v4, 1280, v4
    v_lshl_add_u32 v4, v5, 4, v4
    v_add_u32 v7, s60, v4
    s_lshl_b32 s64, s61, 11
    s_lshl_b32 s65, s61, 12
    v_add_u32 v4, s59, v1
    v_lshlrev_b32 v4, 4, v4
    s_lshl_b32 s62, s61, 16
    v_add_u32 v8, s62, v4
    s_add_u32 s28, s22, 7864320
    s_addc_u32 s29, s23, 0
    s_and_b32 s29, s29, 0xffff
    s_mov_b32 s30, 2621440
    s_mov_b32 s31, 0x20000
    s_barrier
    s_add_u32 m0, s65, 4096
    s_mov_b32 s63, 0
    buffer_load_dwordx4 v8, s[28:31], s63 offen sc1 lds
    s_add_u32 m0, s65, 5120
    s_mov_b32 s63, 1024
    buffer_load_dwordx4 v8, s[28:31], s63 offen sc1 lds
    s_add_u32 m0, s65, 6144
    s_mov_b32 s63, 32768
    buffer_load_dwordx4 v8, s[28:31], s63 offen sc1 lds
    s_add_u32 m0, s65, 7168
    s_mov_b32 s63, 33792
    buffer_load_dwordx4 v8, s[28:31], s63 offen sc1 lds
    s_add_u32 m0, s65, 20480
    s_mov_b32 s63, 262144
    buffer_load_dwordx4 v8, s[28:31], s63 offen sc1 lds
    s_add_u32 m0, s65, 21504
    s_mov_b32 s63, 263168
    buffer_load_dwordx4 v8, s[28:31], s63 offen sc1 lds
    s_add_u32 m0, s65, 22528
    s_mov_b32 s63, 294912
    buffer_load_dwordx4 v8, s[28:31], s63 offen sc1 lds
    s_add_u32 m0, s65, 23552
    s_mov_b32 s63, 295936
    buffer_load_dwordx4 v8, s[28:31], s63 offen sc1 lds
    s_add_u32 m0, s65, 36864
    s_mov_b32 s63, 524288
    buffer_load_dwordx4 v8, s[28:31], s63 offen sc1 lds
    s_add_u32 m0, s65, 37888
    s_mov_b32 s63, 525312
    buffer_load_dwordx4 v8, s[28:31], s63 offen sc1 lds
    s_add_u32 m0, s65, 38912
    s_mov_b32 s63, 557056
    buffer_load_dwordx4 v8, s[28:31], s63 offen sc1 lds
    s_add_u32 m0, s65, 39936
    s_mov_b32 s63, 558080
    buffer_load_dwordx4 v8, s[28:31], s63 offen sc1 lds
    s_add_u32 m0, s65, 53248
    s_mov_b32 s63, 786432
    buffer_load_dwordx4 v8, s[28:31], s63 offen sc1 lds
    s_add_u32 m0, s65, 54272
    s_mov_b32 s63, 787456
    buffer_load_dwordx4 v8, s[28:31], s63 offen sc1 lds
    s_add_u32 m0, s65, 55296
    s_mov_b32 s63, 819200
    buffer_load_dwordx4 v8, s[28:31], s63 offen sc1 lds
    s_add_u32 m0, s65, 56320
    s_mov_b32 s63, 820224
    buffer_load_dwordx4 v8, s[28:31], s63 offen sc1 lds
    s_waitcnt vmcnt(12)
    s_barrier
    s_waitcnt vmcnt(8)
    s_barrier
    s_add_u32 m0, s65, 4096
    s_mov_b32 s63, 1048576
    buffer_load_dwordx4 v8, s[28:31], s63 offen sc1 lds
    s_add_u32 m0, s65, 5120
    s_mov_b32 s63, 1049600
    buffer_load_dwordx4 v8, s[28:31], s63 offen sc1 lds
    s_add_u32 m0, s65, 6144
    s_mov_b32 s63, 1081344
    buffer_load_dwordx4 v8, s[28:31], s63 offen sc1 lds
    s_add_u32 m0, s65, 7168
    s_mov_b32 s63, 1082368
    buffer_load_dwordx4 v8, s[28:31], s63 offen sc1 lds
    s_waitcnt vmcnt(8)
    s_barrier
    s_add_u32 m0, s65, 20480
    s_mov_b32 s63, 1310720
    buffer_load_dwordx4 v8, s[28:31], s63 offen sc1 lds
    s_add_u32 m0, s65, 21504
    s_mov_b32 s63, 1311744
    buffer_load_dwordx4 v8, s[28:31], s63 offen sc1 lds
    s_add_u32 m0, s65, 22528
    s_mov_b32 s63, 1343488
    buffer_load_dwordx4 v8, s[28:31], s63 offen sc1 lds
    s_add_u32 m0, s65, 23552
    s_mov_b32 s63, 1344512
    buffer_load_dwordx4 v8, s[28:31], s63 offen sc1 lds
    s_waitcnt vmcnt(8)
    s_barrier
    s_add_u32 m0, s65, 36864
    s_mov_b32 s63, 1572864
    buffer_load_dwordx4 v8, s[28:31], s63 offen sc1 lds
    s_add_u32 m0, s65, 37888
    s_mov_b32 s63, 1573888
    buffer_load_dwordx4 v8, s[28:31], s63 offen sc1 lds
    s_add_u32 m0, s65, 38912
    s_mov_b32 s63, 1605632
    buffer_load_dwordx4 v8, s[28:31], s63 offen sc1 lds
    s_add_u32 m0, s65, 39936
    s_mov_b32 s63, 1606656
    buffer_load_dwordx4 v8, s[28:31], s63 offen sc1 lds
    s_waitcnt vmcnt(8)
    s_barrier
    s_add_u32 m0, s65, 53248
    s_mov_b32 s63, 1835008
    buffer_load_dwordx4 v8, s[28:31], s63 offen sc1 lds
    s_add_u32 m0, s65, 54272
    s_mov_b32 s63, 1836032
    buffer_load_dwordx4 v8, s[28:31], s63 offen sc1 lds
    s_add_u32 m0, s65, 55296
    s_mov_b32 s63, 1867776
    buffer_load_dwordx4 v8, s[28:31], s63 offen sc1 lds
    s_add_u32 m0, s65, 56320
    s_mov_b32 s63, 1868800
    buffer_load_dwordx4 v8, s[28:31], s63 offen sc1 lds
    s_waitcnt vmcnt(8)
    s_barrier
    s_add_u32 m0, s65, 4096
    s_mov_b32 s63, 2097152
    buffer_load_dwordx4 v8, s[28:31], s63 offen sc1 lds
    s_add_u32 m0, s65, 5120
    s_mov_b32 s63, 2098176
    buffer_load_dwordx4 v8, s[28:31], s63 offen sc1 lds
    s_add_u32 m0, s65, 6144
    s_mov_b32 s63, 2129920
    buffer_load_dwordx4 v8, s[28:31], s63 offen sc1 lds
    s_add_u32 m0, s65, 7168
    s_mov_b32 s63, 2130944
    buffer_load_dwordx4 v8, s[28:31], s63 offen sc1 lds
    s_waitcnt vmcnt(8)
    s_barrier
    s_add_u32 m0, s65, 20480
    s_mov_b32 s63, 2359296
    buffer_load_dwordx4 v8, s[28:31], s63 offen sc1 lds
    s_add_u32 m0, s65, 21504
    s_mov_b32 s63, 2360320
    buffer_load_dwordx4 v8, s[28:31], s63 offen sc1 lds
    s_add_u32 m0, s65, 22528
    s_mov_b32 s63, 2392064
    buffer_load_dwordx4 v8, s[28:31], s63 offen sc1 lds
    s_add_u32 m0, s65, 23552
    s_mov_b32 s63, 2393088
    buffer_load_dwordx4 v8, s[28:31], s63 offen sc1 lds
    s_waitcnt vmcnt(8)
    s_barrier
    s_waitcnt vmcnt(4)
    s_barrier
    s_waitcnt vmcnt(0)
    s_barrier
    s_barrier
    s_barrier
    s_lshl_b32 s59, s54, 7
    s_lshl_b32 s60, s56, 8
    s_add_u32 s61, s54, s56
    s_mul_i32 s62, s61, 26
    s_lshr_b32 s62, s62, 8
    s_mul_i32 s62, s62, 10
    s_sub_u32 s61, s61, s62
    s_mov_b32 s32, s12
    s_and_b32 s33, s13, 0xffff
    s_mov_b32 s34, 2211840
    s_mov_b32 s35, 0x20000
    s_sub_u32 s63, s24, 4
    v_lshrrev_b32 v4, 4, v1
    v_and_b32 v5, 15, v1
    v_lshlrev_b32 v6, 2, v4
    v_xor_b32 v5, v5, v6
    s_lshl_b32 s64, s63, 4
    v_add_u32 v4, s64, v4
    v_mul_u32_u24 v4, 3456, v4
    v_lshl_add_u32 v4, v5, 4, v4
    v_add_u32 v7, s60, v4
    s_lshl_b32 s66, s63, 12
    s_lshl_b32 s67, s63, 12
    v_add_u32 v4, s59, v1
    v_lshlrev_b32 v4, 4, v4
    s_lshl_b32 s64, s63, 16
    v_add_u32 v8, s64, v4
    s_mul_i32 s68, s61, 262144
    s_mul_i32 s69, s61, 221184
    s_add_u32 m0, s66, 75776
    s_add_u32 s65, s69, 0
    buffer_load_dwordx4 v7, s[32:35], s65 offen lds
    s_add_u32 m0, s66, 76800
    s_add_u32 s65, s69, 13824
    buffer_load_dwordx4 v7, s[32:35], s65 offen lds
    s_add_u32 m0, s66, 77824
    s_add_u32 s65, s69, 27648
    buffer_load_dwordx4 v7, s[32:35], s65 offen lds
    s_add_u32 m0, s66, 78848
    s_add_u32 s65, s69, 41472
    buffer_load_dwordx4 v7, s[32:35], s65 offen lds
    s_add_u32 s69, s69, 221184
    s_cmp_ge_u32 s69, 2211840
    s_cselect_b32 s65, 2211840, 0
    s_sub_u32 s69, s69, s65
    s_add_u32 m0, s66, 92160
    s_add_u32 s65, s69, 0
    buffer_load_dwordx4 v7, s[32:35], s65 offen lds
    s_add_u32 m0, s66, 93184
    s_add_u32 s65, s69, 13824
    buffer_load_dwordx4 v7, s[32:35], s65 offen lds
    s_add_u32 m0, s66, 94208
    s_add_u32 s65, s69, 27648
    buffer_load_dwordx4 v7, s[32:35], s65 offen lds
    s_add_u32 m0, s66, 95232
    s_add_u32 s65, s69, 41472
    buffer_load_dwordx4 v7, s[32:35], s65 offen lds
    s_add_u32 s69, s69, 221184
    s_cmp_ge_u32 s69, 2211840
    s_cselect_b32 s65, 2211840, 0
    s_sub_u32 s69, s69, s65
    s_add_u32 s28, s22, 10485760
    s_addc_u32 s29, s23, 0
    s_and_b32 s29, s29, 0xffff
    s_mov_b32 s30, 2621440
    s_mov_b32 s31, 0x20000
    s_add_u32 s36, s22, 20185088
    s_addc_u32 s37, s23, 0
    s_and_b32 s37, s37, 0xffff
    s_mov_b32 s38, 983040
    s_mov_b32 s39, 0x20000
    s_sub_u32 s72, s24, 4
    s_lshl_b32 s72, s72, 10
    v_lshl_add_u32 v9, v1, 4, s72
    s_mul_i32 s70, s54, 20480
    s_add_u32 s70, s70, 491520
    s_mul_i32 s71, s56, 10240
    s_add_u32 s71, s71, 819200
    s_barrier
    s_add_u32 m0, s67, 4096
    s_add_u32 s65, s68, 0
    buffer_load_dwordx4 v8, s[28:31], s65 offen sc1 lds
    s_add_u32 m0, s67, 5120
    s_add_u32 s65, s68, 1024
    buffer_load_dwordx4 v8, s[28:31], s65 offen sc1 lds
    s_add_u32 m0, s67, 6144
    s_add_u32 s65, s68, 32768
    buffer_load_dwordx4 v8, s[28:31], s65 offen sc1 lds
    s_add_u32 m0, s67, 7168
    s_add_u32 s65, s68, 33792
    buffer_load_dwordx4 v8, s[28:31], s65 offen sc1 lds
    s_add_u32 s68, s68, 262144
    s_cmp_ge_u32 s68, 2621440
    s_cselect_b32 s65, 2621440, 0
    s_sub_u32 s68, s68, s65
    s_add_u32 m0, s67, 20480
    s_add_u32 s65, s68, 0
    buffer_load_dwordx4 v8, s[28:31], s65 offen sc1 lds
    s_add_u32 m0, s67, 21504
    s_add_u32 s65, s68, 1024
    buffer_load_dwordx4 v8, s[28:31], s65 offen sc1 lds
    s_add_u32 m0, s67, 22528
    s_add_u32 s65, s68, 32768
    buffer_load_dwordx4 v8, s[28:31], s65 offen sc1 lds
    s_add_u32 m0, s67, 23552
    s_add_u32 s65, s68, 33792
    buffer_load_dwordx4 v8, s[28:31], s65 offen sc1 lds
    s_add_u32 s68, s68, 262144
    s_cmp_ge_u32 s68, 2621440
    s_cselect_b32 s65, 2621440, 0
    s_sub_u32 s68, s68, s65
    s_add_u32 m0, s67, 36864
    s_add_u32 s65, s68, 0
    buffer_load_dwordx4 v8, s[28:31], s65 offen sc1 lds
    s_add_u32 m0, s67, 37888
    s_add_u32 s65, s68, 1024
    buffer_load_dwordx4 v8, s[28:31], s65 offen sc1 lds
    s_add_u32 m0, s67, 38912
    s_add_u32 s65, s68, 32768
    buffer_load_dwordx4 v8, s[28:31], s65 offen sc1 lds
    s_add_u32 m0, s67, 39936
    s_add_u32 s65, s68, 33792
    buffer_load_dwordx4 v8, s[28:31], s65 offen sc1 lds
    s_add_u32 s68, s68, 262144
    s_cmp_ge_u32 s68, 2621440
    s_cselect_b32 s65, 2621440, 0
    s_sub_u32 s68, s68, s65
    s_add_u32 m0, s67, 53248
    s_add_u32 s65, s68, 0
    buffer_load_dwordx4 v8, s[28:31], s65 offen sc1 lds
    s_add_u32 m0, s67, 54272
    s_add_u32 s65, s68, 1024
    buffer_load_dwordx4 v8, s[28:31], s65 offen sc1 lds
    s_add_u32 m0, s67, 55296
    s_add_u32 s65, s68, 32768
    buffer_load_dwordx4 v8, s[28:31], s65 offen sc1 lds
    s_add_u32 m0, s67, 56320
    s_add_u32 s65, s68, 33792
    buffer_load_dwordx4 v8, s[28:31], s65 offen sc1 lds
    s_add_u32 s68, s68, 262144
    s_cmp_ge_u32 s68, 2621440
    s_cselect_b32 s65, 2621440, 0
    s_sub_u32 s68, s68, s65
    s_waitcnt vmcnt(12)
    s_barrier
    s_add_u32 m0, s66, 108544
    s_add_u32 s65, s69, 0
    buffer_load_dwordx4 v7, s[32:35], s65 offen lds
    s_add_u32 m0, s66, 109568
    s_add_u32 s65, s69, 13824
    buffer_load_dwordx4 v7, s[32:35], s65 offen lds
    s_add_u32 m0, s66, 110592
    s_add_u32 s65, s69, 27648
    buffer_load_dwordx4 v7, s[32:35], s65 offen lds
    s_add_u32 m0, s66, 111616
    s_add_u32 s65, s69, 41472
    buffer_load_dwordx4 v7, s[32:35], s65 offen lds
    s_add_u32 s69, s69, 221184
    s_cmp_ge_u32 s69, 2211840
    s_cselect_b32 s65, 2211840, 0
    s_sub_u32 s69, s69, s65
    s_add_u32 m0, s66, 124928
    s_add_u32 s65, s69, 0
    buffer_load_dwordx4 v7, s[32:35], s65 offen lds
    s_add_u32 m0, s66, 125952
    s_add_u32 s65, s69, 13824
    buffer_load_dwordx4 v7, s[32:35], s65 offen lds
    s_add_u32 m0, s66, 126976
    s_add_u32 s65, s69, 27648
    buffer_load_dwordx4 v7, s[32:35], s65 offen lds
    s_add_u32 m0, s66, 128000
    s_add_u32 s65, s69, 41472
    buffer_load_dwordx4 v7, s[32:35], s65 offen lds
    s_add_u32 s69, s69, 221184
    s_cmp_ge_u32 s69, 2211840
    s_cselect_b32 s65, 2211840, 0
    s_sub_u32 s69, s69, s65
    s_waitcnt vmcnt(16)
    s_barrier
    s_add_u32 m0, s66, 141312
    s_add_u32 s65, s69, 0
    buffer_load_dwordx4 v7, s[32:35], s65 offen lds
    s_add_u32 m0, s66, 142336
    s_add_u32 s65, s69, 13824
    buffer_load_dwordx4 v7, s[32:35], s65 offen lds
    s_add_u32 m0, s66, 143360
    s_add_u32 s65, s69, 27648
    buffer_load_dwordx4 v7, s[32:35], s65 offen lds
    s_add_u32 m0, s66, 144384
    s_add_u32 s65, s69, 41472
    buffer_load_dwordx4 v7, s[32:35], s65 offen lds
    s_add_u32 s69, s69, 221184
    s_cmp_ge_u32 s69, 2211840
    s_cselect_b32 s65, 2211840, 0
    s_sub_u32 s69, s69, s65
    s_add_u32 m0, s67, 4096
    s_add_u32 s65, s68, 0
    buffer_load_dwordx4 v8, s[28:31], s65 offen sc1 lds
    s_add_u32 m0, s67, 5120
    s_add_u32 s65, s68, 1024
    buffer_load_dwordx4 v8, s[28:31], s65 offen sc1 lds
    s_add_u32 m0, s67, 6144
    s_add_u32 s65, s68, 32768
    buffer_load_dwordx4 v8, s[28:31], s65 offen sc1 lds
    s_add_u32 m0, s67, 7168
    s_add_u32 s65, s68, 33792
    buffer_load_dwordx4 v8, s[28:31], s65 offen sc1 lds
    s_add_u32 s68, s68, 262144
    s_cmp_ge_u32 s68, 2621440
    s_cselect_b32 s65, 2621440, 0
    s_sub_u32 s68, s68, s65
    s_add_u32 m0, s66, 75776
    s_add_u32 s65, s69, 0
    buffer_load_dwordx4 v7, s[32:35], s65 offen lds
    s_add_u32 m0, s66, 76800
    s_add_u32 s65, s69, 13824
    buffer_load_dwordx4 v7, s[32:35], s65 offen lds
    s_add_u32 m0, s66, 77824
    s_add_u32 s65, s69, 27648
    buffer_load_dwordx4 v7, s[32:35], s65 offen lds
    s_add_u32 m0, s66, 78848
    s_add_u32 s65, s69, 41472
    buffer_load_dwordx4 v7, s[32:35], s65 offen lds
    s_add_u32 s69, s69, 221184
    s_cmp_ge_u32 s69, 2211840
    s_cselect_b32 s65, 2211840, 0
    s_sub_u32 s69, s69, s65
    s_waitcnt vmcnt(16)
    s_barrier
    s_add_u32 m0, s67, 20480
    s_add_u32 s65, s68, 0
    buffer_load_dwordx4 v8, s[28:31], s65 offen sc1 lds
    s_add_u32 m0, s67, 21504
    s_add_u32 s65, s68, 1024
    buffer_load_dwordx4 v8, s[28:31], s65 offen sc1 lds
    s_add_u32 m0, s67, 22528
    s_add_u32 s65, s68, 32768
    buffer_load_dwordx4 v8, s[28:31], s65 offen sc1 lds
    s_add_u32 m0, s67, 23552
    s_add_u32 s65, s68, 33792
    buffer_load_dwordx4 v8, s[28:31], s65 offen sc1 lds
    s_add_u32 s68, s68, 262144
    s_cmp_ge_u32 s68, 2621440
    s_cselect_b32 s65, 2621440, 0
    s_sub_u32 s68, s68, s65
    s_add_u32 m0, s66, 92160
    s_add_u32 s65, s69, 0
    buffer_load_dwordx4 v7, s[32:35], s65 offen lds
    s_add_u32 m0, s66, 93184
    s_add_u32 s65, s69, 13824
    buffer_load_dwordx4 v7, s[32:35], s65 offen lds
    s_add_u32 m0, s66, 94208
    s_add_u32 s65, s69, 27648
    buffer_load_dwordx4 v7, s[32:35], s65 offen lds
    s_add_u32 m0, s66, 95232
    s_add_u32 s65, s69, 41472
    buffer_load_dwordx4 v7, s[32:35], s65 offen lds
    s_add_u32 s69, s69, 221184
    s_cmp_ge_u32 s69, 2211840
    s_cselect_b32 s65, 2211840, 0
    s_sub_u32 s69, s69, s65
    s_waitcnt vmcnt(20)
    s_barrier
    s_add_u32 m0, s67, 36864
    s_add_u32 s65, s68, 0
    buffer_load_dwordx4 v8, s[28:31], s65 offen sc1 lds
    s_add_u32 m0, s67, 37888
    s_add_u32 s65, s68, 1024
    buffer_load_dwordx4 v8, s[28:31], s65 offen sc1 lds
    s_add_u32 m0, s67, 38912
    s_add_u32 s65, s68, 32768
    buffer_load_dwordx4 v8, s[28:31], s65 offen sc1 lds
    s_add_u32 m0, s67, 39936
    s_add_u32 s65, s68, 33792
    buffer_load_dwordx4 v8, s[28:31], s65 offen sc1 lds
    s_add_u32 s68, s68, 262144
    s_cmp_ge_u32 s68, 2621440
    s_cselect_b32 s65, 2621440, 0
    s_sub_u32 s68, s68, s65
    s_add_u32 m0, s66, 108544
    s_add_u32 s65, s69, 0
    buffer_load_dwordx4 v7, s[32:35], s65 offen lds
    s_add_u32 m0, s66, 109568
    s_add_u32 s65, s69, 13824
    buffer_load_dwordx4 v7, s[32:35], s65 offen lds
    s_add_u32 m0, s66, 110592
    s_add_u32 s65, s69, 27648
    buffer_load_dwordx4 v7, s[32:35], s65 offen lds
    s_add_u32 m0, s66, 111616
    s_add_u32 s65, s69, 41472
    buffer_load_dwordx4 v7, s[32:35], s65 offen lds
    s_add_u32 s69, s69, 221184
    s_cmp_ge_u32 s69, 2211840
    s_cselect_b32 s65, 2211840, 0
    s_sub_u32 s69, s69, s65
    s_waitcnt vmcnt(20)
    s_barrier
    s_add_u32 m0, s67, 53248
    s_add_u32 s65, s68, 0
    buffer_load_dwordx4 v8, s[28:31], s65 offen sc1 lds
    s_add_u32 m0, s67, 54272
    s_add_u32 s65, s68, 1024
    buffer_load_dwordx4 v8, s[28:31], s65 offen sc1 lds
    s_add_u32 m0, s67, 55296
    s_add_u32 s65, s68, 32768
    buffer_load_dwordx4 v8, s[28:31], s65 offen sc1 lds
    s_add_u32 m0, s67, 56320
    s_add_u32 s65, s68, 33792
    buffer_load_dwordx4 v8, s[28:31], s65 offen sc1 lds
    s_add_u32 s68, s68, 262144
    s_cmp_ge_u32 s68, 2621440
    s_cselect_b32 s65, 2621440, 0
    s_sub_u32 s68, s68, s65
    s_add_u32 m0, s66, 124928
    s_add_u32 s65, s69, 0
    buffer_load_dwordx4 v7, s[32:35], s65 offen lds
    s_add_u32 m0, s66, 125952
    s_add_u32 s65, s69, 13824
    buffer_load_dwordx4 v7, s[32:35], s65 offen lds
    s_add_u32 m0, s66, 126976
    s_add_u32 s65, s69, 27648
    buffer_load_dwordx4 v7, s[32:35], s65 offen lds
    s_add_u32 m0, s66, 128000
    s_add_u32 s65, s69, 41472
    buffer_load_dwordx4 v7, s[32:35], s65 offen lds
    s_add_u32 s69, s69, 221184
    s_cmp_ge_u32 s69, 2211840
    s_cselect_b32 s65, 2211840, 0
    s_sub_u32 s69, s69, s65
    s_waitcnt vmcnt(20)
    s_barrier
    s_add_u32 m0, s67, 4096
    s_add_u32 s65, s68, 0
    buffer_load_dwordx4 v8, s[28:31], s65 offen sc1 lds
    s_add_u32 m0, s67, 5120
    s_add_u32 s65, s68, 1024
    buffer_load_dwordx4 v8, s[28:31], s65 offen sc1 lds
    s_add_u32 m0, s67, 6144
    s_add_u32 s65, s68, 32768
    buffer_load_dwordx4 v8, s[28:31], s65 offen sc1 lds
    s_add_u32 m0, s67, 7168
    s_add_u32 s65, s68, 33792
    buffer_load_dwordx4 v8, s[28:31], s65 offen sc1 lds
    s_add_u32 s68, s68, 262144
    s_cmp_ge_u32 s68, 2621440
    s_cselect_b32 s65, 2621440, 0
    s_sub_u32 s68, s68, s65
    s_add_u32 m0, s66, 141312
    s_add_u32 s65, s69, 0
    buffer_load_dwordx4 v7, s[32:35], s65 offen lds
    s_add_u32 m0, s66, 142336
    s_add_u32 s65, s69, 13824
    buffer_load_dwordx4 v7, s[32:35], s65 offen lds
    s_add_u32 m0, s66, 143360
    s_add_u32 s65, s69, 27648
    buffer_load_dwordx4 v7, s[32:35], s65 offen lds
    s_add_u32 m0, s66, 144384
    s_add_u32 s65, s69, 41472
    buffer_load_dwordx4 v7, s[32:35], s65 offen lds
    s_add_u32 s69, s69, 221184
    s_cmp_ge_u32 s69, 2211840
    s_cselect_b32 s65, 2211840, 0
    s_sub_u32 s69, s69, s65
    s_waitcnt vmcnt(20)
    s_barrier
    s_add_u32 m0, s67, 20480
    s_add_u32 s65, s68, 0
    buffer_load_dwordx4 v8, s[28:31], s65 offen sc1 lds
    s_add_u32 m0, s67, 21504
    s_add_u32 s65, s68, 1024
    buffer_load_dwordx4 v8, s[28:31], s65 offen sc1 lds
    s_add_u32 m0, s67, 22528
    s_add_u32 s65, s68, 32768
    buffer_load_dwordx4 v8, s[28:31], s65 offen sc1 lds
    s_add_u32 m0, s67, 23552
    s_add_u32 s65, s68, 33792
    buffer_load_dwordx4 v8, s[28:31], s65 offen sc1 lds
    s_add_u32 s68, s68, 262144
    s_cmp_ge_u32 s68, 2621440
    s_cselect_b32 s65, 2621440, 0
    s_sub_u32 s68, s68, s65
    s_waitcnt vmcnt(16)
    s_barrier
    s_add_u32 m0, s72, 36864
    s_add_u32 s65, s70, 0
    buffer_load_dwordx4 v9, s[36:39], s65 offen sc1 lds
    s_add_u32 m0, s72, 40960
    s_add_u32 s65, s70, 4096
    buffer_load_dwordx4 v9, s[36:39], s65 offen sc1 lds
    s_add_u32 m0, s72, 45056
    s_add_u32 s65, s70, 8192
    buffer_load_dwordx4 v9, s[36:39], s65 offen sc1 lds
    s_add_u32 m0, s72, 49152
    s_add_u32 s65, s70, 12288
    buffer_load_dwordx4 v9, s[36:39], s65 offen sc1 lds
    s_add_u32 m0, s72, 92160
    s_add_u32 s65, s70, 16384
    buffer_load_dwordx4 v9, s[36:39], s65 offen sc1 lds
    s_add_u32 m0, s72, 96256
    s_add_u32 s65, s71, 0
    buffer_load_dwordx4 v9, s[36:39], s65 offen sc1 lds
    s_add_u32 m0, s72, 100352
    s_add_u32 s65, s71, 4096
    buffer_load_dwordx4 v9, s[36:39], s65 offen sc1 lds
    s_cmp_ge_u32 s72, 2048
    s_cbranch_scc1 sd_skip_90
    s_add_u32 m0, s72, 104448
    s_add_u32 s65, s71, 8192
    buffer_load_dwordx4 v9, s[36:39], s65 offen sc1 lds
sd_skip_90:
    s_waitcnt vmcnt(8)
    s_barrier
    s_waitcnt vmcnt(0)
    s_barrier
    s_barrier
    s_barrier
    s_lshl_b32 s59, s54, 7
    s_lshl_b32 s60, s55, 7
    s_mov_b32 s32, s16
    s_and_b32 s33, s17, 0xffff
    s_mov_b32 s34, 2211840
    s_mov_b32 s35, 0x20000
    s_sub_u32 s61, s24, 4
    v_lshrrev_b32 v4, 3, v1
    v_and_b32 v5, 7, v1
    v_bfe_u32 v6, v1, 4, 1
    v_lshlrev_b32 v6, 2, v6
    v_xor_b32 v5, v5, v6
    s_lshl_b32 s62, s61, 4
    v_add_u32 v4, s62, v4
    v_mul_u32_u24 v4, 1280, v4
    v_lshl_add_u32 v4, v5, 4, v4
    v_add_u32 v7, s60, v4
    s_lshl_b32 s64, s61, 11
    s_lshl_b32 s65, s61, 12
    v_add_u32 v4, s59, v1
    v_lshlrev_b32 v4, 4, v4
    s_lshl_b32 s62, s61, 16
    v_add_u32 v8, s62, v4
    s_add_u32 m0, s64, 75776
    s_mov_b32 s63, 0
    buffer_load_dwordx4 v7, s[32:35], s63 offen lds
    s_add_u32 m0, s64, 76800
    s_mov_b32 s63, 10240
    buffer_load_dwordx4 v7, s[32:35], s63 offen lds
    s_add_u32 m0, s64, 83968
    s_mov_b32 s63, 81920
    buffer_load_dwordx4 v7, s[32:35], s63 offen lds
    s_add_u32 m0, s64, 84992
    s_mov_b32 s63, 92160
    buffer_load_dwordx4 v7, s[32:35], s63 offen lds
    s_add_u32 m0, s64, 92160
    s_mov_b32 s63, 163840
    buffer_load_dwordx4 v7, s[32:35], s63 offen lds
    s_add_u32 m0, s64, 93184
    s_mov_b32 s63, 174080
    buffer_load_dwordx4 v7, s[32:35], s63 offen lds
    s_add_u32 m0, s64, 100352
    s_mov_b32 s63, 245760
    buffer_load_dwordx4 v7, s[32:35], s63 offen lds
    s_add_u32 m0, s64, 101376
    s_mov_b32 s63, 256000
    buffer_load_dwordx4 v7, s[32:35], s63 offen lds
    s_add_u32 m0, s64, 108544
    s_mov_b32 s63, 327680
    buffer_load_dwordx4 v7, s[32:35], s63 offen lds
    s_add_u32 m0, s64, 109568
    s_mov_b32 s63, 337920
    buffer_load_dwordx4 v7, s[32:35], s63 offen lds
    s_add_u32 s28, s22, 13107200
    s_addc_u32 s29, s23, 0
    s_and_b32 s29, s29, 0xffff
    s_mov_b32 s30, 7077888
    s_mov_b32 s31, 0x20000
    s_barrier
    s_add_u32 m0, s65, 4096
    s_mov_b32 s63, 0
    buffer_load_dwordx4 v8, s[28:31], s63 offen sc1 lds
    s_add_u32 m0, s65, 5120
    s_mov_b32 s63, 1024
    buffer_load_dwordx4 v8, s[28:31], s63 offen sc1 lds
    s_add_u32 m0, s65, 6144
    s_mov_b32 s63, 32768
    buffer_load_dwordx4 v8, s[28:31], s63 offen sc1 lds
    s_add_u32 m0, s65, 7168
    s_mov_b32 s63, 33792
    buffer_load_dwordx4 v8, s[28:31], s63 offen sc1 lds
    s_add_u32 m0, s65, 20480
    s_mov_b32 s63, 262144
    buffer_load_dwordx4 v8, s[28:31], s63 offen sc1 lds
    s_add_u32 m0, s65, 21504
    s_mov_b32 s63, 263168
    buffer_load_dwordx4 v8, s[28:31], s63 offen sc1 lds
    s_add_u32 m0, s65, 22528
    s_mov_b32 s63, 294912
    buffer_load_dwordx4 v8, s[28:31], s63 offen sc1 lds
    s_add_u32 m0, s65, 23552
    s_mov_b32 s63, 295936
    buffer_load_dwordx4 v8, s[28:31], s63 offen sc1 lds
    s_add_u32 m0, s65, 36864
    s_mov_b32 s63, 524288
    buffer_load_dwordx4 v8, s[28:31], s63 offen sc1 lds
    s_add_u32 m0, s65, 37888
    s_mov_b32 s63, 525312
    buffer_load_dwordx4 v8, s[28:31], s63 offen sc1 lds
    s_add_u32 m0, s65, 38912
    s_mov_b32 s63, 557056
    buffer_load_dwordx4 v8, s[28:31], s63 offen sc1 lds
    s_add_u32 m0, s65, 39936
    s_mov_b32 s63, 558080
    buffer_load_dwordx4 v8, s[28:31], s63 offen sc1 lds
    s_add_u32 m0, s65, 53248
    s_mov_b32 s63, 786432
    buffer_load_dwordx4 v8, s[28:31], s63 offen sc1 lds
    s_add_u32 m0, s65, 54272
    s_mov_b32 s63, 787456
    buffer_load_dwordx4 v8, s[28:31], s63 offen sc1 lds
    s_add_u32 m0, s65, 55296
    s_mov_b32 s63, 819200
    buffer_load_dwordx4 v8, s[28:31], s63 offen sc1 lds
    s_add_u32 m0, s65, 56320
    s_mov_b32 s63, 820224
    buffer_load_dwordx4 v8, s[28:31], s63 offen sc1 lds
    s_waitcnt vmcnt(12)
    s_barrier
    s_add_u32 m0, s64, 116736
    s_mov_b32 s63, 409600
    buffer_load_dwordx4 v7, s[32:35], s63 offen lds
    s_add_u32 m0, s64, 117760
    s_mov_b32 s63, 419840
    buffer_load_dwordx4 v7, s[32:35], s63 offen lds
    s_add_u32 m0, s64, 124928
    s_mov_b32 s63, 491520
    buffer_load_dwordx4 v7, s[32:35], s63 offen lds
    s_add_u32 m0, s64, 125952
    s_mov_b32 s63, 501760
    buffer_load_dwordx4 v7, s[32:35], s63 offen lds
    s_waitcnt vmcnt(12)
    s_barrier
    s_add_u32 m0, s65, 4096
    s_mov_b32 s63, 1048576
    buffer_load_dwordx4 v8, s[28:31], s63 offen sc1 lds
    s_add_u32 m0, s65, 5120
    s_mov_b32 s63, 1049600
    buffer_load_dwordx4 v8, s[28:31], s63 offen sc1 lds
    s_add_u32 m0, s65, 6144
    s_mov_b32 s63, 1081344
    buffer_load_dwordx4 v8, s[28:31], s63 offen sc1 lds
    s_add_u32 m0, s65, 7168
    s_mov_b32 s63, 1082368
    buffer_load_dwordx4 v8, s[28:31], s63 offen sc1 lds
    s_add_u32 m0, s64, 133120
    s_mov_b32 s63, 573440
    buffer_load_dwordx4 v7, s[32:35], s63 offen lds
    s_add_u32 m0, s64, 134144
    s_mov_b32 s63, 583680
    buffer_load_dwordx4 v7, s[32:35], s63 offen lds
    s_add_u32 m0, s64, 141312
    s_mov_b32 s63, 655360
    buffer_load_dwordx4 v7, s[32:35], s63 offen lds
    s_add_u32 m0, s64, 142336
    s_mov_b32 s63, 665600
    buffer_load_dwordx4 v7, s[32:35], s63 offen lds
    s_waitcnt vmcnt(16)
    s_barrier
    s_add_u32 m0, s65, 20480
    s_mov_b32 s63, 1310720
    buffer_load_dwordx4 v8, s[28:31], s63 offen sc1 lds
    s_add_u32 m0, s65, 21504
    s_mov_b32 s63, 1311744
    buffer_load_dwordx4 v8, s[28:31], s63 offen sc1 lds
    s_add_u32 m0, s65, 22528
    s_mov_b32 s63, 1343488
    buffer_load_dwordx4 v8, s[28:31], s63 offen sc1 lds
    s_add_u32 m0, s65, 23552
    s_mov_b32 s63, 1344512
    buffer_load_dwordx4 v8, s[28:31], s63 offen sc1 lds
    s_add_u32 m0, s64, 149504
    s_mov_b32 s63, 737280
    buffer_load_dwordx4 v7, s[32:35], s63 offen lds
    s_add_u32 m0, s64, 150528
    s_mov_b32 s63, 747520
    buffer_load_dwordx4 v7, s[32:35], s63 offen lds
    s_add_u32 m0, s64, 75776
    s_mov_b32 s63, 819200
    buffer_load_dwordx4 v7, s[32:35], s63 offen lds
    s_add_u32 m0, s64, 76800
    s_mov_b32 s63, 829440
    buffer_load_dwordx4 v7, s[32:35], s63 offen lds
    s_waitcnt vmcnt(20)
    s_barrier
    s_add_u32 m0, s65, 36864
    s_mov_b32 s63, 1572864
    buffer_load_dwordx4 v8, s[28:31], s63 offen sc1 lds
    s_add_u32 m0, s65, 37888
    s_mov_b32 s63, 1573888
    buffer_load_dwordx4 v8, s[28:31], s63 offen sc1 lds
    s_add_u32 m0, s65, 38912
    s_mov_b32 s63, 1605632
    buffer_load_dwordx4 v8, s[28:31], s63 offen sc1 lds
    s_add_u32 m0, s65, 39936
    s_mov_b32 s63, 1606656
    buffer_load_dwordx4 v8, s[28:31], s63 offen sc1 lds
    s_add_u32 m0, s64, 83968
    s_mov_b32 s63, 901120
    buffer_load_dwordx4 v7, s[32:35], s63 offen lds
    s_add_u32 m0, s64, 84992
    s_mov_b32 s63, 911360
    buffer_load_dwordx4 v7, s[32:35], s63 offen lds
    s_add_u32 m0, s64, 92160
    s_mov_b32 s63, 983040
    buffer_load_dwordx4 v7, s[32:35], s63 offen lds
    s_add_u32 m0, s64, 93184
    s_mov_b32 s63, 993280
    buffer_load_dwordx4 v7, s[32:35], s63 offen lds
    s_waitcnt vmcnt(20)
    s_barrier
    s_add_u32 m0, s65, 53248
    s_mov_b32 s63, 1835008
    buffer_load_dwordx4 v8, s[28:31], s63 offen sc1 lds
    s_add_u32 m0, s65, 54272
    s_mov_b32 s63, 1836032
    buffer_load_dwordx4 v8, s[28:31], s63 offen sc1 lds
    s_add_u32 m0, s65, 55296
    s_mov_b32 s63, 1867776
    buffer_load_dwordx4 v8, s[28:31], s63 offen sc1 lds
    s_add_u32 m0, s65, 56320
    s_mov_b32 s63, 1868800
    buffer_load_dwordx4 v8, s[28:31], s63 offen sc1 lds
    s_add_u32 m0, s64, 100352
    s_mov_b32 s63, 1064960
    buffer_load_dwordx4 v7, s[32:35], s63 offen lds
    s_add_u32 m0, s64, 101376
    s_mov_b32 s63, 1075200
    buffer_load_dwordx4 v7, s[32:35], s63 offen lds
    s_waitcnt vmcnt(18)
    s_barrier
    s_add_u32 m0, s65, 4096
    s_mov_b32 s63, 2097152
    buffer_load_dwordx4 v8, s[28:31], s63 offen sc1 lds
    s_add_u32 m0, s65, 5120
    s_mov_b32 s63, 2098176
    buffer_load_dwordx4 v8, s[28:31], s63 offen sc1 lds
    s_add_u32 m0, s65, 6144
    s_mov_b32 s63, 2129920
    buffer_load_dwordx4 v8, s[28:31], s63 offen sc1 lds
    s_add_u32 m0, s65, 7168
    s_mov_b32 s63, 2130944
    buffer_load_dwordx4 v8, s[28:31], s63 offen sc1 lds
    s_add_u32 m0, s64, 108544
    s_mov_b32 s63, 1146880
    buffer_load_dwordx4 v7, s[32:35], s63 offen lds
    s_add_u32 m0, s64, 109568
    s_mov_b32 s63, 1157120
    buffer_load_dwordx4 v7, s[32:35], s63 offen lds
    s_waitcnt vmcnt(16)
    s_barrier
    s_add_u32 m0, s65, 20480
    s_mov_b32 s63, 2359296
    buffer_load_dwordx4 v8, s[28:31], s63 offen sc1 lds
    s_add_u32 m0, s65, 21504
    s_mov_b32 s63, 2360320
    buffer_load_dwordx4 v8, s[28:31], s63 offen sc1 lds
    s_add_u32 m0, s65, 22528
    s_mov_b32 s63, 2392064
    buffer_load_dwordx4 v8, s[28:31], s63 offen sc1 lds
    s_add_u32 m0, s65, 23552
    s_mov_b32 s63, 2393088
    buffer_load_dwordx4 v8, s[28:31], s63 offen sc1 lds
    s_add_u32 m0, s64, 116736
    s_mov_b32 s63, 1228800
    buffer_load_dwordx4 v7, s[32:35], s63 offen lds
    s_add_u32 m0, s64, 117760
    s_mov_b32 s63, 1239040
    buffer_load_dwordx4 v7, s[32:35], s63 offen lds
    s_waitcnt vmcnt(14)
    s_barrier
    s_add_u32 m0, s65, 36864
    s_mov_b32 s63, 2621440
    buffer_load_dwordx4 v8, s[28:31], s63 offen sc1 lds
    s_add_u32 m0, s65, 37888
    s_mov_b32 s63, 2622464
    buffer_load_dwordx4 v8, s[28:31], s63 offen sc1 lds
    s_add_u32 m0, s65, 38912
    s_mov_b32 s63, 2654208
    buffer_load_dwordx4 v8, s[28:31], s63 offen sc1 lds
    s_add_u32 m0, s65, 39936
    s_mov_b32 s63, 2655232
    buffer_load_dwordx4 v8, s[28:31], s63 offen sc1 lds
    s_add_u32 m0, s64, 124928
    s_mov_b32 s63, 1310720
    buffer_load_dwordx4 v7, s[32:35], s63 offen lds
    s_add_u32 m0, s64, 125952
    s_mov_b32 s63, 1320960
    buffer_load_dwordx4 v7, s[32:35], s63 offen lds
    s_waitcnt vmcnt(14)
    s_barrier
    s_add_u32 m0, s65, 53248
    s_mov_b32 s63, 2883584
    buffer_load_dwordx4 v8, s[28:31], s63 offen sc1 lds
    s_add_u32 m0, s65, 54272
    s_mov_b32 s63, 2884608
    buffer_load_dwordx4 v8, s[28:31], s63 offen sc1 lds
    s_add_u32 m0, s65, 55296
    s_mov_b32 s63, 2916352
    buffer_load_dwordx4 v8, s[28:31], s63 offen sc1 lds
    s_add_u32 m0, s65, 56320
    s_mov_b32 s63, 2917376
    buffer_load_dwordx4 v8, s[28:31], s63 offen sc1 lds
    s_add_u32 m0, s64, 133120
    s_mov_b32 s63, 1392640
    buffer_load_dwordx4 v7, s[32:35], s63 offen lds
    s_add_u32 m0, s64, 134144
    s_mov_b32 s63, 1402880
    buffer_load_dwordx4 v7, s[32:35], s63 offen lds
    s_waitcnt vmcnt(14)
    s_barrier
    s_add_u32 m0, s65, 4096
    s_mov_b32 s63, 3145728
    buffer_load_dwordx4 v8, s[28:31], s63 offen sc1 lds
    s_add_u32 m0, s65, 5120
    s_mov_b32 s63, 3146752
    buffer_load_dwordx4 v8, s[28:31], s63 offen sc1 lds
    s_add_u32 m0, s65, 6144
    s_mov_b32 s63, 3178496
    buffer_load_dwordx4 v8, s[28:31], s63 offen sc1 lds
    s_add_u32 m0, s65, 7168
    s_mov_b32 s63, 3179520
    buffer_load_dwordx4 v8, s[28:31], s63 offen sc1 lds
    s_add_u32 m0, s64, 141312
    s_mov_b32 s63, 1474560
    buffer_load_dwordx4 v7, s[32:35], s63 offen lds
    s_add_u32 m0, s64, 142336
    s_mov_b32 s63, 1484800
    buffer_load_dwordx4 v7, s[32:35], s63 offen lds
    s_waitcnt vmcnt(14)
    s_barrier
    s_add_u32 m0, s65, 20480
    s_mov_b32 s63, 3407872
    buffer_load_dwordx4 v8, s[28:31], s63 offen sc1 lds
    s_add_u32 m0, s65, 21504
    s_mov_b32 s63, 3408896
    buffer_load_dwordx4 v8, s[28:31], s63 offen sc1 lds
    s_add_u32 m0, s65, 22528
    s_mov_b32 s63, 3440640
    buffer_load_dwordx4 v8, s[28:31], s63 offen sc1 lds
    s_add_u32 m0, s65, 23552
    s_mov_b32 s63, 3441664
    buffer_load_dwordx4 v8, s[28:31], s63 offen sc1 lds
    s_add_u32 m0, s64, 149504
    s_mov_b32 s63, 1556480
    buffer_load_dwordx4 v7, s[32:35], s63 offen lds
    s_add_u32 m0, s64, 150528
    s_mov_b32 s63, 1566720
    buffer_load_dwordx4 v7, s[32:35], s63 offen lds
    s_waitcnt vmcnt(14)
    s_barrier
    s_add_u32 m0, s65, 36864
    s_mov_b32 s63, 3670016
    buffer_load_dwordx4 v8, s[28:31], s63 offen sc1 lds
    s_add_u32 m0, s65, 37888
    s_mov_b32 s63, 3671040
    buffer_load_dwordx4 v8, s[28:31], s63 offen sc1 lds
    s_add_u32 m0, s65, 38912
    s_mov_b32 s63, 3702784
    buffer_load_dwordx4 v8, s[28:31], s63 offen sc1 lds
    s_add_u32 m0, s65, 39936
    s_mov_b32 s63, 3703808
    buffer_load_dwordx4 v8, s[28:31], s63 offen sc1 lds
    s_add_u32 m0, s64, 75776
    s_mov_b32 s63, 1638400
    buffer_load_dwordx4 v7, s[32:35], s63 offen lds
    s_add_u32 m0, s64, 76800
    s_mov_b32 s63, 1648640
    buffer_load_dwordx4 v7, s[32:35], s63 offen lds
    s_waitcnt vmcnt(14)
    s_barrier
    s_add_u32 m0, s65, 53248
    s_mov_b32 s63, 3932160
    buffer_load_dwordx4 v8, s[28:31], s63 offen sc1 lds
    s_add_u32 m0, s65, 54272
    s_mov_b32 s63, 3933184
    buffer_load_dwordx4 v8, s[28:31], s63 offen sc1 lds
    s_add_u32 m0, s65, 55296
    s_mov_b32 s63, 3964928
    buffer_load_dwordx4 v8, s[28:31], s63 offen sc1 lds
    s_add_u32 m0, s65, 56320
    s_mov_b32 s63, 3965952
    buffer_load_dwordx4 v8, s[28:31], s63 offen sc1 lds
    s_add_u32 m0, s64, 83968
    s_mov_b32 s63, 1720320
    buffer_load_dwordx4 v7, s[32:35], s63 offen lds
    s_add_u32 m0, s64, 84992
    s_mov_b32 s63, 1730560
    buffer_load_dwordx4 v7, s[32:35], s63 offen lds
    s_waitcnt vmcnt(14)
    s_barrier
    s_add_u32 m0, s65, 4096
    s_mov_b32 s63, 4194304
    buffer_load_dwordx4 v8, s[28:31], s63 offen sc1 lds
    s_add_u32 m0, s65, 5120
    s_mov_b32 s63, 4195328
    buffer_load_dwordx4 v8, s[28:31], s63 offen sc1 lds
    s_add_u32 m0, s65, 6144
    s_mov_b32 s63, 4227072
    buffer_load_dwordx4 v8, s[28:31], s63 offen sc1 lds
    s_add_u32 m0, s65, 7168
    s_mov_b32 s63, 4228096
    buffer_load_dwordx4 v8, s[28:31], s63 offen sc1 lds
    s_add_u32 m0, s64, 92160
    s_mov_b32 s63, 1802240
    buffer_load_dwordx4 v7, s[32:35], s63 offen lds
    s_add_u32 m0, s64, 93184
    s_mov_b32 s63, 1812480
    buffer_load_dwordx4 v7, s[32:35], s63 offen lds
    s_waitcnt vmcnt(14)
    s_barrier
    s_add_u32 m0, s65, 20480
    s_mov_b32 s63, 4456448
    buffer_load_dwordx4 v8, s[28:31], s63 offen sc1 lds
    s_add_u32 m0, s65, 21504
    s_mov_b32 s63, 4457472
    buffer_load_dwordx4 v8, s[28:31], s63 offen sc1 lds
    s_add_u32 m0, s65, 22528
    s_mov_b32 s63, 4489216
    buffer_load_dwordx4 v8, s[28:31], s63 offen sc1 lds
    s_add_u32 m0, s65, 23552
    s_mov_b32 s63, 4490240
    buffer_load_dwordx4 v8, s[28:31], s63 offen sc1 lds
    s_add_u32 m0, s64, 100352
    s_mov_b32 s63, 1884160
    buffer_load_dwordx4 v7, s[32:35], s63 offen lds
    s_add_u32 m0, s64, 101376
    s_mov_b32 s63, 1894400
    buffer_load_dwordx4 v7, s[32:35], s63 offen lds
    s_waitcnt vmcnt(14)
    s_barrier
    s_add_u32 m0, s65, 36864
    s_mov_b32 s63, 4718592
    buffer_load_dwordx4 v8, s[28:31], s63 offen sc1 lds
    s_add_u32 m0, s65, 37888
    s_mov_b32 s63, 4719616
    buffer_load_dwordx4 v8, s[28:31], s63 offen sc1 lds
    s_add_u32 m0, s65, 38912
    s_mov_b32 s63, 4751360
    buffer_load_dwordx4 v8, s[28:31], s63 offen sc1 lds
    s_add_u32 m0, s65, 39936
    s_mov_b32 s63, 4752384
    buffer_load_dwordx4 v8, s[28:31], s63 offen sc1 lds
    s_add_u32 m0, s64, 108544
    s_mov_b32 s63, 1966080
    buffer_load_dwordx4 v7, s[32:35], s63 offen lds
    s_add_u32 m0, s64, 109568
    s_mov_b32 s63, 1976320
    buffer_load_dwordx4 v7, s[32:35], s63 offen lds
    s_waitcnt vmcnt(14)
    s_barrier
    s_add_u32 m0, s65, 53248
    s_mov_b32 s63, 4980736
    buffer_load_dwordx4 v8, s[28:31], s63 offen sc1 lds
    s_add_u32 m0, s65, 54272
    s_mov_b32 s63, 4981760
    buffer_load_dwordx4 v8, s[28:31], s63 offen sc1 lds
    s_add_u32 m0, s65, 55296
    s_mov_b32 s63, 5013504
    buffer_load_dwordx4 v8, s[28:31], s63 offen sc1 lds
    s_add_u32 m0, s65, 56320
    s_mov_b32 s63, 5014528
    buffer_load_dwordx4 v8, s[28:31], s63 offen sc1 lds
    s_add_u32 m0, s64, 116736
    s_mov_b32 s63, 2048000
    buffer_load_dwordx4 v7, s[32:35], s63 offen lds
    s_add_u32 m0, s64, 117760
    s_mov_b32 s63, 2058240
    buffer_load_dwordx4 v7, s[32:35], s63 offen lds
    s_waitcnt vmcnt(14)
    s_barrier
    s_add_u32 m0, s65, 4096
    s_mov_b32 s63, 5242880
    buffer_load_dwordx4 v8, s[28:31], s63 offen sc1 lds
    s_add_u32 m0, s65, 5120
    s_mov_b32 s63, 5243904
    buffer_load_dwordx4 v8, s[28:31], s63 offen sc1 lds
    s_add_u32 m0, s65, 6144
    s_mov_b32 s63, 5275648
    buffer_load_dwordx4 v8, s[28:31], s63 offen sc1 lds
    s_add_u32 m0, s65, 7168
    s_mov_b32 s63, 5276672
    buffer_load_dwordx4 v8, s[28:31], s63 offen sc1 lds
    s_add_u32 m0, s64, 124928
    s_mov_b32 s63, 2129920
    buffer_load_dwordx4 v7, s[32:35], s63 offen lds
    s_add_u32 m0, s64, 125952
    s_mov_b32 s63, 2140160
    buffer_load_dwordx4 v7, s[32:35], s63 offen lds
    s_waitcnt vmcnt(14)
    s_barrier
    s_add_u32 m0, s65, 20480
    s_mov_b32 s63, 5505024
    buffer_load_dwordx4 v8, s[28:31], s63 offen sc1 lds
    s_add_u32 m0, s65, 21504
    s_mov_b32 s63, 5506048
    buffer_load_dwordx4 v8, s[28:31], s63 offen sc1 lds
    s_add_u32 m0, s65, 22528
    s_mov_b32 s63, 5537792
    buffer_load_dwordx4 v8, s[28:31], s63 offen sc1 lds
    s_add_u32 m0, s65, 23552
    s_mov_b32 s63, 5538816
    buffer_load_dwordx4 v8, s[28:31], s63 offen sc1 lds
    s_waitcnt vmcnt(12)
    s_barrier
    s_add_u32 m0, s65, 36864
    s_mov_b32 s63, 5767168
    buffer_load_dwordx4 v8, s[28:31], s63 offen sc1 lds
    s_add_u32 m0, s65, 37888
    s_mov_b32 s63, 5768192
    buffer_load_dwordx4 v8, s[28:31], s63 offen sc1 lds
    s_add_u32 m0, s65, 38912
    s_mov_b32 s63, 5799936
    buffer_load_dwordx4 v8, s[28:31], s63 offen sc1 lds
    s_add_u32 m0, s65, 39936
    s_mov_b32 s63, 5800960
    buffer_load_dwordx4 v8, s[28:31], s63 offen sc1 lds
    s_waitcnt vmcnt(10)
    s_barrier
    s_add_u32 m0, s65, 53248
    s_mov_b32 s63, 6029312
    buffer_load_dwordx4 v8, s[28:31], s63 offen sc1 lds
    s_add_u32 m0, s65, 54272
    s_mov_b32 s63, 6030336
    buffer_load_dwordx4 v8, s[28:31], s63 offen sc1 lds
    s_add_u32 m0, s65, 55296
    s_mov_b32 s63, 6062080
    buffer_load_dwordx4 v8, s[28:31], s63 offen sc1 lds
    s_add_u32 m0, s65, 56320
    s_mov_b32 s63, 6063104
    buffer_load_dwordx4 v8, s[28:31], s63 offen sc1 lds
    s_waitcnt vmcnt(8)
    s_barrier
    s_add_u32 m0, s65, 4096
    s_mov_b32 s63, 6291456
    buffer_load_dwordx4 v8, s[28:31], s63 offen sc1 lds
    s_add_u32 m0, s65, 5120
    s_mov_b32 s63, 6292480
    buffer_load_dwordx4 v8, s[28:31], s63 offen sc1 lds
    s_add_u32 m0, s65, 6144
    s_mov_b32 s63, 6324224
    buffer_load_dwordx4 v8, s[28:31], s63 offen sc1 lds
    s_add_u32 m0, s65, 7168
    s_mov_b32 s63, 6325248
    buffer_load_dwordx4 v8, s[28:31], s63 offen sc1 lds
    s_waitcnt vmcnt(8)
    s_barrier
    s_add_u32 m0, s65, 20480
    s_mov_b32 s63, 6553600
    buffer_load_dwordx4 v8, s[28:31], s63 offen sc1 lds
    s_add_u32 m0, s65, 21504
    s_mov_b32 s63, 6554624
    buffer_load_dwordx4 v8, s[28:31], s63 offen sc1 lds
    s_add_u32 m0, s65, 22528
    s_mov_b32 s63, 6586368
    buffer_load_dwordx4 v8, s[28:31], s63 offen sc1 lds
    s_add_u32 m0, s65, 23552
    s_mov_b32 s63, 6587392
    buffer_load_dwordx4 v8, s[28:31], s63 offen sc1 lds
    s_waitcnt vmcnt(8)
    s_barrier
    s_add_u32 m0, s65, 36864
    s_mov_b32 s63, 6815744
    buffer_load_dwordx4 v8, s[28:31], s63 offen sc1 lds
    s_add_u32 m0, s65, 37888
    s_mov_b32 s63, 6816768
    buffer_load_dwordx4 v8, s[28:31], s63 offen sc1 lds
    s_add_u32 m0, s65, 38912
    s_mov_b32 s63, 6848512
    buffer_load_dwordx4 v8, s[28:31], s63 offen sc1 lds
    s_add_u32 m0, s65, 39936
    s_mov_b32 s63, 6849536
    buffer_load_dwordx4 v8, s[28:31], s63 offen sc1 lds
    s_waitcnt vmcnt(8)
    s_barrier
    s_waitcnt vmcnt(4)
    s_barrier
    s_waitcnt vmcnt(0)
    s_barrier
    s_barrier
    s_branch l_end_89
l_classB_88:
    s_lshl_b32 s59, s54, 7
    s_lshl_b32 s60, s56, 8
    s_add_u32 s61, s54, s56
    s_mul_i32 s62, s61, 26
    s_lshr_b32 s62, s62, 8
    s_mul_i32 s62, s62, 10
    s_sub_u32 s61, s61, s62
    s_mov_b32 s32, s12
    s_and_b32 s33, s13, 0xffff
    s_mov_b32 s34, 2211840
    s_mov_b32 s35, 0x20000
    s_sub_u32 s63, s24, 4
    v_lshrrev_b32 v4, 4, v1
    v_and_b32 v5, 15, v1
    v_lshlrev_b32 v6, 2, v4
    v_xor_b32 v5, v5, v6
    s_lshl_b32 s64, s63, 4
    v_add_u32 v4, s64, v4
    v_mul_u32_u24 v4, 3456, v4
    v_lshl_add_u32 v4, v5, 4, v4
    v_add_u32 v7, s60, v4
    s_lshl_b32 s66, s63, 12
    s_lshl_b32 s67, s63, 12
    v_add_u32 v4, s59, v1
    v_lshlrev_b32 v4, 4, v4
    s_lshl_b32 s64, s63, 16
    v_add_u32 v8, s64, v4
    s_mul_i32 s68, s61, 262144
    s_mul_i32 s69, s61, 221184
    s_add_u32 s69, s69, 221184
    s_cmp_ge_u32 s69, 2211840
    s_cselect_b32 s65, 2211840, 0
    s_sub_u32 s69, s69, s65
    s_add_u32 s69, s69, 221184
    s_cmp_ge_u32 s69, 2211840
    s_cselect_b32 s65, 2211840, 0
    s_sub_u32 s69, s69, s65
    s_add_u32 s69, s69, 221184
    s_cmp_ge_u32 s69, 2211840
    s_cselect_b32 s65, 2211840, 0
    s_sub_u32 s69, s69, s65
    s_add_u32 s69, s69, 221184
    s_cmp_ge_u32 s69, 2211840
    s_cselect_b32 s65, 2211840, 0
    s_sub_u32 s69, s69, s65
    s_add_u32 s69, s69, 221184
    s_cmp_ge_u32 s69, 2211840
    s_cselect_b32 s65, 2211840, 0
    s_sub_u32 s69, s69, s65
    s_add_u32 s28, s22, 10485760
    s_addc_u32 s29, s23, 0
    s_and_b32 s29, s29, 0xffff
    s_mov_b32 s30, 2621440
    s_mov_b32 s31, 0x20000
    s_add_u32 s36, s22, 20185088
    s_addc_u32 s37, s23, 0
    s_and_b32 s37, s37, 0xffff
    s_mov_b32 s38, 983040
    s_mov_b32 s39, 0x20000
    s_sub_u32 s72, s24, 4
    s_lshl_b32 s72, s72, 10
    v_lshl_add_u32 v9, v1, 4, s72
    s_mul_i32 s70, s54, 20480
    s_add_u32 s70, s70, 491520
    s_mul_i32 s71, s56, 10240
    s_add_u32 s71, s71, 819200
    s_barrier
    s_add_u32 m0, s67, 4096
    s_add_u32 s65, s68, 0
    buffer_load_dwordx4 v8, s[28:31], s65 offen sc1 lds
    s_add_u32 m0, s67, 5120
    s_add_u32 s65, s68, 1024
    buffer_load_dwordx4 v8, s[28:31], s65 offen sc1 lds
    s_add_u32 m0, s67, 6144
    s_add_u32 s65, s68, 32768
    buffer_load_dwordx4 v8, s[28:31], s65 offen sc1 lds
    s_add_u32 m0, s67, 7168
    s_add_u32 s65, s68, 33792
    buffer_load_dwordx4 v8, s[28:31], s65 offen sc1 lds
    s_add_u32 s68, s68, 262144
    s_cmp_ge_u32 s68, 2621440
    s_cselect_b32 s65, 2621440, 0
    s_sub_u32 s68, s68, s65
    s_add_u32 m0, s67, 20480
    s_add_u32 s65, s68, 0
    buffer_load_dwordx4 v8, s[28:31], s65 offen sc1 lds
    s_add_u32 m0, s67, 21504
    s_add_u32 s65, s68, 1024
    buffer_load_dwordx4 v8, s[28:31], s65 offen sc1 lds
    s_add_u32 m0, s67, 22528
    s_add_u32 s65, s68, 32768
    buffer_load_dwordx4 v8, s[28:31], s65 offen sc1 lds
    s_add_u32 m0, s67, 23552
    s_add_u32 s65, s68, 33792
    buffer_load_dwordx4 v8, s[28:31], s65 offen sc1 lds
    s_add_u32 s68, s68, 262144
    s_cmp_ge_u32 s68, 2621440
    s_cselect_b32 s65, 2621440, 0
    s_sub_u32 s68, s68, s65
    s_add_u32 m0, s67, 36864
    s_add_u32 s65, s68, 0
    buffer_load_dwordx4 v8, s[28:31], s65 offen sc1 lds
    s_add_u32 m0, s67, 37888
    s_add_u32 s65, s68, 1024
    buffer_load_dwordx4 v8, s[28:31], s65 offen sc1 lds
    s_add_u32 m0, s67, 38912
    s_add_u32 s65, s68, 32768
    buffer_load_dwordx4 v8, s[28:31], s65 offen sc1 lds
    s_add_u32 m0, s67, 39936
    s_add_u32 s65, s68, 33792
    buffer_load_dwordx4 v8, s[28:31], s65 offen sc1 lds
    s_add_u32 s68, s68, 262144
    s_cmp_ge_u32 s68, 2621440
    s_cselect_b32 s65, 2621440, 0
    s_sub_u32 s68, s68, s65
    s_add_u32 m0, s67, 53248
    s_add_u32 s65, s68, 0
    buffer_load_dwordx4 v8, s[28:31], s65 offen sc1 lds
    s_add_u32 m0, s67, 54272
    s_add_u32 s65, s68, 1024
    buffer_load_dwordx4 v8, s[28:31], s65 offen sc1 lds
    s_add_u32 m0, s67, 55296
    s_add_u32 s65, s68, 32768
    buffer_load_dwordx4 v8, s[28:31], s65 offen sc1 lds
    s_add_u32 m0, s67, 56320
    s_add_u32 s65, s68, 33792
    buffer_load_dwordx4 v8, s[28:31], s65 offen sc1 lds
    s_add_u32 s68, s68, 262144
    s_cmp_ge_u32 s68, 2621440
    s_cselect_b32 s65, 2621440, 0
    s_sub_u32 s68, s68, s65
    s_waitcnt vmcnt(12)
    s_barrier
    s_waitcnt vmcnt(8)
    s_barrier
    s_add_u32 m0, s67, 4096
    s_add_u32 s65, s68, 0
    buffer_load_dwordx4 v8, s[28:31], s65 offen sc1 lds
    s_add_u32 m0, s67, 5120
    s_add_u32 s65, s68, 1024
    buffer_load_dwordx4 v8, s[28:31], s65 offen sc1 lds
    s_add_u32 m0, s67, 6144
    s_add_u32 s65, s68, 32768
    buffer_load_dwordx4 v8, s[28:31], s65 offen sc1 lds
    s_add_u32 m0, s67, 7168
    s_add_u32 s65, s68, 33792
    buffer_load_dwordx4 v8, s[28:31], s65 offen sc1 lds
    s_add_u32 s68, s68, 262144
    s_cmp_ge_u32 s68, 2621440
    s_cselect_b32 s65, 2621440, 0
    s_sub_u32 s68, s68, s65
    s_add_u32 m0, s66, 75776
    s_add_u32 s65, s69, 0
    buffer_load_dwordx4 v7, s[32:35], s65 offen lds
    s_add_u32 m0, s66, 76800
    s_add_u32 s65, s69, 13824
    buffer_load_dwordx4 v7, s[32:35], s65 offen lds
    s_add_u32 m0, s66, 77824
    s_add_u32 s65, s69, 27648
    buffer_load_dwordx4 v7, s[32:35], s65 offen lds
    s_add_u32 m0, s66, 78848
    s_add_u32 s65, s69, 41472
    buffer_load_dwordx4 v7, s[32:35], s65 offen lds
    s_add_u32 s69, s69, 221184
    s_cmp_ge_u32 s69, 2211840
    s_cselect_b32 s65, 2211840, 0
    s_sub_u32 s69, s69, s65
    s_waitcnt vmcnt(12)
    s_barrier
    s_add_u32 m0, s67, 20480
    s_add_u32 s65, s68, 0
    buffer_load_dwordx4 v8, s[28:31], s65 offen sc1 lds
    s_add_u32 m0, s67, 21504
    s_add_u32 s65, s68, 1024
    buffer_load_dwordx4 v8, s[28:31], s65 offen sc1 lds
    s_add_u32 m0, s67, 22528
    s_add_u32 s65, s68, 32768
    buffer_load_dwordx4 v8, s[28:31], s65 offen sc1 lds
    s_add_u32 m0, s67, 23552
    s_add_u32 s65, s68, 33792
    buffer_load_dwordx4 v8, s[28:31], s65 offen sc1 lds
    s_add_u32 s68, s68, 262144
    s_cmp_ge_u32 s68, 2621440
    s_cselect_b32 s65, 2621440, 0
    s_sub_u32 s68, s68, s65
    s_add_u32 m0, s66, 92160
    s_add_u32 s65, s69, 0
    buffer_load_dwordx4 v7, s[32:35], s65 offen lds
    s_add_u32 m0, s66, 93184
    s_add_u32 s65, s69, 13824
    buffer_load_dwordx4 v7, s[32:35], s65 offen lds
    s_add_u32 m0, s66, 94208
    s_add_u32 s65, s69, 27648
    buffer_load_dwordx4 v7, s[32:35], s65 offen lds
    s_add_u32 m0, s66, 95232
    s_add_u32 s65, s69, 41472
    buffer_load_dwordx4 v7, s[32:35], s65 offen lds
    s_add_u32 s69, s69, 221184
    s_cmp_ge_u32 s69, 2211840
    s_cselect_b32 s65, 2211840, 0
    s_sub_u32 s69, s69, s65
    s_waitcnt vmcnt(16)
    s_barrier
    s_add_u32 m0, s67, 36864
    s_add_u32 s65, s68, 0
    buffer_load_dwordx4 v8, s[28:31], s65 offen sc1 lds
    s_add_u32 m0, s67, 37888
    s_add_u32 s65, s68, 1024
    buffer_load_dwordx4 v8, s[28:31], s65 offen sc1 lds
    s_add_u32 m0, s67, 38912
    s_add_u32 s65, s68, 32768
    buffer_load_dwordx4 v8, s[28:31], s65 offen sc1 lds
    s_add_u32 m0, s67, 39936
    s_add_u32 s65, s68, 33792
    buffer_load_dwordx4 v8, s[28:31], s65 offen sc1 lds
    s_add_u32 s68, s68, 262144
    s_cmp_ge_u32 s68, 2621440
    s_cselect_b32 s65, 2621440, 0
    s_sub_u32 s68, s68, s65
    s_add_u32 m0, s66, 108544
    s_add_u32 s65, s69, 0
    buffer_load_dwordx4 v7, s[32:35], s65 offen lds
    s_add_u32 m0, s66, 109568
    s_add_u32 s65, s69, 13824
    buffer_load_dwordx4 v7, s[32:35], s65 offen lds
    s_add_u32 m0, s66, 110592
    s_add_u32 s65, s69, 27648
    buffer_load_dwordx4 v7, s[32:35], s65 offen lds
    s_add_u32 m0, s66, 111616
    s_add_u32 s65, s69, 41472
    buffer_load_dwordx4 v7, s[32:35], s65 offen lds
    s_add_u32 s69, s69, 221184
    s_cmp_ge_u32 s69, 2211840
    s_cselect_b32 s65, 2211840, 0
    s_sub_u32 s69, s69, s65
    s_waitcnt vmcnt(20)
    s_barrier
    s_add_u32 m0, s67, 53248
    s_add_u32 s65, s68, 0
    buffer_load_dwordx4 v8, s[28:31], s65 offen sc1 lds
    s_add_u32 m0, s67, 54272
    s_add_u32 s65, s68, 1024
    buffer_load_dwordx4 v8, s[28:31], s65 offen sc1 lds
    s_add_u32 m0, s67, 55296
    s_add_u32 s65, s68, 32768
    buffer_load_dwordx4 v8, s[28:31], s65 offen sc1 lds
    s_add_u32 m0, s67, 56320
    s_add_u32 s65, s68, 33792
    buffer_load_dwordx4 v8, s[28:31], s65 offen sc1 lds
    s_add_u32 s68, s68, 262144
    s_cmp_ge_u32 s68, 2621440
    s_cselect_b32 s65, 2621440, 0
    s_sub_u32 s68, s68, s65
    s_add_u32 m0, s66, 124928
    s_add_u32 s65, s69, 0
    buffer_load_dwordx4 v7, s[32:35], s65 offen lds
    s_add_u32 m0, s66, 125952
    s_add_u32 s65, s69, 13824
    buffer_load_dwordx4 v7, s[32:35], s65 offen lds
    s_add_u32 m0, s66, 126976
    s_add_u32 s65, s69, 27648
    buffer_load_dwordx4 v7, s[32:35], s65 offen lds
    s_add_u32 m0, s66, 128000
    s_add_u32 s65, s69, 41472
    buffer_load_dwordx4 v7, s[32:35], s65 offen lds
    s_add_u32 s69, s69, 221184
    s_cmp_ge_u32 s69, 2211840
    s_cselect_b32 s65, 2211840, 0
    s_sub_u32 s69, s69, s65
    s_waitcnt vmcnt(20)
    s_barrier
    s_add_u32 m0, s67, 4096
    s_add_u32 s65, s68, 0
    buffer_load_dwordx4 v8, s[28:31], s65 offen sc1 lds
    s_add_u32 m0, s67, 5120
    s_add_u32 s65, s68, 1024
    buffer_load_dwordx4 v8, s[28:31], s65 offen sc1 lds
    s_add_u32 m0, s67, 6144
    s_add_u32 s65, s68, 32768
    buffer_load_dwordx4 v8, s[28:31], s65 offen sc1 lds
    s_add_u32 m0, s67, 7168
    s_add_u32 s65, s68, 33792
    buffer_load_dwordx4 v8, s[28:31], s65 offen sc1 lds
    s_add_u32 s68, s68, 262144
    s_cmp_ge_u32 s68, 2621440
    s_cselect_b32 s65, 2621440, 0
    s_sub_u32 s68, s68, s65
    s_add_u32 m0, s66, 141312
    s_add_u32 s65, s69, 0
    buffer_load_dwordx4 v7, s[32:35], s65 offen lds
    s_add_u32 m0, s66, 142336
    s_add_u32 s65, s69, 13824
    buffer_load_dwordx4 v7, s[32:35], s65 offen lds
    s_add_u32 m0, s66, 143360
    s_add_u32 s65, s69, 27648
    buffer_load_dwordx4 v7, s[32:35], s65 offen lds
    s_add_u32 m0, s66, 144384
    s_add_u32 s65, s69, 41472
    buffer_load_dwordx4 v7, s[32:35], s65 offen lds
    s_add_u32 s69, s69, 221184
    s_cmp_ge_u32 s69, 2211840
    s_cselect_b32 s65, 2211840, 0
    s_sub_u32 s69, s69, s65
    s_waitcnt vmcnt(20)
    s_barrier
    s_add_u32 m0, s67, 20480
    s_add_u32 s65, s68, 0
    buffer_load_dwordx4 v8, s[28:31], s65 offen sc1 lds
    s_add_u32 m0, s67, 21504
    s_add_u32 s65, s68, 1024
    buffer_load_dwordx4 v8, s[28:31], s65 offen sc1 lds
    s_add_u32 m0, s67, 22528
    s_add_u32 s65, s68, 32768
    buffer_load_dwordx4 v8, s[28:31], s65 offen sc1 lds
    s_add_u32 m0, s67, 23552
    s_add_u32 s65, s68, 33792
    buffer_load_dwordx4 v8, s[28:31], s65 offen sc1 lds
    s_add_u32 s68, s68, 262144
    s_cmp_ge_u32 s68, 2621440
    s_cselect_b32 s65, 2621440, 0
    s_sub_u32 s68, s68, s65
    s_waitcnt vmcnt(16)
    s_barrier
    s_add_u32 m0, s72, 36864
    s_add_u32 s65, s70, 0
    buffer_load_dwordx4 v9, s[36:39], s65 offen sc1 lds
    s_add_u32 m0, s72, 40960
    s_add_u32 s65, s70, 4096
    buffer_load_dwordx4 v9, s[36:39], s65 offen sc1 lds
    s_add_u32 m0, s72, 45056
    s_add_u32 s65, s70, 8192
    buffer_load_dwordx4 v9, s[36:39], s65 offen sc1 lds
    s_add_u32 m0, s72, 49152
    s_add_u32 s65, s70, 12288
    buffer_load_dwordx4 v9, s[36:39], s65 offen sc1 lds
    s_add_u32 m0, s72, 92160
    s_add_u32 s65, s70, 16384
    buffer_load_dwordx4 v9, s[36:39], s65 offen sc1 lds
    s_add_u32 m0, s72, 96256
    s_add_u32 s65, s71, 0
    buffer_load_dwordx4 v9, s[36:39], s65 offen sc1 lds
    s_add_u32 m0, s72, 100352
    s_add_u32 s65, s71, 4096
    buffer_load_dwordx4 v9, s[36:39], s65 offen sc1 lds
    s_cmp_ge_u32 s72, 2048
    s_cbranch_scc1 sd_skip_91
    s_add_u32 m0, s72, 104448
    s_add_u32 s65, s71, 8192
    buffer_load_dwordx4 v9, s[36:39], s65 offen sc1 lds
sd_skip_91:
    s_waitcnt vmcnt(8)
    s_barrier
    s_waitcnt vmcnt(0)
    s_barrier
    s_barrier
    s_barrier
l_end_89:
sequential_preLN__sliding_block__dense_activation_squared_relu__prompt_kernel_done:
    s_endpgm
sequential_preLN__sliding_block__dense_activation_squared_relu__prompt_kernel_code_end:
.section .rodata,"a"
.p2align 6
.amdhsa_kernel sequential_preLN__sliding_block__dense_activation_squared_relu__prompt_kernel
  .amdhsa_next_free_vgpr 256
  .amdhsa_next_free_sgpr 102
  .amdhsa_accum_offset 256
  .amdhsa_group_segment_fixed_size 0
  .amdhsa_kernarg_size 88
  .amdhsa_user_sgpr_count 2
  .amdhsa_user_sgpr_kernarg_segment_ptr 1
  .amdhsa_system_sgpr_workgroup_id_x 1
.end_amdhsa_kernel
```
